```python
import torch

def _softmax(x, axis=-1):
    return torch.softmax(x, dim=axis)

def _gelu(x):
    return torch.nn.functional.gelu(x, approximate='tanh')

def _silu(x):
    return torch.nn.functional.silu(x)

def _sigmoid(x):
    return torch.sigmoid(x)

def _layernorm(x, axis=-1, eps=1e-05):
    m = x.mean(dim=axis, keepdim=True)
    v = x.var(dim=axis, keepdim=True, unbiased=False)
    return (x - m) / torch.sqrt(v + eps)

def _scatter_add(tgt, idx, src, axis=0):
    return tgt.clone().index_add_(axis, idx, src)

def _segment_sum(src, seg, n):
    out = torch.zeros((n,) + src.shape[1:], dtype=src.dtype)
    return out.index_add_(0, seg, src)

def _pad(x, pw):
    flat = tuple((v for pair in reversed(pw) for v in pair))
    return torch.nn.functional.pad(x, flat)
kernel_name = 'adaLN_cond__mha_block_cached__dense_activation_silu__prompt'

def setup_inputs():

    _w = lambda a: (lambda t: t.to(torch.bfloat16) if t.is_floating_point() else t)(torch.as_tensor(a))

    def _A_setup():
        B, Sq, D = (1, 2048, 448)
        H, Sk, Dh = (16, 2048, 256)
        return {'x': _w((lambda *s: torch.randn(*s, dtype=torch.bfloat16) * 0.1)(B, Sq, D)), 'k_cache': _w((lambda *s: torch.randn(*s, dtype=torch.bfloat16) * 0.8)(B, H, Sk, Dh)), 'v_cache': _w((lambda *s: torch.randn(*s, dtype=torch.bfloat16) * 3.2)(B, H, Sk, Dh)), 'wq': _w((lambda *s: torch.randn(*s, dtype=torch.bfloat16) * 0.8)(D, H * Dh) * D ** (-0.5)), 'wo': _w((lambda *s: torch.randn(*s, dtype=torch.bfloat16) * 3.2)(H * Dh, D) * (H * Dh) ** (-0.5))}
    _A_in = _A_setup()

    def _B_setup():
        B, S, D, F = (1, 2048, 448, 1792)
        return {'x': _w((lambda *s: torch.randn(*s, dtype=torch.bfloat16) * 0.1)(B, S, D)), 'w1': _w((lambda *s: torch.randn(*s, dtype=torch.bfloat16) * 3.2)(D, F) * D ** (-0.5)), 'w2': _w((lambda *s: torch.randn(*s, dtype=torch.bfloat16) * 3.2)(F, D) * F ** (-0.5))}
    _B_in = _B_setup()
    return {'A_x': _A_in['x'], 'A_k_cache': _A_in['k_cache'], 'A_v_cache': _A_in['v_cache'], 'A_wq': _A_in['wq'], 'A_wo': _A_in['wo'], 'B_x': _B_in['x'], 'B_w1': _B_in['w1'], 'B_w2': _B_in['w2'], 'c': _w((lambda *s: torch.randn(*s, dtype=torch.bfloat16) * 0.1)(1, 448) * 8.0), 'w_mod': _w((lambda *s: torch.randn(*s, dtype=torch.bfloat16) * 0.1)(448, 6 * 448) * 448 ** (-0.5) * 8.0)}

def reference(A_x, A_k_cache, A_v_cache, A_wq, A_wo, B_x, B_w1, B_w2, c, w_mod):

    def _A_ref(x, k_cache, v_cache, wq, wo):
        B, Sq, D = x.shape
        H, Dh = (16, 256)
        q = (lambda x, *d: x.permute(*d))((x @ wq).reshape(B, Sq, H, Dh), 0, 2, 1, 3)
        scores = torch.einsum('bhqd,bhkd->bhqk', q, k_cache) * Dh ** (-0.5)
        p = _softmax(scores, axis=-1)
        o = torch.einsum('bhqk,bhkd->bhqd', p, v_cache)
        return (lambda x, *d: x.permute(*d))(o, 0, 2, 1, 3).reshape(B, Sq, H * Dh) @ wo

    def _B_ref(x, w1, w2):
        h = torch.einsum('bsd,df->bsf', x, w1)
        h = _silu(h)
        out = torch.einsum('bsf,fd->bsd', h, w2)
        return out
    x = A_x
    mod = (_silu(c) @ w_mod).reshape(c.shape[0], 6, 1, -1)
    sa, ca, ga, sb, cb, gb = (mod[:, 0].clone(), mod[:, 1].clone(), mod[:, 2].clone(), mod[:, 3].clone(), mod[:, 4].clone(), mod[:, 5].clone())
    h = _layernorm(x, axis=-1) * (1 + ca) + sa
    x = x + ga * _A_ref(h, A_k_cache, A_v_cache, A_wq, A_wo)
    h = _layernorm(x, axis=-1) * (1 + cb) + sb
    x = x + gb * _B_ref(h, B_w1, B_w2)
    return x
```

```asm
; @launch grid=(256,1,1) block=(256,1,1) lds=163840
.amdgcn_target "amdgcn-amd-amdhsa--gfx950"
.text
.globl adaLN_cond__mha_block_cached__dense_activation_silu__prompt_kernel
.p2align 8
.type adaLN_cond__mha_block_cached__dense_activation_silu__prompt_kernel,@function
adaLN_cond__mha_block_cached__dense_activation_silu__prompt_kernel:
  s_cmp_ge_u32 s2, 256
  s_cbranch_scc1 K2_end
  s_load_dwordx2 s[28:29], s[0:1], 88
  s_load_dwordx2 s[64:65], s[0:1], 0
  s_load_dwordx4 s[16:19], s[0:1], 64
  s_load_dwordx2 s[8:9], s[0:1], 24
  s_load_dwordx2 s[10:11], s[0:1], 96
  s_memrealtime s[44:45]
  v_lshrrev_b32 v1, 6, v0
  s_getpc_b64 s[56:57]
K2_pc:
  v_readfirstlane_b32 s14, v1
  s_lshr_b32 s58, s2, 3
  s_lshl_b32 s58, s58, 2
  s_nop 1
  s_add_u32 s58, s58, s14
  s_lshl_b32 s58, s58, 6
  s_add_u32 s59, s58, 0
  s_min_u32 s59, s59, K2_tail-K2_pc-4
  s_load_dword s76, s[56:57], s59
  s_add_u32 s59, s58, 8192
  s_min_u32 s59, s59, K2_tail-K2_pc-4
  s_load_dword s77, s[56:57], s59
  s_add_u32 s59, s58, 16384
  s_min_u32 s59, s59, K2_tail-K2_pc-4
  s_load_dword s78, s[56:57], s59
  s_add_u32 s59, s58, 24576
  s_min_u32 s59, s59, K2_tail-K2_pc-4
  s_load_dword s79, s[56:57], s59
  s_and_b32 s73, s2, 7
  s_lshr_b32 s68, s2, 3
  s_mul_i32 s69, s68, 37
  s_lshr_b32 s69, s69, 8
  s_mul_i32 s70, s69, 7
  s_sub_u32 s70, s68, s70
  s_lshl_b32 s74, s73, 2
  s_add_u32 s69, s69, s74
  s_and_b32 s12, s2, 7
  s_lshl_b32 s12, s12, 1
  s_bfe_u32 s13, s2, 0x10003
  s_add_u32 s12, s12, s13
  s_lshr_b32 s13, s2, 4
  v_mov_b32 v143, v0
  v_and_b32 v208, 63, v0
  v_lshrrev_b32 v209, 6, v0
  v_and_b32 v210, 15, v0
  v_bfe_u32 v211, v0, 4, 2
  v_bfe_u32 v212, v0, 2, 2
  v_and_b32 v213, 3, v0
  v_bfe_u32 v214, v0, 5, 1
  v_and_b32 v215, 31, v0
  v_lshrrev_b32 v115, 2, v0
  v_mul_u32_u24 v114, 5376, v115
  v_lshl_add_u32 v114, v213, 4, v114
  v_lshlrev_b32 v115, 1, v115
  v_mul_u32_u24 v116, 896, v210
  v_lshl_add_u32 v116, v211, 4, v116
  v_lshl_add_u32 v116, v209, 6, v116
  v_lshl_add_u32 v113, v209, 3, v214
  v_add_u32 v113, 0, v113
  v_and_b32 v112, 3, v113
  v_bfe_u32 v117, v113, 3, 1
  v_lshl_add_u32 v112, v117, 2, v112
  v_lshlrev_b32 v112, 1, v112
  v_xor_b32 v112, v112, v215
  v_lshlrev_b32 v112, 4, v112
  v_lshl_add_u32 v128, v113, 13, v112
  v_lshl_add_u32 v113, v209, 3, v214
  v_add_u32 v113, 2, v113
  v_and_b32 v112, 3, v113
  v_bfe_u32 v117, v113, 3, 1
  v_lshl_add_u32 v112, v117, 2, v112
  v_lshlrev_b32 v112, 1, v112
  v_xor_b32 v112, v112, v215
  v_lshlrev_b32 v112, 4, v112
  v_lshl_add_u32 v129, v113, 13, v112
  v_subrev_u32 v129, 1024, v129
  v_lshl_add_u32 v113, v209, 3, v214
  v_add_u32 v113, 4, v113
  v_and_b32 v112, 3, v113
  v_bfe_u32 v117, v113, 3, 1
  v_lshl_add_u32 v112, v117, 2, v112
  v_lshlrev_b32 v112, 1, v112
  v_xor_b32 v112, v112, v215
  v_lshlrev_b32 v112, 4, v112
  v_lshl_add_u32 v130, v113, 13, v112
  v_subrev_u32 v130, 2048, v130
  v_lshl_add_u32 v113, v209, 3, v214
  v_add_u32 v113, 6, v113
  v_and_b32 v112, 3, v113
  v_bfe_u32 v117, v113, 3, 1
  v_lshl_add_u32 v112, v117, 2, v112
  v_lshlrev_b32 v112, 1, v112
  v_xor_b32 v112, v112, v215
  v_lshlrev_b32 v112, 4, v112
  v_lshl_add_u32 v131, v113, 13, v112
  v_subrev_u32 v131, 3072, v131
  s_lshl_b32 s40, s14, 12
  s_lshl_b32 s50, s12, 20
  s_lshl_b32 s51, s12, 9
  s_lshl_b32 s48, s13, 20
  s_lshl_b32 s49, s12, 13
  s_add_u32 s48, s48, s49
  s_lshl_b32 s52, s13, 3
  s_and_b32 s53, s2, 7
  s_add_u32 s52, s52, s53
  s_waitcnt lgkmcnt(0)
  s_and_b32 s29, s29, 0xffff
  s_mov_b32 s30, 256
  s_mov_b32 s31, 0x20000
  s_or_b32 s46, s2, s14
  s_cmp_lg_u32 s46, 0
  s_cbranch_scc1 K2_n0
  s_or_b32 s44, s44, 1
  v_mov_b32 v1, 0
  v_mov_b32 v2, s44
  s_mov_b64 exec, 1
  buffer_store_dword v2, v1, s[28:31], 0 offen sc1
  s_mov_b64 exec, -1
K2_n0:
  s_mov_b32 s47, 0
  s_bitcmp1_b32 s2, 3
  s_cbranch_scc0 K2_ln0
  s_cmp_ge_u32 s52, 84
  s_cbranch_scc1 K2_g0
  s_mov_b32 s47, 1
  s_mov_b32 s20, s16
  s_mov_b32 s21, s17
  s_and_b32 s21, s21, 0xffff
  s_mov_b32 s22, 0x380
  s_mov_b32 s23, 0x20000
  s_mov_b32 s36, s18
  s_mov_b32 s37, s19
  s_and_b32 s37, s37, 0xffff
  s_mov_b32 s38, 0x24c000
  s_mov_b32 s39, 0x20000
  buffer_load_ushort v16, v115, s[20:23], 0 offen offset:0 nt
  buffer_load_ushort v17, v115, s[20:23], 0 offen offset:128 nt
  buffer_load_ushort v18, v115, s[20:23], 0 offen offset:256 nt
  buffer_load_ushort v19, v115, s[20:23], 0 offen offset:384 nt
  buffer_load_ushort v20, v115, s[20:23], 0 offen offset:512 nt
  buffer_load_ushort v21, v115, s[20:23], 0 offen offset:640 nt
  buffer_load_ushort v22, v115, s[20:23], 0 offen offset:768 nt
  s_lshl_b32 s46, s52, 6
  s_add_u32 s53, s46, 0
  buffer_load_dwordx4 v[32:35], v114, s[36:39], s53 offen nt
  s_add_u32 s53, s46, 344064
  buffer_load_dwordx4 v[36:39], v114, s[36:39], s53 offen nt
  s_add_u32 s53, s46, 688128
  buffer_load_dwordx4 v[40:43], v114, s[36:39], s53 offen nt
  s_add_u32 s53, s46, 1032192
  buffer_load_dwordx4 v[44:47], v114, s[36:39], s53 offen nt
  s_add_u32 s53, s46, 1376256
  buffer_load_dwordx4 v[48:51], v114, s[36:39], s53 offen nt
  s_add_u32 s53, s46, 1720320
  buffer_load_dwordx4 v[52:55], v114, s[36:39], s53 offen nt
  s_add_u32 s53, s46, 2064384
  buffer_load_dwordx4 v[56:59], v114, s[36:39], s53 offen nt
  s_branch K2_g0
K2_ln0:
  s_mov_b32 s47, 2
  s_mul_i32 s46, s52, 14336
  s_mov_b32 s36, s64
  s_mov_b32 s37, s65
  s_add_u32 s36, s36, s46
  s_addc_u32 s37, s37, 0
  s_and_b32 s37, s37, 0xffff
  s_mov_b32 s38, 0x3800
  s_mov_b32 s39, 0x20000
  s_cmp_lt_u32 s14, 2
  s_cselect_b32 s53, 0, 0x100000
  buffer_load_dwordx4 v[0:3], v116, s[36:39], 0 offen offset:0 nt
  buffer_load_dwordx4 v[4:7], v116, s[36:39], 0 offen offset:256 nt
  buffer_load_dwordx4 v[8:11], v116, s[36:39], 0 offen offset:512 nt
  buffer_load_dwordx4 v[12:15], v116, s[36:39], s53 offen offset:768 nt
K2_g0:
  s_load_dwordx4 s[4:7], s[0:1], 8
  s_load_dwordx2 s[66:67], s[0:1], 80
  s_load_dwordx2 s[60:61], s[0:1], 32
  s_load_dwordx2 s[62:63], s[0:1], 48
  s_load_dwordx2 s[54:55], s[0:1], 56
  s_mov_b32 s24, s8
  s_mov_b32 s25, s9
  s_add_u32 s24, s24, s51
  s_addc_u32 s25, s25, 0
  s_and_b32 s25, s25, 0xffff
  s_mov_b32 s26, 0x0
  s_mov_b32 s27, 0x20000
  s_sub_u32 s26, 3670016, s51
  s_mov_b32 s8, s28
  s_mov_b32 s9, s29
  s_mov_b32 s32, s10
  s_mov_b32 s33, s11
  s_and_b32 s33, s33, 0xffff
  s_mov_b32 s34, 0x2a00
  s_mov_b32 s35, 0x20000
  s_add_u32 s16, s10, 0x30000
  s_addc_u32 s17, s11, 0
  s_and_b32 s17, s17, 0xffff
  s_mov_b32 s18, 0x4000
  s_mov_b32 s19, 0x20000
  v_mov_b32 v118, 0
  buffer_load_dword v119, v118, s[28:31], 0 offen sc1
  s_cmp_eq_u32 s47, 1
  s_cbranch_scc1 K2_gv
  s_cmp_eq_u32 s47, 2
  s_cbranch_scc1 K2_ln1
  s_branch K2_g8
K2_gv:
  s_waitcnt vmcnt(8)
  v_lshlrev_b32 v16, 16, v16
  v_lshlrev_b32 v17, 16, v17
  v_lshlrev_b32 v18, 16, v18
  v_lshlrev_b32 v19, 16, v19
  v_lshlrev_b32 v20, 16, v20
  v_lshlrev_b32 v21, 16, v21
  v_lshlrev_b32 v22, 16, v22
  v_mul_f32 v24, 0xbfb8aa3b, v16
  v_mul_f32 v25, 0xbfb8aa3b, v17
  v_mul_f32 v26, 0xbfb8aa3b, v18
  v_mul_f32 v27, 0xbfb8aa3b, v19
  v_mul_f32 v28, 0xbfb8aa3b, v20
  v_mul_f32 v29, 0xbfb8aa3b, v21
  v_mul_f32 v30, 0xbfb8aa3b, v22
  v_exp_f32 v24, v24
  v_exp_f32 v25, v25
  v_exp_f32 v26, v26
  v_exp_f32 v27, v27
  v_exp_f32 v28, v28
  v_exp_f32 v29, v29
  v_exp_f32 v30, v30
  v_add_f32 v24, 1.0, v24
  v_add_f32 v25, 1.0, v25
  v_add_f32 v26, 1.0, v26
  v_add_f32 v27, 1.0, v27
  v_add_f32 v28, 1.0, v28
  v_add_f32 v29, 1.0, v29
  v_add_f32 v30, 1.0, v30
  v_rcp_f32 v24, v24
  v_rcp_f32 v25, v25
  v_rcp_f32 v26, v26
  v_rcp_f32 v27, v27
  v_rcp_f32 v28, v28
  v_rcp_f32 v29, v29
  v_rcp_f32 v30, v30
  v_mul_f32 v16, v16, v24
  v_mul_f32 v17, v17, v25
  v_mul_f32 v18, v18, v26
  v_mul_f32 v19, v19, v27
  v_mul_f32 v20, v20, v28
  v_mul_f32 v21, v21, v29
  v_mul_f32 v22, v22, v30
  v_cvt_pk_bf16_f32 v16, v16, v16
  v_and_b32 v16, 0xffff0000, v16
  v_cvt_pk_bf16_f32 v17, v17, v17
  v_and_b32 v17, 0xffff0000, v17
  v_cvt_pk_bf16_f32 v18, v18, v18
  v_and_b32 v18, 0xffff0000, v18
  v_cvt_pk_bf16_f32 v19, v19, v19
  v_and_b32 v19, 0xffff0000, v19
  v_cvt_pk_bf16_f32 v20, v20, v20
  v_and_b32 v20, 0xffff0000, v20
  v_cvt_pk_bf16_f32 v21, v21, v21
  v_and_b32 v21, 0xffff0000, v21
  v_cvt_pk_bf16_f32 v22, v22, v22
  v_and_b32 v22, 0xffff0000, v22
  s_waitcnt vmcnt(7)
  v_lshlrev_b32 v72, 16, v32
  v_and_b32 v73, 0xffff0000, v32
  v_mul_f32 v64, v72, v16
  v_mul_f32 v65, v73, v16
  v_lshlrev_b32 v74, 16, v33
  v_and_b32 v75, 0xffff0000, v33
  v_mul_f32 v66, v74, v16
  v_mul_f32 v67, v75, v16
  v_lshlrev_b32 v72, 16, v34
  v_and_b32 v73, 0xffff0000, v34
  v_mul_f32 v68, v72, v16
  v_mul_f32 v69, v73, v16
  v_lshlrev_b32 v74, 16, v35
  v_and_b32 v75, 0xffff0000, v35
  v_mul_f32 v70, v74, v16
  v_mul_f32 v71, v75, v16
  s_waitcnt vmcnt(6)
  v_lshlrev_b32 v72, 16, v36
  v_and_b32 v73, 0xffff0000, v36
  v_fmac_f32 v64, v72, v17
  v_fmac_f32 v65, v73, v17
  v_lshlrev_b32 v74, 16, v37
  v_and_b32 v75, 0xffff0000, v37
  v_fmac_f32 v66, v74, v17
  v_fmac_f32 v67, v75, v17
  v_lshlrev_b32 v72, 16, v38
  v_and_b32 v73, 0xffff0000, v38
  v_fmac_f32 v68, v72, v17
  v_fmac_f32 v69, v73, v17
  v_lshlrev_b32 v74, 16, v39
  v_and_b32 v75, 0xffff0000, v39
  v_fmac_f32 v70, v74, v17
  v_fmac_f32 v71, v75, v17
  s_waitcnt vmcnt(5)
  v_lshlrev_b32 v72, 16, v40
  v_and_b32 v73, 0xffff0000, v40
  v_fmac_f32 v64, v72, v18
  v_fmac_f32 v65, v73, v18
  v_lshlrev_b32 v74, 16, v41
  v_and_b32 v75, 0xffff0000, v41
  v_fmac_f32 v66, v74, v18
  v_fmac_f32 v67, v75, v18
  v_lshlrev_b32 v72, 16, v42
  v_and_b32 v73, 0xffff0000, v42
  v_fmac_f32 v68, v72, v18
  v_fmac_f32 v69, v73, v18
  v_lshlrev_b32 v74, 16, v43
  v_and_b32 v75, 0xffff0000, v43
  v_fmac_f32 v70, v74, v18
  v_fmac_f32 v71, v75, v18
  s_waitcnt vmcnt(4)
  v_lshlrev_b32 v72, 16, v44
  v_and_b32 v73, 0xffff0000, v44
  v_fmac_f32 v64, v72, v19
  v_fmac_f32 v65, v73, v19
  v_lshlrev_b32 v74, 16, v45
  v_and_b32 v75, 0xffff0000, v45
  v_fmac_f32 v66, v74, v19
  v_fmac_f32 v67, v75, v19
  v_lshlrev_b32 v72, 16, v46
  v_and_b32 v73, 0xffff0000, v46
  v_fmac_f32 v68, v72, v19
  v_fmac_f32 v69, v73, v19
  v_lshlrev_b32 v74, 16, v47
  v_and_b32 v75, 0xffff0000, v47
  v_fmac_f32 v70, v74, v19
  v_fmac_f32 v71, v75, v19
  s_waitcnt vmcnt(3)
  v_lshlrev_b32 v72, 16, v48
  v_and_b32 v73, 0xffff0000, v48
  v_fmac_f32 v64, v72, v20
  v_fmac_f32 v65, v73, v20
  v_lshlrev_b32 v74, 16, v49
  v_and_b32 v75, 0xffff0000, v49
  v_fmac_f32 v66, v74, v20
  v_fmac_f32 v67, v75, v20
  v_lshlrev_b32 v72, 16, v50
  v_and_b32 v73, 0xffff0000, v50
  v_fmac_f32 v68, v72, v20
  v_fmac_f32 v69, v73, v20
  v_lshlrev_b32 v74, 16, v51
  v_and_b32 v75, 0xffff0000, v51
  v_fmac_f32 v70, v74, v20
  v_fmac_f32 v71, v75, v20
  s_waitcnt vmcnt(2)
  v_lshlrev_b32 v72, 16, v52
  v_and_b32 v73, 0xffff0000, v52
  v_fmac_f32 v64, v72, v21
  v_fmac_f32 v65, v73, v21
  v_lshlrev_b32 v74, 16, v53
  v_and_b32 v75, 0xffff0000, v53
  v_fmac_f32 v66, v74, v21
  v_fmac_f32 v67, v75, v21
  v_lshlrev_b32 v72, 16, v54
  v_and_b32 v73, 0xffff0000, v54
  v_fmac_f32 v68, v72, v21
  v_fmac_f32 v69, v73, v21
  v_lshlrev_b32 v74, 16, v55
  v_and_b32 v75, 0xffff0000, v55
  v_fmac_f32 v70, v74, v21
  v_fmac_f32 v71, v75, v21
  s_waitcnt vmcnt(1)
  v_lshlrev_b32 v72, 16, v56
  v_and_b32 v73, 0xffff0000, v56
  v_fmac_f32 v64, v72, v22
  v_fmac_f32 v65, v73, v22
  v_lshlrev_b32 v74, 16, v57
  v_and_b32 v75, 0xffff0000, v57
  v_fmac_f32 v66, v74, v22
  v_fmac_f32 v67, v75, v22
  v_lshlrev_b32 v72, 16, v58
  v_and_b32 v73, 0xffff0000, v58
  v_fmac_f32 v68, v72, v22
  v_fmac_f32 v69, v73, v22
  v_lshlrev_b32 v74, 16, v59
  v_and_b32 v75, 0xffff0000, v59
  v_fmac_f32 v70, v74, v22
  v_fmac_f32 v71, v75, v22
  v_lshlrev_b32 v76, 5, v143
  v_add_u32 v76, 139264, v76
  ds_write_b128 v76, v[64:67]
  ds_write_b128 v76, v[68:71] offset:16
  v_lshrrev_b32 v77, 5, v143
  v_lshlrev_b32 v78, 2, v215
  v_add_u32 v78, 139264, v78
  v_lshl_add_u32 v79, v77, 10, v78
  v_lshl_add_u32 v80, v77, 7, v78
  s_waitcnt lgkmcnt(0)
  s_barrier
  ds_read_b32 v64, v79 offset:0
  ds_read_b32 v65, v79 offset:128
  ds_read_b32 v66, v79 offset:256
  ds_read_b32 v67, v79 offset:384
  ds_read_b32 v68, v79 offset:512
  ds_read_b32 v69, v79 offset:640
  ds_read_b32 v70, v79 offset:768
  ds_read_b32 v71, v79 offset:896
  s_waitcnt lgkmcnt(0)
  v_add_f32 v64, v64, v68
  v_add_f32 v65, v65, v69
  v_add_f32 v66, v66, v70
  v_add_f32 v67, v67, v71
  v_add_f32 v64, v64, v66
  v_add_f32 v65, v65, v67
  v_add_f32 v64, v64, v65
  ds_write_b32 v80, v64 offset:8192
  s_waitcnt lgkmcnt(0)
  s_barrier
  ds_read_b32 v64, v78 offset:8192
  ds_read_b32 v65, v78 offset:8320
  ds_read_b32 v66, v78 offset:8448
  ds_read_b32 v67, v78 offset:8576
  ds_read_b32 v68, v78 offset:8704
  ds_read_b32 v69, v78 offset:8832
  ds_read_b32 v70, v78 offset:8960
  ds_read_b32 v71, v78 offset:9088
  s_waitcnt lgkmcnt(0)
  v_add_f32 v64, v64, v68
  v_add_f32 v65, v65, v69
  v_add_f32 v66, v66, v70
  v_add_f32 v67, v67, v71
  v_add_f32 v64, v64, v66
  v_add_f32 v65, v65, v67
  v_add_f32 v64, v64, v65
  v_cvt_pk_bf16_f32 v64, v64, v64
  v_and_b32 v64, 0xffff0000, v64
  s_sub_u32 s53, s52, 14
  s_cmp_lt_u32 s53, 14
  s_cbranch_scc1 K2_g1
  s_sub_u32 s53, s52, 56
  s_cmp_lt_u32 s53, 14
  s_cbranch_scc0 K2_g2
K2_g1:
  v_add_f32 v64, 1.0, v64
  v_cvt_pk_bf16_f32 v64, v64, v64
  v_and_b32 v64, 0xffff0000, v64
K2_g2:
  s_cmp_lt_u32 s52, 28
  s_cbranch_scc0 K2_g3
  v_mul_f32 v64, 0x3db8aa3b, v64
K2_g3:
  s_lshl_b32 s46, s52, 4
  s_add_u32 s46, s46, 8192
  s_cmp_lg_u32 s14, 0
  s_cbranch_scc1 K2_g8
  v_lshlrev_b32 v77, 2, v215
  s_lshl_b32 s53, s52, 7
  buffer_store_dword v64, v77, s[32:35], s53 offen sc1
K2_g8:
  s_branch K2_g9
K2_ln1:
  s_mul_i32 s46, s52, 14336
  s_add_u32 s36, s10, 0x40000
  s_addc_u32 s37, s11, 0
  s_add_u32 s36, s36, s46
  s_addc_u32 s37, s37, 0
  s_and_b32 s37, s37, 0xffff
  s_mov_b32 s38, 0x3800
  s_mov_b32 s39, 0x20000
  v_lshl_add_u32 v48, v209, 2, v211
  v_lshlrev_b32 v49, 7, v210
  v_add_u32 v49, 139264, v49
  v_lshl_add_u32 v48, v48, 3, v49
  v_lshlrev_b32 v50, 4, v208
  v_lshl_add_u32 v50, v209, 10, v50
  s_waitcnt vmcnt(1)
  v_lshlrev_b32 v16, 16, v0
  v_and_b32 v17, 0xffff0000, v0
  v_lshlrev_b32 v18, 16, v1
  v_and_b32 v19, 0xffff0000, v1
  v_lshlrev_b32 v20, 16, v2
  v_and_b32 v21, 0xffff0000, v2
  v_lshlrev_b32 v22, 16, v3
  v_and_b32 v23, 0xffff0000, v3
  v_lshlrev_b32 v24, 16, v4
  v_and_b32 v25, 0xffff0000, v4
  v_lshlrev_b32 v26, 16, v5
  v_and_b32 v27, 0xffff0000, v5
  v_lshlrev_b32 v28, 16, v6
  v_and_b32 v29, 0xffff0000, v6
  v_lshlrev_b32 v30, 16, v7
  v_and_b32 v31, 0xffff0000, v7
  v_lshlrev_b32 v32, 16, v8
  v_and_b32 v33, 0xffff0000, v8
  v_lshlrev_b32 v34, 16, v9
  v_and_b32 v35, 0xffff0000, v9
  v_lshlrev_b32 v36, 16, v10
  v_and_b32 v37, 0xffff0000, v10
  v_lshlrev_b32 v38, 16, v11
  v_and_b32 v39, 0xffff0000, v11
  v_lshlrev_b32 v40, 16, v12
  v_and_b32 v41, 0xffff0000, v12
  v_lshlrev_b32 v42, 16, v13
  v_and_b32 v43, 0xffff0000, v13
  v_lshlrev_b32 v44, 16, v14
  v_and_b32 v45, 0xffff0000, v14
  v_lshlrev_b32 v46, 16, v15
  v_and_b32 v47, 0xffff0000, v15
  v_add_f32 v52, v16, v17
  v_mul_f32 v53, v16, v16
  v_add_f32 v54, v18, v19
  v_mul_f32 v55, v18, v18
  v_fmac_f32 v53, v17, v17
  v_fmac_f32 v55, v19, v19
  v_add_f32 v52, v52, v20
  v_fmac_f32 v53, v20, v20
  v_add_f32 v54, v54, v21
  v_fmac_f32 v55, v21, v21
  v_add_f32 v52, v52, v22
  v_fmac_f32 v53, v22, v22
  v_add_f32 v54, v54, v23
  v_fmac_f32 v55, v23, v23
  v_add_f32 v52, v52, v24
  v_fmac_f32 v53, v24, v24
  v_add_f32 v54, v54, v25
  v_fmac_f32 v55, v25, v25
  v_add_f32 v52, v52, v26
  v_fmac_f32 v53, v26, v26
  v_add_f32 v54, v54, v27
  v_fmac_f32 v55, v27, v27
  v_add_f32 v52, v52, v28
  v_fmac_f32 v53, v28, v28
  v_add_f32 v54, v54, v29
  v_fmac_f32 v55, v29, v29
  v_add_f32 v52, v52, v30
  v_fmac_f32 v53, v30, v30
  v_add_f32 v54, v54, v31
  v_fmac_f32 v55, v31, v31
  v_add_f32 v52, v52, v32
  v_fmac_f32 v53, v32, v32
  v_add_f32 v54, v54, v33
  v_fmac_f32 v55, v33, v33
  v_add_f32 v52, v52, v34
  v_fmac_f32 v53, v34, v34
  v_add_f32 v54, v54, v35
  v_fmac_f32 v55, v35, v35
  v_add_f32 v52, v52, v36
  v_fmac_f32 v53, v36, v36
  v_add_f32 v54, v54, v37
  v_fmac_f32 v55, v37, v37
  v_add_f32 v52, v52, v38
  v_fmac_f32 v53, v38, v38
  v_add_f32 v54, v54, v39
  v_fmac_f32 v55, v39, v39
  v_add_f32 v52, v52, v40
  v_fmac_f32 v53, v40, v40
  v_add_f32 v54, v54, v41
  v_fmac_f32 v55, v41, v41
  v_add_f32 v52, v52, v42
  v_fmac_f32 v53, v42, v42
  v_add_f32 v54, v54, v43
  v_fmac_f32 v55, v43, v43
  v_add_f32 v52, v52, v44
  v_fmac_f32 v53, v44, v44
  v_add_f32 v54, v54, v45
  v_fmac_f32 v55, v45, v45
  v_add_f32 v52, v52, v46
  v_fmac_f32 v53, v46, v46
  v_add_f32 v54, v54, v47
  v_fmac_f32 v55, v47, v47
  v_add_f32 v52, v52, v54
  v_add_f32 v53, v53, v55
  ds_write_b64 v48, v[52:53]
  s_waitcnt lgkmcnt(0)
  s_barrier
  ds_read_b128 v[56:59], v49 offset:0
  ds_read_b128 v[60:63], v49 offset:16
  ds_read_b128 v[64:67], v49 offset:32
  ds_read_b128 v[68:71], v49 offset:48
  ds_read_b128 v[72:75], v49 offset:64
  ds_read_b128 v[76:79], v49 offset:80
  ds_read_b128 v[80:83], v49 offset:96
  ds_read_b128 v[84:87], v49 offset:112
  s_waitcnt lgkmcnt(0)
  v_add_f32 v56, v56, v72
  v_add_f32 v57, v57, v73
  v_add_f32 v58, v58, v74
  v_add_f32 v59, v59, v75
  v_add_f32 v60, v60, v76
  v_add_f32 v61, v61, v77
  v_add_f32 v62, v62, v78
  v_add_f32 v63, v63, v79
  v_add_f32 v64, v64, v80
  v_add_f32 v65, v65, v81
  v_add_f32 v66, v66, v82
  v_add_f32 v67, v67, v83
  v_add_f32 v68, v68, v84
  v_add_f32 v69, v69, v85
  v_add_f32 v70, v70, v86
  v_add_f32 v71, v71, v87
  v_add_f32 v56, v56, v64
  v_add_f32 v57, v57, v65
  v_add_f32 v58, v58, v66
  v_add_f32 v59, v59, v67
  v_add_f32 v60, v60, v68
  v_add_f32 v61, v61, v69
  v_add_f32 v62, v62, v70
  v_add_f32 v63, v63, v71
  v_add_f32 v56, v56, v60
  v_add_f32 v57, v57, v61
  v_add_f32 v58, v58, v62
  v_add_f32 v59, v59, v63
  v_add_f32 v56, v56, v58
  v_add_f32 v57, v57, v59
  v_mul_f32 v56, 0x3b124925, v56
  v_mul_f32 v57, 0x3b124925, v57
  v_fma_f32 v57, -v56, v56, v57
  v_max_f32 v57, 0, v57
  v_cvt_pk_bf16_f32 v57, v57, v57
  v_and_b32 v57, 0xffff0000, v57
  v_add_f32 v57, 0x3727c5ac, v57
  v_cvt_pk_bf16_f32 v57, v57, v57
  v_and_b32 v57, 0xffff0000, v57
  v_sqrt_f32 v57, v57
  v_cvt_pk_bf16_f32 v56, v56, v56
  v_and_b32 v56, 0xffff0000, v56
  v_cvt_pk_bf16_f32 v57, v57, v57
  v_and_b32 v57, 0xffff0000, v57
  v_rcp_f32 v57, v57
  v_sub_f32 v16, v16, v56
  v_sub_f32 v17, v17, v56
  v_sub_f32 v18, v18, v56
  v_sub_f32 v19, v19, v56
  v_sub_f32 v20, v20, v56
  v_sub_f32 v21, v21, v56
  v_sub_f32 v22, v22, v56
  v_sub_f32 v23, v23, v56
  v_sub_f32 v24, v24, v56
  v_sub_f32 v25, v25, v56
  v_sub_f32 v26, v26, v56
  v_sub_f32 v27, v27, v56
  v_sub_f32 v28, v28, v56
  v_sub_f32 v29, v29, v56
  v_sub_f32 v30, v30, v56
  v_sub_f32 v31, v31, v56
  v_sub_f32 v32, v32, v56
  v_sub_f32 v33, v33, v56
  v_sub_f32 v34, v34, v56
  v_sub_f32 v35, v35, v56
  v_sub_f32 v36, v36, v56
  v_sub_f32 v37, v37, v56
  v_sub_f32 v38, v38, v56
  v_sub_f32 v39, v39, v56
  v_sub_f32 v40, v40, v56
  v_sub_f32 v41, v41, v56
  v_sub_f32 v42, v42, v56
  v_sub_f32 v43, v43, v56
  v_sub_f32 v44, v44, v56
  v_sub_f32 v45, v45, v56
  v_sub_f32 v46, v46, v56
  v_sub_f32 v47, v47, v56
  v_cvt_pk_bf16_f32 v0, v16, v17
  v_cvt_pk_bf16_f32 v1, v18, v19
  v_cvt_pk_bf16_f32 v2, v20, v21
  v_cvt_pk_bf16_f32 v3, v22, v23
  v_cvt_pk_bf16_f32 v4, v24, v25
  v_cvt_pk_bf16_f32 v5, v26, v27
  v_cvt_pk_bf16_f32 v6, v28, v29
  v_cvt_pk_bf16_f32 v7, v30, v31
  v_cvt_pk_bf16_f32 v8, v32, v33
  v_cvt_pk_bf16_f32 v9, v34, v35
  v_cvt_pk_bf16_f32 v10, v36, v37
  v_cvt_pk_bf16_f32 v11, v38, v39
  v_cvt_pk_bf16_f32 v12, v40, v41
  v_cvt_pk_bf16_f32 v13, v42, v43
  v_cvt_pk_bf16_f32 v14, v44, v45
  v_cvt_pk_bf16_f32 v15, v46, v47
  v_lshlrev_b32 v16, 16, v0
  v_and_b32 v17, 0xffff0000, v0
  v_lshlrev_b32 v18, 16, v1
  v_and_b32 v19, 0xffff0000, v1
  v_lshlrev_b32 v20, 16, v2
  v_and_b32 v21, 0xffff0000, v2
  v_lshlrev_b32 v22, 16, v3
  v_and_b32 v23, 0xffff0000, v3
  v_lshlrev_b32 v24, 16, v4
  v_and_b32 v25, 0xffff0000, v4
  v_lshlrev_b32 v26, 16, v5
  v_and_b32 v27, 0xffff0000, v5
  v_lshlrev_b32 v28, 16, v6
  v_and_b32 v29, 0xffff0000, v6
  v_lshlrev_b32 v30, 16, v7
  v_and_b32 v31, 0xffff0000, v7
  v_lshlrev_b32 v32, 16, v8
  v_and_b32 v33, 0xffff0000, v8
  v_lshlrev_b32 v34, 16, v9
  v_and_b32 v35, 0xffff0000, v9
  v_lshlrev_b32 v36, 16, v10
  v_and_b32 v37, 0xffff0000, v10
  v_lshlrev_b32 v38, 16, v11
  v_and_b32 v39, 0xffff0000, v11
  v_lshlrev_b32 v40, 16, v12
  v_and_b32 v41, 0xffff0000, v12
  v_lshlrev_b32 v42, 16, v13
  v_and_b32 v43, 0xffff0000, v13
  v_lshlrev_b32 v44, 16, v14
  v_and_b32 v45, 0xffff0000, v14
  v_lshlrev_b32 v46, 16, v15
  v_and_b32 v47, 0xffff0000, v15
  v_mul_f32 v16, v16, v57
  v_mul_f32 v17, v17, v57
  v_mul_f32 v18, v18, v57
  v_mul_f32 v19, v19, v57
  v_mul_f32 v20, v20, v57
  v_mul_f32 v21, v21, v57
  v_mul_f32 v22, v22, v57
  v_mul_f32 v23, v23, v57
  v_mul_f32 v24, v24, v57
  v_mul_f32 v25, v25, v57
  v_mul_f32 v26, v26, v57
  v_mul_f32 v27, v27, v57
  v_mul_f32 v28, v28, v57
  v_mul_f32 v29, v29, v57
  v_mul_f32 v30, v30, v57
  v_mul_f32 v31, v31, v57
  v_mul_f32 v32, v32, v57
  v_mul_f32 v33, v33, v57
  v_mul_f32 v34, v34, v57
  v_mul_f32 v35, v35, v57
  v_mul_f32 v36, v36, v57
  v_mul_f32 v37, v37, v57
  v_mul_f32 v38, v38, v57
  v_mul_f32 v39, v39, v57
  v_mul_f32 v40, v40, v57
  v_mul_f32 v41, v41, v57
  v_mul_f32 v42, v42, v57
  v_mul_f32 v43, v43, v57
  v_mul_f32 v44, v44, v57
  v_mul_f32 v45, v45, v57
  v_mul_f32 v46, v46, v57
  v_mul_f32 v47, v47, v57
  v_cvt_pk_bf16_f32 v0, v16, v17
  v_cvt_pk_bf16_f32 v1, v18, v19
  v_cvt_pk_bf16_f32 v2, v20, v21
  v_cvt_pk_bf16_f32 v3, v22, v23
  v_cvt_pk_bf16_f32 v4, v24, v25
  v_cvt_pk_bf16_f32 v5, v26, v27
  v_cvt_pk_bf16_f32 v6, v28, v29
  v_cvt_pk_bf16_f32 v7, v30, v31
  v_cvt_pk_bf16_f32 v8, v32, v33
  v_cvt_pk_bf16_f32 v9, v34, v35
  v_cvt_pk_bf16_f32 v10, v36, v37
  v_cvt_pk_bf16_f32 v11, v38, v39
  v_cvt_pk_bf16_f32 v12, v40, v41
  v_cvt_pk_bf16_f32 v13, v42, v43
  v_cvt_pk_bf16_f32 v14, v44, v45
  v_cvt_pk_bf16_f32 v15, v46, v47
  s_mov_b32 s53, 0
  buffer_store_dwordx4 v[0:3], v50, s[36:39], s53 offen sc1
  s_mov_b32 s53, 4096
  buffer_store_dwordx4 v[4:7], v50, s[36:39], s53 offen sc1
  s_mov_b32 s53, 8192
  buffer_store_dwordx4 v[8:11], v50, s[36:39], s53 offen sc1
  s_mov_b32 s53, 12288
  buffer_store_dwordx4 v[12:15], v50, s[36:39], s53 offen sc1
  s_waitcnt vmcnt(0)
  s_barrier
  s_lshl_b32 s46, s13, 7
  s_and_b32 s53, s2, 7
  s_lshl_b32 s53, s53, 2
  s_add_u32 s46, s46, s53
  s_add_u32 s46, s46, 10240
K2_g9:
  s_mov_b32 s45, 0x8000
  s_waitcnt vmcnt(0)
K2_o_pl:
  v_readfirstlane_b32 s75, v119
  s_nop 3
  s_cmp_lg_u32 s75, 0
  s_cbranch_scc1 K2_o_pd
  buffer_load_dword v119, v118, s[28:31], 0 offen sc1
  s_waitcnt vmcnt(0)
  s_sub_u32 s45, s45, 1
  s_cmp_lg_u32 s45, 0
  s_cbranch_scc1 K2_o_pl
K2_o_pd:
  s_cmp_eq_u32 s47, 0
  s_cbranch_scc1 K2_p9
  s_cmp_lg_u32 s14, 0
  s_cbranch_scc1 K2_p9
  s_mov_b64 exec, 1
  buffer_store_dword v119, v118, s[16:19], s46 offen sc1
  s_mov_b64 exec, -1
K2_p9:
  s_add_u32 m0, s40, 0x8000
  s_mov_b32 s44, 0x0
  buffer_load_dwordx4 v128, s[24:27], s44 offen offset:0 nt lds
  buffer_load_dwordx4 v129, s[24:27], s44 offen offset:1024 nt lds
  buffer_load_dwordx4 v130, s[24:27], s44 offen offset:2048 nt lds
  buffer_load_dwordx4 v131, s[24:27], s44 offen offset:3072 nt lds
  s_add_u32 m0, s40, 0x10000
  s_mov_b32 s44, 0x40000
  buffer_load_dwordx4 v128, s[24:27], s44 offen offset:0 nt lds
  buffer_load_dwordx4 v129, s[24:27], s44 offen offset:1024 nt lds
  buffer_load_dwordx4 v130, s[24:27], s44 offen offset:2048 nt lds
  buffer_load_dwordx4 v131, s[24:27], s44 offen offset:3072 nt lds
  s_add_u32 m0, s40, 0xc000
  s_mov_b32 s44, 0x80000
  buffer_load_dwordx4 v128, s[24:27], s44 offen offset:0 nt lds
  buffer_load_dwordx4 v129, s[24:27], s44 offen offset:1024 nt lds
  buffer_load_dwordx4 v130, s[24:27], s44 offen offset:2048 nt lds
  buffer_load_dwordx4 v131, s[24:27], s44 offen offset:3072 nt lds
  s_add_u32 m0, s40, 0x14000
  s_mov_b32 s44, 0xc0000
  buffer_load_dwordx4 v128, s[24:27], s44 offen offset:0 nt lds
  buffer_load_dwordx4 v129, s[24:27], s44 offen offset:1024 nt lds
  buffer_load_dwordx4 v130, s[24:27], s44 offen offset:2048 nt lds
  buffer_load_dwordx4 v131, s[24:27], s44 offen offset:3072 nt lds
  s_add_u32 m0, s40, 0x18000
  s_mov_b32 s44, 0x100000
  buffer_load_dwordx4 v128, s[24:27], s44 offen offset:0 nt lds
  buffer_load_dwordx4 v129, s[24:27], s44 offen offset:1024 nt lds
  buffer_load_dwordx4 v130, s[24:27], s44 offen offset:2048 nt lds
  buffer_load_dwordx4 v131, s[24:27], s44 offen offset:3072 nt lds
  v_lshl_add_u32 v112, v209, 3, v214
  v_add_u32 v113, 0, v112
  v_and_b32 v117, 7, v113
  v_lshlrev_b32 v117, 1, v117
  v_xor_b32 v117, v117, v215
  v_lshlrev_b32 v117, 4, v117
  v_lshl_add_u32 v186, v112, 9, v117
  v_and_b32 v117, 15, v113
  v_xor_b32 v117, v117, v215
  v_lshlrev_b32 v117, 4, v117
  v_lshl_add_u32 v182, v112, 9, v117
  v_lshl_add_u32 v112, v209, 3, v214
  v_add_u32 v113, 2, v112
  v_and_b32 v117, 7, v113
  v_lshlrev_b32 v117, 1, v117
  v_xor_b32 v117, v117, v215
  v_lshlrev_b32 v117, 4, v117
  v_lshl_add_u32 v187, v112, 9, v117
  v_and_b32 v117, 15, v113
  v_xor_b32 v117, v117, v215
  v_lshlrev_b32 v117, 4, v117
  v_lshl_add_u32 v183, v112, 9, v117
  v_lshl_add_u32 v112, v209, 3, v214
  v_add_u32 v113, 4, v112
  v_and_b32 v117, 7, v113
  v_lshlrev_b32 v117, 1, v117
  v_xor_b32 v117, v117, v215
  v_lshlrev_b32 v117, 4, v117
  v_lshl_add_u32 v188, v112, 9, v117
  v_and_b32 v117, 15, v113
  v_xor_b32 v117, v117, v215
  v_lshlrev_b32 v117, 4, v117
  v_lshl_add_u32 v184, v112, 9, v117
  v_lshl_add_u32 v112, v209, 3, v214
  v_add_u32 v113, 6, v112
  v_and_b32 v117, 7, v113
  v_lshlrev_b32 v117, 1, v117
  v_xor_b32 v117, v117, v215
  v_lshlrev_b32 v117, 4, v117
  v_lshl_add_u32 v189, v112, 9, v117
  v_and_b32 v117, 15, v113
  v_xor_b32 v117, v117, v215
  v_lshlrev_b32 v117, 4, v117
  v_lshl_add_u32 v185, v112, 9, v117
  v_add_u32 v112, 0, v211
  v_xor_b32 v112, v112, v210
  v_lshlrev_b32 v112, 4, v112
  v_lshl_add_u32 v170, v210, 9, v112
  v_add_u32 v112, 4, v211
  v_xor_b32 v112, v112, v210
  v_lshlrev_b32 v112, 4, v112
  v_lshl_add_u32 v171, v210, 9, v112
  v_add_u32 v112, 8, v211
  v_xor_b32 v112, v112, v210
  v_lshlrev_b32 v112, 4, v112
  v_lshl_add_u32 v172, v210, 9, v112
  v_add_u32 v112, 12, v211
  v_xor_b32 v112, v112, v210
  v_lshlrev_b32 v112, 4, v112
  v_lshl_add_u32 v173, v210, 9, v112
  v_lshl_add_u32 v113, v211, 2, v212
  v_lshlrev_b32 v117, 3, v213
  v_lshl_add_u32 v117, v113, 9, v117
  v_add_u32 v117, 65536, v117
  v_and_b32 v113, 7, v113
  v_xor_b32 v112, 0, v113
  v_lshl_add_u32 v174, v112, 5, v117
  v_xor_b32 v112, 1, v113
  v_lshl_add_u32 v175, v112, 5, v117
  v_xor_b32 v112, 2, v113
  v_lshl_add_u32 v176, v112, 5, v117
  v_xor_b32 v112, 3, v113
  v_lshl_add_u32 v177, v112, 5, v117
  v_xor_b32 v112, 4, v113
  v_lshl_add_u32 v178, v112, 5, v117
  v_xor_b32 v112, 5, v113
  v_lshl_add_u32 v179, v112, 5, v117
  v_xor_b32 v112, 6, v113
  v_lshl_add_u32 v180, v112, 5, v117
  v_xor_b32 v112, 7, v113
  v_lshl_add_u32 v181, v112, 5, v117
  v_lshl_add_u32 v113, v211, 3, v212
  v_lshlrev_b32 v117, 3, v213
  v_lshl_add_u32 v117, v113, 9, v117
  v_and_b32 v113, 1, v211
  v_lshl_add_u32 v113, v113, 2, v212
  v_xor_b32 v112, 0, v113
  v_lshl_add_u32 v132, v112, 5, v117
  v_add_u32 v200, 65536, v132
  v_xor_b32 v112, 1, v113
  v_lshl_add_u32 v133, v112, 5, v117
  v_add_u32 v201, 65536, v133
  v_xor_b32 v112, 2, v113
  v_lshl_add_u32 v134, v112, 5, v117
  v_add_u32 v202, 65536, v134
  v_xor_b32 v112, 3, v113
  v_lshl_add_u32 v135, v112, 5, v117
  v_add_u32 v203, 65536, v135
  v_xor_b32 v112, 4, v113
  v_lshl_add_u32 v136, v112, 5, v117
  v_add_u32 v204, 65536, v136
  v_xor_b32 v112, 5, v113
  v_lshl_add_u32 v137, v112, 5, v117
  v_add_u32 v205, 65536, v137
  v_xor_b32 v112, 6, v113
  v_lshl_add_u32 v138, v112, 5, v117
  v_add_u32 v206, 65536, v138
  v_xor_b32 v112, 7, v113
  v_lshl_add_u32 v139, v112, 5, v117
  v_add_u32 v207, 65536, v139
  v_lshlrev_b32 v140, 5, v211
  v_add_u32 v140, 131072, v140
  v_lshlrev_b32 v112, 18, v209
  v_lshl_add_u32 v190, v208, 4, v112
  v_add_u32 v191, 131072, v190
  v_mul_u32_u24 v112, 28672, v209
  v_lshl_add_u32 v141, v208, 4, v112
  v_add_u32 v142, 14336, v141
  s_waitcnt lgkmcnt(0)
  s_mov_b32 s43, 0
  s_mov_b32 s46, 4096
  s_mov_b32 s20, s6
  s_mov_b32 s21, s7
  s_add_u32 s20, s20, s50
  s_addc_u32 s21, s21, 0
  s_and_b32 s21, s21, 0xffff
  s_mov_b32 s22, 0x100000
  s_mov_b32 s23, 0x20000
  s_add_u32 s36, s10, 0x1000000
  s_addc_u32 s37, s11, 0
  s_add_u32 s36, s36, s48
  s_addc_u32 s37, s37, 0
  s_and_b32 s37, s37, 0xffff
  s_mov_b32 s38, 0x0
  s_mov_b32 s39, 0x20000
  s_sub_u32 s38, 1048576, s49
  s_lshl_b32 s52, s2, 2
  s_add_u32 s52, s52, s14
  s_mov_b32 s56, s60
  s_mov_b32 s57, s61
  s_sub_u32 s53, s52, 392
  s_cmp_ge_u32 s52, 392
  s_cbranch_scc1 K2_pf
  s_mov_b32 s56, s54
  s_mov_b32 s57, s55
  s_mov_b32 s53, s52
  s_cmp_lt_u32 s52, 196
  s_cbranch_scc1 K2_pf
  s_mov_b32 s56, s62
  s_mov_b32 s57, s63
  s_sub_u32 s53, s52, 196
K2_pf:
  s_lshl_b32 s53, s53, 13
  s_add_u32 s56, s56, s53
  s_addc_u32 s57, s57, 0
  s_lshl_b32 s53, s14, 18
  s_sub_u32 s56, s56, s53
  s_subb_u32 s57, s57, 0
  s_and_b32 s57, s57, 0xffff
  s_mov_b32 s59, 0x20000
  s_add_u32 s53, s53, 8192
  s_cmp_lt_u32 s52, 840
  s_cselect_b32 s58, s53, 0
  s_mov_b32 s53, 0xfffffc00
  s_lshl_b32 s71, s14, 15
  s_cmp_eq_u32 s14, 3
  s_cselect_b32 s71, 0x20000, s71
  s_lshr_b32 s47, s2, 3
  s_lshl_b32 s47, s47, 2
  s_add_u32 s47, s47, s14
  s_mul_i32 s47, s47, 28672
  s_add_u32 s76, s60, s47
  s_addc_u32 s77, s61, 0
  s_lshl_b32 s47, s14, 18
  s_sub_u32 s76, s76, s47
  s_subb_u32 s77, s77, 0
  s_and_b32 s77, s77, 0xffff
  s_add_u32 s78, s47, 28672
  s_mov_b32 s79, 0x20000
  s_mul_i32 s47, s13, 114688
  s_add_u32 s28, s10, 0x40000
  s_addc_u32 s29, s11, 0
  s_add_u32 s28, s28, s47
  s_addc_u32 s29, s29, 0
  s_and_b32 s29, s29, 0xffff
  s_mov_b32 s30, 0x1c000
  s_mov_b32 s31, 0x20000
  s_mov_b32 s47, 31744
  v_lshlrev_b32 v0, 4, v208
  v_add_u32 v0, 8192, v0
  s_lshl_b32 s44, s13, 7
  s_add_u32 s44, s44, 10128
  v_lshlrev_b32 v1, 2, v208
  v_add_u32 v1, s44, v1
  v_cmp_gt_u32 vcc, 28, v208
  s_nop 1
  v_cndmask_b32 v0, v1, v0, vcc
  v_lshlrev_b32 v2, 4, v143
  v_add_u32 v3, 131072, v2
  s_mov_b32 s44, 0x8000
  s_cmp_lg_u32 s14, 0
  s_cbranch_scc1 K2_m_pd
K2_m_pl:
  buffer_load_dword v1, v0, s[16:19], 0 offen sc1
  s_waitcnt vmcnt(0)
  v_cmp_eq_u32 vcc, s75, v1
  s_nop 1
  s_and_b32 vcc_hi, vcc_hi, 15
  s_bcnt1_i32_b64 s73, vcc
  s_cmp_eq_u32 s73, 36
  s_cbranch_scc1 K2_m_pd
  s_sleep 2
  s_sub_u32 s44, s44, 1
  s_cmp_lg_u32 s44, 0
  s_cbranch_scc1 K2_m_pl
K2_m_pd:
  s_waitcnt vmcnt(0)
  s_barrier
  buffer_load_dwordx4 v[4:7], v2, s[32:35], 0 offen sc1
  s_mov_b32 s45, 0
  buffer_load_dwordx4 v[216:219], v141, s[28:31], s45 offen sc1
  buffer_load_dwordx4 v[220:223], v142, s[28:31], s45 offen sc1
  s_mov_b32 s45, 1024
  buffer_load_dwordx4 v[224:227], v141, s[28:31], s45 offen sc1
  buffer_load_dwordx4 v[228:231], v142, s[28:31], s45 offen sc1
  s_mov_b32 s45, 2048
  buffer_load_dwordx4 v[232:235], v141, s[28:31], s45 offen sc1
  buffer_load_dwordx4 v[236:239], v142, s[28:31], s45 offen sc1
  s_mov_b32 s16, s4
  s_mov_b32 s17, s5
  s_add_u32 s16, s16, s50
  s_addc_u32 s17, s17, 0
  s_and_b32 s17, s17, 0xffff
  s_mov_b32 s18, 0x100000
  s_mov_b32 s19, 0x20000
  s_waitcnt vmcnt(6)
  ds_write_b128 v3, v[4:7]
  s_waitcnt lgkmcnt(0)
  s_barrier
  ds_read_b128 v[144:147], v140 offset:1792
  ds_read_b128 v[148:151], v140 offset:1808
  ds_read_b128 v[152:155], v140 offset:0
  ds_read_b128 v[156:159], v140 offset:16
  ds_read_b64_tr_b16 a[64:65], v132 offset:32768
  ds_read_b64_tr_b16 a[66:67], v132 offset:34816
  ds_read_b64_tr_b16 a[68:69], v133 offset:32768
  ds_read_b64_tr_b16 a[70:71], v133 offset:34816
  ds_read_b64_tr_b16 a[72:73], v134 offset:32768
  ds_read_b64_tr_b16 a[74:75], v134 offset:34816
  ds_read_b64_tr_b16 a[76:77], v135 offset:32768
  ds_read_b64_tr_b16 a[78:79], v135 offset:34816
  ds_read_b64_tr_b16 a[80:81], v136 offset:32768
  ds_read_b64_tr_b16 a[82:83], v136 offset:34816
  ds_read_b64_tr_b16 a[84:85], v137 offset:32768
  ds_read_b64_tr_b16 a[86:87], v137 offset:34816
  ds_read_b64_tr_b16 a[88:89], v138 offset:32768
  ds_read_b64_tr_b16 a[90:91], v138 offset:34816
  ds_read_b64_tr_b16 a[92:93], v139 offset:32768
  ds_read_b64_tr_b16 a[94:95], v139 offset:34816
  ds_read_b64_tr_b16 a[96:97], v132 offset:33024
  ds_read_b64_tr_b16 a[98:99], v132 offset:35072
  ds_read_b64_tr_b16 a[100:101], v133 offset:33024
  ds_read_b64_tr_b16 a[102:103], v133 offset:35072
  ds_read_b64_tr_b16 a[104:105], v134 offset:33024
  ds_read_b64_tr_b16 a[106:107], v134 offset:35072
  ds_read_b64_tr_b16 a[108:109], v135 offset:33024
  ds_read_b64_tr_b16 a[110:111], v135 offset:35072
  ds_read_b64_tr_b16 a[112:113], v136 offset:33024
  ds_read_b64_tr_b16 a[114:115], v136 offset:35072
  ds_read_b64_tr_b16 a[116:117], v137 offset:33024
  ds_read_b64_tr_b16 a[118:119], v137 offset:35072
  ds_read_b64_tr_b16 a[120:121], v138 offset:33024
  ds_read_b64_tr_b16 a[122:123], v138 offset:35072
  ds_read_b64_tr_b16 a[124:125], v139 offset:33024
  ds_read_b64_tr_b16 a[126:127], v139 offset:35072
  s_waitcnt vmcnt(4) lgkmcnt(15)
  v_lshlrev_b32 v208, 16, v216
  v_and_b32 v209, 0xffff0000, v216
  v_fma_f32 v208, v208, v144, v152
  v_fma_f32 v209, v209, v145, v153
  v_cvt_pk_bf16_f32 v192, v208, v209
  v_lshlrev_b32 v210, 16, v217
  v_and_b32 v211, 0xffff0000, v217
  v_fma_f32 v210, v210, v146, v154
  v_fma_f32 v211, v211, v147, v155
  v_cvt_pk_bf16_f32 v193, v210, v211
  v_lshlrev_b32 v212, 16, v218
  v_and_b32 v213, 0xffff0000, v218
  v_fma_f32 v212, v212, v148, v156
  v_fma_f32 v213, v213, v149, v157
  v_cvt_pk_bf16_f32 v194, v212, v213
  v_lshlrev_b32 v214, 16, v219
  v_and_b32 v215, 0xffff0000, v219
  v_fma_f32 v214, v214, v150, v158
  v_fma_f32 v215, v215, v151, v159
  v_cvt_pk_bf16_f32 v195, v214, v215
  v_lshlrev_b32 v208, 16, v220
  v_and_b32 v209, 0xffff0000, v220
  v_fma_f32 v208, v208, v144, v152
  v_fma_f32 v209, v209, v145, v153
  v_cvt_pk_bf16_f32 v196, v208, v209
  v_lshlrev_b32 v210, 16, v221
  v_and_b32 v211, 0xffff0000, v221
  v_fma_f32 v210, v210, v146, v154
  v_fma_f32 v211, v211, v147, v155
  v_cvt_pk_bf16_f32 v197, v210, v211
  v_lshlrev_b32 v212, 16, v222
  v_and_b32 v213, 0xffff0000, v222
  v_fma_f32 v212, v212, v148, v156
  v_fma_f32 v213, v213, v149, v157
  v_cvt_pk_bf16_f32 v198, v212, v213
  v_lshlrev_b32 v214, 16, v223
  v_and_b32 v215, 0xffff0000, v223
  v_fma_f32 v214, v214, v150, v158
  v_fma_f32 v215, v215, v151, v159
  v_cvt_pk_bf16_f32 v199, v214, v215
  ds_read_b128 v[240:243], v140 offset:1920
  ds_read_b128 v[244:247], v140 offset:1936
  ds_read_b128 v[248:251], v140 offset:128
  ds_read_b128 v[252:255], v140 offset:144
  s_waitcnt lgkmcnt(0)
  v_mfma_f32_16x16x32_bf16 v[0:3], a[64:67], v[192:195], 0
  v_mfma_f32_16x16x32_bf16 v[4:7], a[64:67], v[196:199], 0
  s_waitcnt vmcnt(2)
  v_mfma_f32_16x16x32_bf16 v[8:11], a[68:71], v[192:195], 0
  ds_read_b64_tr_b16 a[64:65], v200 offset:0
  s_mov_b32 s45, 3072
  buffer_load_dwordx4 v[216:219], v141, s[28:31], s45 offen sc1
  v_lshlrev_b32 v208, 16, v224
  v_mfma_f32_16x16x32_bf16 v[12:15], a[68:71], v[196:199], 0
  ds_read_b64_tr_b16 a[66:67], v200 offset:2048
  ds_read_b128 v[144:147], v140 offset:2048
  v_and_b32 v209, 0xffff0000, v224
  v_mfma_f32_16x16x32_bf16 v[16:19], a[72:75], v[192:195], 0
  s_waitcnt lgkmcnt(8)
  ds_read_b64_tr_b16 a[68:69], v201 offset:0
  v_lshlrev_b32 v210, 16, v225
  v_mfma_f32_16x16x32_bf16 v[20:23], a[72:75], v[196:199], 0
  ds_read_b64_tr_b16 a[70:71], v201 offset:2048
  ds_read_b128 v[148:151], v140 offset:2064
  v_and_b32 v211, 0xffff0000, v225
  v_mfma_f32_16x16x32_bf16 v[24:27], a[76:79], v[192:195], 0
  ds_read_b64_tr_b16 a[72:73], v202 offset:0
  buffer_load_dwordx4 v[220:223], v142, s[28:31], s45 offen sc1
  v_fma_f32 v208, v208, v240, v248
  v_mfma_f32_16x16x32_bf16 v[28:31], a[76:79], v[196:199], 0
  ds_read_b64_tr_b16 a[74:75], v202 offset:2048
  ds_read_b128 v[152:155], v140 offset:256
  v_fma_f32 v209, v209, v241, v249
  v_mfma_f32_16x16x32_bf16 v[32:35], a[80:83], v[192:195], 0
  ds_read_b64_tr_b16 a[76:77], v203 offset:0
  v_lshlrev_b32 v212, 16, v226
  v_and_b32 v213, 0xffff0000, v226
  v_mfma_f32_16x16x32_bf16 v[36:39], a[80:83], v[196:199], 0
  s_add_u32 m0, s40, 0x1c000
  s_mov_b32 s44, 0x140000
  ds_read_b64_tr_b16 a[78:79], v203 offset:2048
  ds_read_b128 v[156:159], v140 offset:272
  v_fma_f32 v210, v210, v242, v250
  v_mfma_f32_16x16x32_bf16 v[40:43], a[84:87], v[192:195], 0
  ds_read_b64_tr_b16 a[80:81], v204 offset:0
  buffer_load_dwordx4 v128, s[24:27], s44 offen offset:0 nt lds
  v_fma_f32 v211, v211, v243, v251
  v_mfma_f32_16x16x32_bf16 v[44:47], a[84:87], v[196:199], 0
  ds_read_b64_tr_b16 a[82:83], v204 offset:2048
  v_cvt_pk_bf16_f32 v160, v208, v209
  v_lshlrev_b32 v214, 16, v227
  v_mfma_f32_16x16x32_bf16 v[48:51], a[88:91], v[192:195], 0
  s_waitcnt lgkmcnt(8)
  ds_read_b64_tr_b16 a[84:85], v205 offset:0
  v_and_b32 v215, 0xffff0000, v227
  v_mfma_f32_16x16x32_bf16 v[52:55], a[88:91], v[196:199], 0
  ds_read_b64_tr_b16 a[86:87], v205 offset:2048
  v_fma_f32 v212, v212, v244, v252
  v_fma_f32 v213, v213, v245, v253
  v_mfma_f32_16x16x32_bf16 v[56:59], a[92:95], v[192:195], 0
  ds_read_b64_tr_b16 a[88:89], v206 offset:0
  buffer_load_dwordx4 v129, s[24:27], s44 offen offset:1024 nt lds
  v_cvt_pk_bf16_f32 v161, v210, v211
  v_mfma_f32_16x16x32_bf16 v[60:63], a[92:95], v[196:199], 0
  ds_read_b64_tr_b16 a[90:91], v206 offset:2048
  v_lshlrev_b32 v208, 16, v228
  v_and_b32 v209, 0xffff0000, v228
  v_mfma_f32_16x16x32_bf16 v[64:67], a[96:99], v[192:195], 0
  ds_read_b64_tr_b16 a[92:93], v207 offset:0
  v_fma_f32 v214, v214, v246, v254
  v_fma_f32 v215, v215, v247, v255
  v_mfma_f32_16x16x32_bf16 v[68:71], a[96:99], v[196:199], 0
  ds_read_b64_tr_b16 a[94:95], v207 offset:2048
  v_cvt_pk_bf16_f32 v162, v212, v213
  v_lshlrev_b32 v210, 16, v229
  v_mfma_f32_16x16x32_bf16 v[72:75], a[100:103], v[192:195], 0
  ds_read_b64_tr_b16 a[96:97], v200 offset:256
  buffer_load_dwordx4 v130, s[24:27], s44 offen offset:2048 nt lds
  v_and_b32 v211, 0xffff0000, v229
  v_mfma_f32_16x16x32_bf16 v[76:79], a[100:103], v[196:199], 0
  ds_read_b64_tr_b16 a[98:99], v200 offset:2304
  v_fma_f32 v208, v208, v240, v248
  v_fma_f32 v209, v209, v241, v249
  v_mfma_f32_16x16x32_bf16 v[80:83], a[104:107], v[192:195], 0
  s_waitcnt lgkmcnt(8)
  ds_read_b64_tr_b16 a[100:101], v201 offset:256
  v_cvt_pk_bf16_f32 v163, v214, v215
  v_mfma_f32_16x16x32_bf16 v[84:87], a[104:107], v[196:199], 0
  ds_read_b64_tr_b16 a[102:103], v201 offset:2304
  v_lshlrev_b32 v212, 16, v230
  v_and_b32 v213, 0xffff0000, v230
  v_mfma_f32_16x16x32_bf16 v[88:91], a[108:111], v[192:195], 0
  ds_read_b64_tr_b16 a[104:105], v202 offset:256
  buffer_load_dwordx4 v131, s[24:27], s44 offen offset:3072 nt lds
  v_mfma_f32_16x16x32_bf16 v[92:95], a[108:111], v[196:199], 0
  ds_read_b64_tr_b16 a[106:107], v202 offset:2304
  v_fma_f32 v210, v210, v242, v250
  v_fma_f32 v211, v211, v243, v251
  v_mfma_f32_16x16x32_bf16 v[96:99], a[112:115], v[192:195], 0
  ds_read_b64_tr_b16 a[108:109], v203 offset:256
  v_cvt_pk_bf16_f32 v164, v208, v209
  v_lshlrev_b32 v214, 16, v231
  v_mfma_f32_16x16x32_bf16 v[100:103], a[112:115], v[196:199], 0
  ds_read_b64_tr_b16 a[110:111], v203 offset:2304
  v_and_b32 v215, 0xffff0000, v231
  v_fma_f32 v212, v212, v244, v252
  v_mfma_f32_16x16x32_bf16 v[104:107], a[116:119], v[192:195], 0
  ds_read_b64_tr_b16 a[112:113], v204 offset:256
  v_fma_f32 v213, v213, v245, v253
  v_cvt_pk_bf16_f32 v165, v210, v211
  v_mfma_f32_16x16x32_bf16 v[108:111], a[116:119], v[196:199], 0
  ds_read_b64_tr_b16 a[114:115], v204 offset:2304
  v_fma_f32 v214, v214, v246, v254
  v_fma_f32 v215, v215, v247, v255
  v_mfma_f32_16x16x32_bf16 v[112:115], a[120:123], v[192:195], 0
  s_waitcnt lgkmcnt(8)
  ds_read_b64_tr_b16 a[116:117], v205 offset:256
  v_mfma_f32_16x16x32_bf16 v[116:119], a[120:123], v[196:199], 0
  ds_read_b64_tr_b16 a[118:119], v205 offset:2304
  v_cvt_pk_bf16_f32 v166, v212, v213
  v_cvt_pk_bf16_f32 v167, v214, v215
  v_mfma_f32_16x16x32_bf16 v[120:123], a[124:127], v[192:195], 0
  ds_read_b64_tr_b16 a[120:121], v206 offset:256
  v_mfma_f32_16x16x32_bf16 v[124:127], a[124:127], v[196:199], 0
  ds_read_b64_tr_b16 a[122:123], v206 offset:2304
  v_mfma_f32_16x16x32_bf16 v[0:3], a[64:67], v[160:163], v[0:3]
  ds_read_b64_tr_b16 a[124:125], v207 offset:256
  v_mfma_f32_16x16x32_bf16 v[4:7], a[64:67], v[164:167], v[4:7]
  ds_read_b64_tr_b16 a[126:127], v207 offset:2304
  s_waitcnt vmcnt(6)
  v_mfma_f32_16x16x32_bf16 v[8:11], a[68:71], v[160:163], v[8:11]
  ds_read_b64_tr_b16 a[64:65], v132 offset:49152
  s_mov_b32 s45, 4096
  buffer_load_dwordx4 v[224:227], v141, s[28:31], s45 offen sc1
  v_lshlrev_b32 v208, 16, v232
  v_mfma_f32_16x16x32_bf16 v[12:15], a[68:71], v[164:167], v[12:15]
  ds_read_b64_tr_b16 a[66:67], v132 offset:51200
  ds_read_b128 v[240:243], v140 offset:2176
  v_and_b32 v209, 0xffff0000, v232
  v_mfma_f32_16x16x32_bf16 v[16:19], a[72:75], v[160:163], v[16:19]
  s_waitcnt lgkmcnt(8)
  ds_read_b64_tr_b16 a[68:69], v133 offset:49152
  v_lshlrev_b32 v210, 16, v233
  v_mfma_f32_16x16x32_bf16 v[20:23], a[72:75], v[164:167], v[20:23]
  ds_read_b64_tr_b16 a[70:71], v133 offset:51200
  ds_read_b128 v[244:247], v140 offset:2192
  v_and_b32 v211, 0xffff0000, v233
  v_mfma_f32_16x16x32_bf16 v[24:27], a[76:79], v[160:163], v[24:27]
  ds_read_b64_tr_b16 a[72:73], v134 offset:49152
  buffer_load_dwordx4 v[228:231], v142, s[28:31], s45 offen sc1
  v_fma_f32 v208, v208, v144, v152
  v_mfma_f32_16x16x32_bf16 v[28:31], a[76:79], v[164:167], v[28:31]
  ds_read_b64_tr_b16 a[74:75], v134 offset:51200
  ds_read_b128 v[248:251], v140 offset:384
  v_fma_f32 v209, v209, v145, v153
  v_mfma_f32_16x16x32_bf16 v[32:35], a[80:83], v[160:163], v[32:35]
  ds_read_b64_tr_b16 a[76:77], v135 offset:49152
  v_lshlrev_b32 v212, 16, v234
  v_and_b32 v213, 0xffff0000, v234
  v_mfma_f32_16x16x32_bf16 v[36:39], a[80:83], v[164:167], v[36:39]
  s_add_u32 m0, s40, 0x0
  s_mov_b32 s44, 0x180000
  ds_read_b64_tr_b16 a[78:79], v135 offset:51200
  ds_read_b128 v[252:255], v140 offset:400
  v_fma_f32 v210, v210, v146, v154
  v_mfma_f32_16x16x32_bf16 v[40:43], a[84:87], v[160:163], v[40:43]
  ds_read_b64_tr_b16 a[80:81], v136 offset:49152
  buffer_load_dwordx4 v128, s[24:27], s44 offen offset:0 nt lds
  v_fma_f32 v211, v211, v147, v155
  v_mfma_f32_16x16x32_bf16 v[44:47], a[84:87], v[164:167], v[44:47]
  ds_read_b64_tr_b16 a[82:83], v136 offset:51200
  v_cvt_pk_bf16_f32 v192, v208, v209
  v_lshlrev_b32 v214, 16, v235
  v_mfma_f32_16x16x32_bf16 v[48:51], a[88:91], v[160:163], v[48:51]
  s_waitcnt lgkmcnt(8)
  ds_read_b64_tr_b16 a[84:85], v137 offset:49152
  v_and_b32 v215, 0xffff0000, v235
  v_mfma_f32_16x16x32_bf16 v[52:55], a[88:91], v[164:167], v[52:55]
  ds_read_b64_tr_b16 a[86:87], v137 offset:51200
  v_fma_f32 v212, v212, v148, v156
  v_fma_f32 v213, v213, v149, v157
  v_mfma_f32_16x16x32_bf16 v[56:59], a[92:95], v[160:163], v[56:59]
  ds_read_b64_tr_b16 a[88:89], v138 offset:49152
  buffer_load_dwordx4 v129, s[24:27], s44 offen offset:1024 nt lds
  v_cvt_pk_bf16_f32 v193, v210, v211
  v_mfma_f32_16x16x32_bf16 v[60:63], a[92:95], v[164:167], v[60:63]
  ds_read_b64_tr_b16 a[90:91], v138 offset:51200
  v_lshlrev_b32 v208, 16, v236
  v_and_b32 v209, 0xffff0000, v236
  v_mfma_f32_16x16x32_bf16 v[64:67], a[96:99], v[160:163], v[64:67]
  ds_read_b64_tr_b16 a[92:93], v139 offset:49152
  v_fma_f32 v214, v214, v150, v158
  v_fma_f32 v215, v215, v151, v159
  v_mfma_f32_16x16x32_bf16 v[68:71], a[96:99], v[164:167], v[68:71]
  ds_read_b64_tr_b16 a[94:95], v139 offset:51200
  v_cvt_pk_bf16_f32 v194, v212, v213
  v_lshlrev_b32 v210, 16, v237
  v_mfma_f32_16x16x32_bf16 v[72:75], a[100:103], v[160:163], v[72:75]
  ds_read_b64_tr_b16 a[96:97], v132 offset:49408
  buffer_load_dwordx4 v130, s[24:27], s44 offen offset:2048 nt lds
  v_and_b32 v211, 0xffff0000, v237
  v_mfma_f32_16x16x32_bf16 v[76:79], a[100:103], v[164:167], v[76:79]
  ds_read_b64_tr_b16 a[98:99], v132 offset:51456
  v_fma_f32 v208, v208, v144, v152
  v_fma_f32 v209, v209, v145, v153
  v_mfma_f32_16x16x32_bf16 v[80:83], a[104:107], v[160:163], v[80:83]
  s_waitcnt lgkmcnt(8)
  ds_read_b64_tr_b16 a[100:101], v133 offset:49408
  v_cvt_pk_bf16_f32 v195, v214, v215
  v_mfma_f32_16x16x32_bf16 v[84:87], a[104:107], v[164:167], v[84:87]
  ds_read_b64_tr_b16 a[102:103], v133 offset:51456
  v_lshlrev_b32 v212, 16, v238
  v_and_b32 v213, 0xffff0000, v238
  v_mfma_f32_16x16x32_bf16 v[88:91], a[108:111], v[160:163], v[88:91]
  ds_read_b64_tr_b16 a[104:105], v134 offset:49408
  buffer_load_dwordx4 v131, s[24:27], s44 offen offset:3072 nt lds
  v_mfma_f32_16x16x32_bf16 v[92:95], a[108:111], v[164:167], v[92:95]
  ds_read_b64_tr_b16 a[106:107], v134 offset:51456
  v_fma_f32 v210, v210, v146, v154
  v_fma_f32 v211, v211, v147, v155
  v_mfma_f32_16x16x32_bf16 v[96:99], a[112:115], v[160:163], v[96:99]
  ds_read_b64_tr_b16 a[108:109], v135 offset:49408
  v_cvt_pk_bf16_f32 v196, v208, v209
  v_lshlrev_b32 v214, 16, v239
  v_mfma_f32_16x16x32_bf16 v[100:103], a[112:115], v[164:167], v[100:103]
  ds_read_b64_tr_b16 a[110:111], v135 offset:51456
  v_and_b32 v215, 0xffff0000, v239
  v_fma_f32 v212, v212, v148, v156
  v_mfma_f32_16x16x32_bf16 v[104:107], a[116:119], v[160:163], v[104:107]
  ds_read_b64_tr_b16 a[112:113], v136 offset:49408
  v_fma_f32 v213, v213, v149, v157
  v_cvt_pk_bf16_f32 v197, v210, v211
  v_mfma_f32_16x16x32_bf16 v[108:111], a[116:119], v[164:167], v[108:111]
  ds_read_b64_tr_b16 a[114:115], v136 offset:51456
  v_fma_f32 v214, v214, v150, v158
  v_fma_f32 v215, v215, v151, v159
  v_mfma_f32_16x16x32_bf16 v[112:115], a[120:123], v[160:163], v[112:115]
  s_waitcnt lgkmcnt(8)
  ds_read_b64_tr_b16 a[116:117], v137 offset:49408
  v_mfma_f32_16x16x32_bf16 v[116:119], a[120:123], v[164:167], v[116:119]
  ds_read_b64_tr_b16 a[118:119], v137 offset:51456
  v_cvt_pk_bf16_f32 v198, v212, v213
  v_cvt_pk_bf16_f32 v199, v214, v215
  v_mfma_f32_16x16x32_bf16 v[120:123], a[124:127], v[160:163], v[120:123]
  ds_read_b64_tr_b16 a[120:121], v138 offset:49408
  v_mfma_f32_16x16x32_bf16 v[124:127], a[124:127], v[164:167], v[124:127]
  ds_read_b64_tr_b16 a[122:123], v138 offset:51456
  v_mfma_f32_16x16x32_bf16 v[0:3], a[64:67], v[192:195], v[0:3]
  ds_read_b64_tr_b16 a[124:125], v139 offset:49408
  v_mfma_f32_16x16x32_bf16 v[4:7], a[64:67], v[196:199], v[4:7]
  ds_read_b64_tr_b16 a[126:127], v139 offset:51456
  s_waitcnt vmcnt(10)
  s_barrier
  v_mfma_f32_16x16x32_bf16 v[8:11], a[68:71], v[192:195], v[8:11]
  ds_read_b64_tr_b16 a[64:65], v200 offset:16384
  s_mov_b32 s45, 5120
  buffer_load_dwordx4 v[232:235], v141, s[28:31], s45 offen sc1
  v_mfma_f32_16x16x32_bf16 v[12:15], a[68:71], v[196:199], v[12:15]
  ds_read_b64_tr_b16 a[66:67], v200 offset:18432
  ds_read_b128 v[144:147], v140 offset:2304
  v_mfma_f32_16x16x32_bf16 v[16:19], a[72:75], v[192:195], v[16:19]
  s_waitcnt lgkmcnt(8)
  ds_read_b64_tr_b16 a[68:69], v201 offset:16384
  v_mfma_f32_16x16x32_bf16 v[20:23], a[72:75], v[196:199], v[20:23]
  ds_read_b64_tr_b16 a[70:71], v201 offset:18432
  ds_read_b128 v[148:151], v140 offset:2320
  v_mfma_f32_16x16x32_bf16 v[24:27], a[76:79], v[192:195], v[24:27]
  ds_read_b64_tr_b16 a[72:73], v202 offset:16384
  buffer_load_dwordx4 v[236:239], v142, s[28:31], s45 offen sc1
  v_mfma_f32_16x16x32_bf16 v[28:31], a[76:79], v[196:199], v[28:31]
  ds_read_b64_tr_b16 a[74:75], v202 offset:18432
  ds_read_b128 v[152:155], v140 offset:512
  v_mfma_f32_16x16x32_bf16 v[32:35], a[80:83], v[192:195], v[32:35]
  ds_read_b64_tr_b16 a[76:77], v203 offset:16384
  v_mfma_f32_16x16x32_bf16 v[36:39], a[80:83], v[196:199], v[36:39]
  s_add_u32 m0, s40, 0x4000
  s_mov_b32 s44, 0x1c0000
  ds_read_b64_tr_b16 a[78:79], v203 offset:18432
  ds_read_b128 v[156:159], v140 offset:528
  v_mfma_f32_16x16x32_bf16 v[40:43], a[84:87], v[192:195], v[40:43]
  ds_read_b64_tr_b16 a[80:81], v204 offset:16384
  buffer_load_dwordx4 v128, s[24:27], s44 offen offset:0 nt lds
  v_lshlrev_b32 v208, 16, v216
  v_mfma_f32_16x16x32_bf16 v[44:47], a[84:87], v[196:199], v[44:47]
  ds_read_b64_tr_b16 a[82:83], v204 offset:18432
  v_and_b32 v209, 0xffff0000, v216
  v_lshlrev_b32 v210, 16, v217
  v_and_b32 v211, 0xffff0000, v217
  v_mfma_f32_16x16x32_bf16 v[48:51], a[88:91], v[192:195], v[48:51]
  s_waitcnt lgkmcnt(8)
  ds_read_b64_tr_b16 a[84:85], v205 offset:16384
  v_fma_f32 v208, v208, v240, v248
  v_mfma_f32_16x16x32_bf16 v[52:55], a[88:91], v[196:199], v[52:55]
  ds_read_b64_tr_b16 a[86:87], v205 offset:18432
  v_fma_f32 v209, v209, v241, v249
  v_lshlrev_b32 v212, 16, v218
  v_and_b32 v213, 0xffff0000, v218
  v_mfma_f32_16x16x32_bf16 v[56:59], a[92:95], v[192:195], v[56:59]
  ds_read_b64_tr_b16 a[88:89], v206 offset:16384
  buffer_load_dwordx4 v129, s[24:27], s44 offen offset:1024 nt lds
  v_fma_f32 v210, v210, v242, v250
  v_mfma_f32_16x16x32_bf16 v[60:63], a[92:95], v[196:199], v[60:63]
  ds_read_b64_tr_b16 a[90:91], v206 offset:18432
  v_fma_f32 v211, v211, v243, v251
  v_cvt_pk_bf16_f32 v160, v208, v209
  v_lshlrev_b32 v214, 16, v219
  v_mfma_f32_16x16x32_bf16 v[64:67], a[96:99], v[192:195], v[64:67]
  ds_read_b64_tr_b16 a[92:93], v207 offset:16384
  v_and_b32 v215, 0xffff0000, v219
  v_fma_f32 v212, v212, v244, v252
  v_fma_f32 v213, v213, v245, v253
  v_mfma_f32_16x16x32_bf16 v[68:71], a[96:99], v[196:199], v[68:71]
  ds_read_b64_tr_b16 a[94:95], v207 offset:18432
  v_cvt_pk_bf16_f32 v161, v210, v211
  v_lshlrev_b32 v208, 16, v220
  v_and_b32 v209, 0xffff0000, v220
  v_mfma_f32_16x16x32_bf16 v[72:75], a[100:103], v[192:195], v[72:75]
  ds_read_b64_tr_b16 a[96:97], v200 offset:16640
  buffer_load_dwordx4 v130, s[24:27], s44 offen offset:2048 nt lds
  v_fma_f32 v214, v214, v246, v254
  v_mfma_f32_16x16x32_bf16 v[76:79], a[100:103], v[196:199], v[76:79]
  ds_read_b64_tr_b16 a[98:99], v200 offset:18688
  v_fma_f32 v215, v215, v247, v255
  v_cvt_pk_bf16_f32 v162, v212, v213
  v_lshlrev_b32 v210, 16, v221
  v_mfma_f32_16x16x32_bf16 v[80:83], a[104:107], v[192:195], v[80:83]
  s_waitcnt lgkmcnt(8)
  ds_read_b64_tr_b16 a[100:101], v201 offset:16640
  v_and_b32 v211, 0xffff0000, v221
  v_mfma_f32_16x16x32_bf16 v[84:87], a[104:107], v[196:199], v[84:87]
  ds_read_b64_tr_b16 a[102:103], v201 offset:18688
  v_fma_f32 v208, v208, v240, v248
  v_fma_f32 v209, v209, v241, v249
  v_cvt_pk_bf16_f32 v163, v214, v215
  v_mfma_f32_16x16x32_bf16 v[88:91], a[108:111], v[192:195], v[88:91]
  ds_read_b64_tr_b16 a[104:105], v202 offset:16640
  buffer_load_dwordx4 v131, s[24:27], s44 offen offset:3072 nt lds
  v_lshlrev_b32 v212, 16, v222
  v_mfma_f32_16x16x32_bf16 v[92:95], a[108:111], v[196:199], v[92:95]
  ds_read_b64_tr_b16 a[106:107], v202 offset:18688
  v_and_b32 v213, 0xffff0000, v222
  v_fma_f32 v210, v210, v242, v250
  v_mfma_f32_16x16x32_bf16 v[96:99], a[112:115], v[192:195], v[96:99]
  ds_read_b64_tr_b16 a[108:109], v203 offset:16640
  v_fma_f32 v211, v211, v243, v251
  v_cvt_pk_bf16_f32 v164, v208, v209
  v_mfma_f32_16x16x32_bf16 v[100:103], a[112:115], v[196:199], v[100:103]
  ds_read_b64_tr_b16 a[110:111], v203 offset:18688
  v_lshlrev_b32 v214, 16, v223
  v_and_b32 v215, 0xffff0000, v223
  v_mfma_f32_16x16x32_bf16 v[104:107], a[116:119], v[192:195], v[104:107]
  ds_read_b64_tr_b16 a[112:113], v204 offset:16640
  v_fma_f32 v212, v212, v244, v252
  v_fma_f32 v213, v213, v245, v253
  v_mfma_f32_16x16x32_bf16 v[108:111], a[116:119], v[196:199], v[108:111]
  ds_read_b64_tr_b16 a[114:115], v204 offset:18688
  v_cvt_pk_bf16_f32 v165, v210, v211
  v_fma_f32 v214, v214, v246, v254
  v_mfma_f32_16x16x32_bf16 v[112:115], a[120:123], v[192:195], v[112:115]
  s_waitcnt lgkmcnt(8)
  ds_read_b64_tr_b16 a[116:117], v205 offset:16640
  v_fma_f32 v215, v215, v247, v255
  v_mfma_f32_16x16x32_bf16 v[116:119], a[120:123], v[196:199], v[116:119]
  ds_read_b64_tr_b16 a[118:119], v205 offset:18688
  v_cvt_pk_bf16_f32 v166, v212, v213
  v_cvt_pk_bf16_f32 v167, v214, v215
  v_mfma_f32_16x16x32_bf16 v[120:123], a[124:127], v[192:195], v[120:123]
  ds_read_b64_tr_b16 a[120:121], v206 offset:16640
  v_mfma_f32_16x16x32_bf16 v[124:127], a[124:127], v[196:199], v[124:127]
  ds_read_b64_tr_b16 a[122:123], v206 offset:18688
  v_mfma_f32_16x16x32_bf16 v[0:3], a[64:67], v[160:163], v[0:3]
  ds_read_b64_tr_b16 a[124:125], v207 offset:16640
  v_mfma_f32_16x16x32_bf16 v[4:7], a[64:67], v[164:167], v[4:7]
  ds_read_b64_tr_b16 a[126:127], v207 offset:18688
  s_waitcnt vmcnt(10)
  v_mfma_f32_16x16x32_bf16 v[8:11], a[68:71], v[160:163], v[8:11]
  ds_read_b64_tr_b16 a[64:65], v200 offset:32768
  s_mov_b32 s45, 6144
  buffer_load_dwordx4 v[216:219], v141, s[28:31], s45 offen sc1
  v_lshlrev_b32 v208, 16, v224
  v_mfma_f32_16x16x32_bf16 v[12:15], a[68:71], v[164:167], v[12:15]
  ds_read_b64_tr_b16 a[66:67], v200 offset:34816
  ds_read_b128 v[240:243], v140 offset:2432
  v_and_b32 v209, 0xffff0000, v224
  v_mfma_f32_16x16x32_bf16 v[16:19], a[72:75], v[160:163], v[16:19]
  s_waitcnt lgkmcnt(8)
  ds_read_b64_tr_b16 a[68:69], v201 offset:32768
  v_lshlrev_b32 v210, 16, v225
  v_mfma_f32_16x16x32_bf16 v[20:23], a[72:75], v[164:167], v[20:23]
  ds_read_b64_tr_b16 a[70:71], v201 offset:34816
  ds_read_b128 v[244:247], v140 offset:2448
  v_and_b32 v211, 0xffff0000, v225
  v_mfma_f32_16x16x32_bf16 v[24:27], a[76:79], v[160:163], v[24:27]
  ds_read_b64_tr_b16 a[72:73], v202 offset:32768
  buffer_load_dwordx4 v[220:223], v142, s[28:31], s45 offen sc1
  v_fma_f32 v208, v208, v144, v152
  v_mfma_f32_16x16x32_bf16 v[28:31], a[76:79], v[164:167], v[28:31]
  ds_read_b64_tr_b16 a[74:75], v202 offset:34816
  ds_read_b128 v[248:251], v140 offset:640
  v_fma_f32 v209, v209, v145, v153
  v_mfma_f32_16x16x32_bf16 v[32:35], a[80:83], v[160:163], v[32:35]
  ds_read_b64_tr_b16 a[76:77], v203 offset:32768
  v_lshlrev_b32 v212, 16, v226
  v_and_b32 v213, 0xffff0000, v226
  v_mfma_f32_16x16x32_bf16 v[36:39], a[80:83], v[164:167], v[36:39]
  s_add_u32 m0, s40, 0x8000
  s_mov_b32 s44, 0x200000
  ds_read_b64_tr_b16 a[78:79], v203 offset:34816
  ds_read_b128 v[252:255], v140 offset:656
  v_fma_f32 v210, v210, v146, v154
  v_mfma_f32_16x16x32_bf16 v[40:43], a[84:87], v[160:163], v[40:43]
  ds_read_b64_tr_b16 a[80:81], v204 offset:32768
  buffer_load_dwordx4 v128, s[24:27], s44 offen offset:0 nt lds
  v_fma_f32 v211, v211, v147, v155
  v_mfma_f32_16x16x32_bf16 v[44:47], a[84:87], v[164:167], v[44:47]
  ds_read_b64_tr_b16 a[82:83], v204 offset:34816
  v_cvt_pk_bf16_f32 v192, v208, v209
  v_lshlrev_b32 v214, 16, v227
  v_mfma_f32_16x16x32_bf16 v[48:51], a[88:91], v[160:163], v[48:51]
  s_waitcnt lgkmcnt(8)
  ds_read_b64_tr_b16 a[84:85], v205 offset:32768
  v_and_b32 v215, 0xffff0000, v227
  v_mfma_f32_16x16x32_bf16 v[52:55], a[88:91], v[164:167], v[52:55]
  ds_read_b64_tr_b16 a[86:87], v205 offset:34816
  v_fma_f32 v212, v212, v148, v156
  v_fma_f32 v213, v213, v149, v157
  v_mfma_f32_16x16x32_bf16 v[56:59], a[92:95], v[160:163], v[56:59]
  ds_read_b64_tr_b16 a[88:89], v206 offset:32768
  buffer_load_dwordx4 v129, s[24:27], s44 offen offset:1024 nt lds
  v_cvt_pk_bf16_f32 v193, v210, v211
  v_mfma_f32_16x16x32_bf16 v[60:63], a[92:95], v[164:167], v[60:63]
  ds_read_b64_tr_b16 a[90:91], v206 offset:34816
  v_lshlrev_b32 v208, 16, v228
  v_and_b32 v209, 0xffff0000, v228
  v_mfma_f32_16x16x32_bf16 v[64:67], a[96:99], v[160:163], v[64:67]
  ds_read_b64_tr_b16 a[92:93], v207 offset:32768
  v_fma_f32 v214, v214, v150, v158
  v_fma_f32 v215, v215, v151, v159
  v_mfma_f32_16x16x32_bf16 v[68:71], a[96:99], v[164:167], v[68:71]
  ds_read_b64_tr_b16 a[94:95], v207 offset:34816
  v_cvt_pk_bf16_f32 v194, v212, v213
  v_lshlrev_b32 v210, 16, v229
  v_mfma_f32_16x16x32_bf16 v[72:75], a[100:103], v[160:163], v[72:75]
  ds_read_b64_tr_b16 a[96:97], v200 offset:33024
  buffer_load_dwordx4 v130, s[24:27], s44 offen offset:2048 nt lds
  v_and_b32 v211, 0xffff0000, v229
  v_mfma_f32_16x16x32_bf16 v[76:79], a[100:103], v[164:167], v[76:79]
  ds_read_b64_tr_b16 a[98:99], v200 offset:35072
  v_fma_f32 v208, v208, v144, v152
  v_fma_f32 v209, v209, v145, v153
  v_mfma_f32_16x16x32_bf16 v[80:83], a[104:107], v[160:163], v[80:83]
  s_waitcnt lgkmcnt(8)
  ds_read_b64_tr_b16 a[100:101], v201 offset:33024
  v_cvt_pk_bf16_f32 v195, v214, v215
  v_mfma_f32_16x16x32_bf16 v[84:87], a[104:107], v[164:167], v[84:87]
  ds_read_b64_tr_b16 a[102:103], v201 offset:35072
  v_lshlrev_b32 v212, 16, v230
  v_and_b32 v213, 0xffff0000, v230
  v_mfma_f32_16x16x32_bf16 v[88:91], a[108:111], v[160:163], v[88:91]
  ds_read_b64_tr_b16 a[104:105], v202 offset:33024
  buffer_load_dwordx4 v131, s[24:27], s44 offen offset:3072 nt lds
  v_mfma_f32_16x16x32_bf16 v[92:95], a[108:111], v[164:167], v[92:95]
  ds_read_b64_tr_b16 a[106:107], v202 offset:35072
  v_fma_f32 v210, v210, v146, v154
  v_fma_f32 v211, v211, v147, v155
  v_mfma_f32_16x16x32_bf16 v[96:99], a[112:115], v[160:163], v[96:99]
  ds_read_b64_tr_b16 a[108:109], v203 offset:33024
  v_cvt_pk_bf16_f32 v196, v208, v209
  v_lshlrev_b32 v214, 16, v231
  v_mfma_f32_16x16x32_bf16 v[100:103], a[112:115], v[164:167], v[100:103]
  ds_read_b64_tr_b16 a[110:111], v203 offset:35072
  v_and_b32 v215, 0xffff0000, v231
  v_fma_f32 v212, v212, v148, v156
  v_mfma_f32_16x16x32_bf16 v[104:107], a[116:119], v[160:163], v[104:107]
  ds_read_b64_tr_b16 a[112:113], v204 offset:33024
  v_fma_f32 v213, v213, v149, v157
  v_cvt_pk_bf16_f32 v197, v210, v211
  v_mfma_f32_16x16x32_bf16 v[108:111], a[116:119], v[164:167], v[108:111]
  ds_read_b64_tr_b16 a[114:115], v204 offset:35072
  v_fma_f32 v214, v214, v150, v158
  v_fma_f32 v215, v215, v151, v159
  v_mfma_f32_16x16x32_bf16 v[112:115], a[120:123], v[160:163], v[112:115]
  s_waitcnt lgkmcnt(8)
  ds_read_b64_tr_b16 a[116:117], v205 offset:33024
  v_mfma_f32_16x16x32_bf16 v[116:119], a[120:123], v[164:167], v[116:119]
  ds_read_b64_tr_b16 a[118:119], v205 offset:35072
  v_cvt_pk_bf16_f32 v198, v212, v213
  v_cvt_pk_bf16_f32 v199, v214, v215
  v_mfma_f32_16x16x32_bf16 v[120:123], a[124:127], v[160:163], v[120:123]
  ds_read_b64_tr_b16 a[120:121], v206 offset:33024
  v_mfma_f32_16x16x32_bf16 v[124:127], a[124:127], v[164:167], v[124:127]
  ds_read_b64_tr_b16 a[122:123], v206 offset:35072
  v_mfma_f32_16x16x32_bf16 v[0:3], a[64:67], v[192:195], v[0:3]
  ds_read_b64_tr_b16 a[124:125], v207 offset:33024
  v_mfma_f32_16x16x32_bf16 v[4:7], a[64:67], v[196:199], v[4:7]
  ds_read_b64_tr_b16 a[126:127], v207 offset:35072
  s_waitcnt vmcnt(10)
  s_barrier
  v_mfma_f32_16x16x32_bf16 v[8:11], a[68:71], v[192:195], v[8:11]
  ds_read_b64_tr_b16 a[64:65], v200 offset:49152
  s_mov_b32 s45, 7168
  buffer_load_dwordx4 v[224:227], v141, s[28:31], s45 offen sc1
  v_mfma_f32_16x16x32_bf16 v[12:15], a[68:71], v[196:199], v[12:15]
  ds_read_b64_tr_b16 a[66:67], v200 offset:51200
  ds_read_b128 v[144:147], v140 offset:2560
  v_mfma_f32_16x16x32_bf16 v[16:19], a[72:75], v[192:195], v[16:19]
  s_waitcnt lgkmcnt(8)
  ds_read_b64_tr_b16 a[68:69], v201 offset:49152
  v_mfma_f32_16x16x32_bf16 v[20:23], a[72:75], v[196:199], v[20:23]
  ds_read_b64_tr_b16 a[70:71], v201 offset:51200
  ds_read_b128 v[148:151], v140 offset:2576
  v_mfma_f32_16x16x32_bf16 v[24:27], a[76:79], v[192:195], v[24:27]
  ds_read_b64_tr_b16 a[72:73], v202 offset:49152
  buffer_load_dwordx4 v[228:231], v142, s[28:31], s45 offen sc1
  v_mfma_f32_16x16x32_bf16 v[28:31], a[76:79], v[196:199], v[28:31]
  ds_read_b64_tr_b16 a[74:75], v202 offset:51200
  ds_read_b128 v[152:155], v140 offset:768
  v_mfma_f32_16x16x32_bf16 v[32:35], a[80:83], v[192:195], v[32:35]
  ds_read_b64_tr_b16 a[76:77], v203 offset:49152
  v_mfma_f32_16x16x32_bf16 v[36:39], a[80:83], v[196:199], v[36:39]
  s_add_u32 m0, s40, 0x10000
  s_mov_b32 s44, 0x240000
  ds_read_b64_tr_b16 a[78:79], v203 offset:51200
  ds_read_b128 v[156:159], v140 offset:784
  v_mfma_f32_16x16x32_bf16 v[40:43], a[84:87], v[192:195], v[40:43]
  ds_read_b64_tr_b16 a[80:81], v204 offset:49152
  buffer_load_dwordx4 v128, s[24:27], s44 offen offset:0 nt lds
  v_lshlrev_b32 v208, 16, v232
  v_mfma_f32_16x16x32_bf16 v[44:47], a[84:87], v[196:199], v[44:47]
  ds_read_b64_tr_b16 a[82:83], v204 offset:51200
  v_and_b32 v209, 0xffff0000, v232
  v_lshlrev_b32 v210, 16, v233
  v_and_b32 v211, 0xffff0000, v233
  v_mfma_f32_16x16x32_bf16 v[48:51], a[88:91], v[192:195], v[48:51]
  s_waitcnt lgkmcnt(8)
  ds_read_b64_tr_b16 a[84:85], v205 offset:49152
  v_fma_f32 v208, v208, v240, v248
  v_mfma_f32_16x16x32_bf16 v[52:55], a[88:91], v[196:199], v[52:55]
  ds_read_b64_tr_b16 a[86:87], v205 offset:51200
  v_fma_f32 v209, v209, v241, v249
  v_lshlrev_b32 v212, 16, v234
  v_and_b32 v213, 0xffff0000, v234
  v_mfma_f32_16x16x32_bf16 v[56:59], a[92:95], v[192:195], v[56:59]
  ds_read_b64_tr_b16 a[88:89], v206 offset:49152
  buffer_load_dwordx4 v129, s[24:27], s44 offen offset:1024 nt lds
  v_fma_f32 v210, v210, v242, v250
  v_mfma_f32_16x16x32_bf16 v[60:63], a[92:95], v[196:199], v[60:63]
  ds_read_b64_tr_b16 a[90:91], v206 offset:51200
  v_fma_f32 v211, v211, v243, v251
  v_cvt_pk_bf16_f32 v160, v208, v209
  v_lshlrev_b32 v214, 16, v235
  v_mfma_f32_16x16x32_bf16 v[64:67], a[96:99], v[192:195], v[64:67]
  ds_read_b64_tr_b16 a[92:93], v207 offset:49152
  v_and_b32 v215, 0xffff0000, v235
  v_fma_f32 v212, v212, v244, v252
  v_fma_f32 v213, v213, v245, v253
  v_mfma_f32_16x16x32_bf16 v[68:71], a[96:99], v[196:199], v[68:71]
  ds_read_b64_tr_b16 a[94:95], v207 offset:51200
  v_cvt_pk_bf16_f32 v161, v210, v211
  v_lshlrev_b32 v208, 16, v236
  v_and_b32 v209, 0xffff0000, v236
  v_mfma_f32_16x16x32_bf16 v[72:75], a[100:103], v[192:195], v[72:75]
  ds_read_b64_tr_b16 a[96:97], v200 offset:49408
  buffer_load_dwordx4 v130, s[24:27], s44 offen offset:2048 nt lds
  v_fma_f32 v214, v214, v246, v254
  v_mfma_f32_16x16x32_bf16 v[76:79], a[100:103], v[196:199], v[76:79]
  ds_read_b64_tr_b16 a[98:99], v200 offset:51456
  v_fma_f32 v215, v215, v247, v255
  v_cvt_pk_bf16_f32 v162, v212, v213
  v_lshlrev_b32 v210, 16, v237
  v_mfma_f32_16x16x32_bf16 v[80:83], a[104:107], v[192:195], v[80:83]
  s_waitcnt lgkmcnt(8)
  ds_read_b64_tr_b16 a[100:101], v201 offset:49408
  v_and_b32 v211, 0xffff0000, v237
  v_mfma_f32_16x16x32_bf16 v[84:87], a[104:107], v[196:199], v[84:87]
  ds_read_b64_tr_b16 a[102:103], v201 offset:51456
  v_fma_f32 v208, v208, v240, v248
  v_fma_f32 v209, v209, v241, v249
  v_cvt_pk_bf16_f32 v163, v214, v215
  v_mfma_f32_16x16x32_bf16 v[88:91], a[108:111], v[192:195], v[88:91]
  ds_read_b64_tr_b16 a[104:105], v202 offset:49408
  buffer_load_dwordx4 v131, s[24:27], s44 offen offset:3072 nt lds
  v_lshlrev_b32 v212, 16, v238
  v_mfma_f32_16x16x32_bf16 v[92:95], a[108:111], v[196:199], v[92:95]
  ds_read_b64_tr_b16 a[106:107], v202 offset:51456
  v_and_b32 v213, 0xffff0000, v238
  v_fma_f32 v210, v210, v242, v250
  v_mfma_f32_16x16x32_bf16 v[96:99], a[112:115], v[192:195], v[96:99]
  ds_read_b64_tr_b16 a[108:109], v203 offset:49408
  v_fma_f32 v211, v211, v243, v251
  v_cvt_pk_bf16_f32 v164, v208, v209
  v_mfma_f32_16x16x32_bf16 v[100:103], a[112:115], v[196:199], v[100:103]
  ds_read_b64_tr_b16 a[110:111], v203 offset:51456
  v_lshlrev_b32 v214, 16, v239
  v_and_b32 v215, 0xffff0000, v239
  v_mfma_f32_16x16x32_bf16 v[104:107], a[116:119], v[192:195], v[104:107]
  ds_read_b64_tr_b16 a[112:113], v204 offset:49408
  v_fma_f32 v212, v212, v244, v252
  v_fma_f32 v213, v213, v245, v253
  v_mfma_f32_16x16x32_bf16 v[108:111], a[116:119], v[196:199], v[108:111]
  ds_read_b64_tr_b16 a[114:115], v204 offset:51456
  v_cvt_pk_bf16_f32 v165, v210, v211
  v_fma_f32 v214, v214, v246, v254
  v_mfma_f32_16x16x32_bf16 v[112:115], a[120:123], v[192:195], v[112:115]
  s_waitcnt lgkmcnt(8)
  ds_read_b64_tr_b16 a[116:117], v205 offset:49408
  v_fma_f32 v215, v215, v247, v255
  v_mfma_f32_16x16x32_bf16 v[116:119], a[120:123], v[196:199], v[116:119]
  ds_read_b64_tr_b16 a[118:119], v205 offset:51456
  v_cvt_pk_bf16_f32 v166, v212, v213
  v_cvt_pk_bf16_f32 v167, v214, v215
  v_mfma_f32_16x16x32_bf16 v[120:123], a[124:127], v[192:195], v[120:123]
  ds_read_b64_tr_b16 a[120:121], v206 offset:49408
  v_mfma_f32_16x16x32_bf16 v[124:127], a[124:127], v[196:199], v[124:127]
  ds_read_b64_tr_b16 a[122:123], v206 offset:51456
  v_mfma_f32_16x16x32_bf16 v[0:3], a[64:67], v[160:163], v[0:3]
  ds_read_b64_tr_b16 a[124:125], v207 offset:49408
  v_mfma_f32_16x16x32_bf16 v[4:7], a[64:67], v[164:167], v[4:7]
  ds_read_b64_tr_b16 a[126:127], v207 offset:51456
  s_waitcnt vmcnt(10)
  v_mfma_f32_16x16x32_bf16 v[8:11], a[68:71], v[160:163], v[8:11]
  ds_read_b64_tr_b16 a[64:65], v132 offset:0
  s_mov_b32 s45, 8192
  buffer_load_dwordx4 v[232:235], v141, s[28:31], s45 offen sc1
  v_lshlrev_b32 v208, 16, v216
  v_mfma_f32_16x16x32_bf16 v[12:15], a[68:71], v[164:167], v[12:15]
  ds_read_b64_tr_b16 a[66:67], v132 offset:2048
  ds_read_b128 v[240:243], v140 offset:2688
  v_and_b32 v209, 0xffff0000, v216
  v_mfma_f32_16x16x32_bf16 v[16:19], a[72:75], v[160:163], v[16:19]
  s_waitcnt lgkmcnt(8)
  ds_read_b64_tr_b16 a[68:69], v133 offset:0
  v_lshlrev_b32 v210, 16, v217
  v_mfma_f32_16x16x32_bf16 v[20:23], a[72:75], v[164:167], v[20:23]
  ds_read_b64_tr_b16 a[70:71], v133 offset:2048
  ds_read_b128 v[244:247], v140 offset:2704
  v_and_b32 v211, 0xffff0000, v217
  v_mfma_f32_16x16x32_bf16 v[24:27], a[76:79], v[160:163], v[24:27]
  ds_read_b64_tr_b16 a[72:73], v134 offset:0
  buffer_load_dwordx4 v[236:239], v142, s[28:31], s45 offen sc1
  v_fma_f32 v208, v208, v144, v152
  v_mfma_f32_16x16x32_bf16 v[28:31], a[76:79], v[164:167], v[28:31]
  ds_read_b64_tr_b16 a[74:75], v134 offset:2048
  ds_read_b128 v[248:251], v140 offset:896
  v_fma_f32 v209, v209, v145, v153
  v_mfma_f32_16x16x32_bf16 v[32:35], a[80:83], v[160:163], v[32:35]
  ds_read_b64_tr_b16 a[76:77], v135 offset:0
  v_lshlrev_b32 v212, 16, v218
  v_and_b32 v213, 0xffff0000, v218
  v_mfma_f32_16x16x32_bf16 v[36:39], a[80:83], v[164:167], v[36:39]
  s_add_u32 m0, s40, 0xc000
  s_mov_b32 s44, 0x280000
  ds_read_b64_tr_b16 a[78:79], v135 offset:2048
  ds_read_b128 v[252:255], v140 offset:912
  v_fma_f32 v210, v210, v146, v154
  v_mfma_f32_16x16x32_bf16 v[40:43], a[84:87], v[160:163], v[40:43]
  ds_read_b64_tr_b16 a[80:81], v136 offset:0
  buffer_load_dwordx4 v128, s[24:27], s44 offen offset:0 nt lds
  v_fma_f32 v211, v211, v147, v155
  v_mfma_f32_16x16x32_bf16 v[44:47], a[84:87], v[164:167], v[44:47]
  ds_read_b64_tr_b16 a[82:83], v136 offset:2048
  v_cvt_pk_bf16_f32 v192, v208, v209
  v_lshlrev_b32 v214, 16, v219
  v_mfma_f32_16x16x32_bf16 v[48:51], a[88:91], v[160:163], v[48:51]
  s_waitcnt lgkmcnt(8)
  ds_read_b64_tr_b16 a[84:85], v137 offset:0
  v_and_b32 v215, 0xffff0000, v219
  v_mfma_f32_16x16x32_bf16 v[52:55], a[88:91], v[164:167], v[52:55]
  ds_read_b64_tr_b16 a[86:87], v137 offset:2048
  v_fma_f32 v212, v212, v148, v156
  v_fma_f32 v213, v213, v149, v157
  v_mfma_f32_16x16x32_bf16 v[56:59], a[92:95], v[160:163], v[56:59]
  ds_read_b64_tr_b16 a[88:89], v138 offset:0
  buffer_load_dwordx4 v129, s[24:27], s44 offen offset:1024 nt lds
  v_cvt_pk_bf16_f32 v193, v210, v211
  v_mfma_f32_16x16x32_bf16 v[60:63], a[92:95], v[164:167], v[60:63]
  ds_read_b64_tr_b16 a[90:91], v138 offset:2048
  v_lshlrev_b32 v208, 16, v220
  v_and_b32 v209, 0xffff0000, v220
  v_mfma_f32_16x16x32_bf16 v[64:67], a[96:99], v[160:163], v[64:67]
  ds_read_b64_tr_b16 a[92:93], v139 offset:0
  v_fma_f32 v214, v214, v150, v158
  v_fma_f32 v215, v215, v151, v159
  v_mfma_f32_16x16x32_bf16 v[68:71], a[96:99], v[164:167], v[68:71]
  ds_read_b64_tr_b16 a[94:95], v139 offset:2048
  v_cvt_pk_bf16_f32 v194, v212, v213
  v_lshlrev_b32 v210, 16, v221
  v_mfma_f32_16x16x32_bf16 v[72:75], a[100:103], v[160:163], v[72:75]
  ds_read_b64_tr_b16 a[96:97], v132 offset:256
  buffer_load_dwordx4 v130, s[24:27], s44 offen offset:2048 nt lds
  v_and_b32 v211, 0xffff0000, v221
  v_mfma_f32_16x16x32_bf16 v[76:79], a[100:103], v[164:167], v[76:79]
  ds_read_b64_tr_b16 a[98:99], v132 offset:2304
  v_fma_f32 v208, v208, v144, v152
  v_fma_f32 v209, v209, v145, v153
  v_mfma_f32_16x16x32_bf16 v[80:83], a[104:107], v[160:163], v[80:83]
  s_waitcnt lgkmcnt(8)
  ds_read_b64_tr_b16 a[100:101], v133 offset:256
  v_cvt_pk_bf16_f32 v195, v214, v215
  v_mfma_f32_16x16x32_bf16 v[84:87], a[104:107], v[164:167], v[84:87]
  ds_read_b64_tr_b16 a[102:103], v133 offset:2304
  v_lshlrev_b32 v212, 16, v222
  v_and_b32 v213, 0xffff0000, v222
  v_mfma_f32_16x16x32_bf16 v[88:91], a[108:111], v[160:163], v[88:91]
  ds_read_b64_tr_b16 a[104:105], v134 offset:256
  buffer_load_dwordx4 v131, s[24:27], s44 offen offset:3072 nt lds
  v_mfma_f32_16x16x32_bf16 v[92:95], a[108:111], v[164:167], v[92:95]
  ds_read_b64_tr_b16 a[106:107], v134 offset:2304
  v_fma_f32 v210, v210, v146, v154
  v_fma_f32 v211, v211, v147, v155
  v_mfma_f32_16x16x32_bf16 v[96:99], a[112:115], v[160:163], v[96:99]
  ds_read_b64_tr_b16 a[108:109], v135 offset:256
  v_cvt_pk_bf16_f32 v196, v208, v209
  v_lshlrev_b32 v214, 16, v223
  v_mfma_f32_16x16x32_bf16 v[100:103], a[112:115], v[164:167], v[100:103]
  ds_read_b64_tr_b16 a[110:111], v135 offset:2304
  v_and_b32 v215, 0xffff0000, v223
  v_fma_f32 v212, v212, v148, v156
  v_mfma_f32_16x16x32_bf16 v[104:107], a[116:119], v[160:163], v[104:107]
  ds_read_b64_tr_b16 a[112:113], v136 offset:256
  v_fma_f32 v213, v213, v149, v157
  v_cvt_pk_bf16_f32 v197, v210, v211
  v_mfma_f32_16x16x32_bf16 v[108:111], a[116:119], v[164:167], v[108:111]
  ds_read_b64_tr_b16 a[114:115], v136 offset:2304
  v_fma_f32 v214, v214, v150, v158
  v_fma_f32 v215, v215, v151, v159
  v_mfma_f32_16x16x32_bf16 v[112:115], a[120:123], v[160:163], v[112:115]
  s_waitcnt lgkmcnt(8)
  ds_read_b64_tr_b16 a[116:117], v137 offset:256
  v_mfma_f32_16x16x32_bf16 v[116:119], a[120:123], v[164:167], v[116:119]
  ds_read_b64_tr_b16 a[118:119], v137 offset:2304
  v_cvt_pk_bf16_f32 v198, v212, v213
  v_cvt_pk_bf16_f32 v199, v214, v215
  v_mfma_f32_16x16x32_bf16 v[120:123], a[124:127], v[160:163], v[120:123]
  ds_read_b64_tr_b16 a[120:121], v138 offset:256
  v_mfma_f32_16x16x32_bf16 v[124:127], a[124:127], v[164:167], v[124:127]
  ds_read_b64_tr_b16 a[122:123], v138 offset:2304
  v_mfma_f32_16x16x32_bf16 v[0:3], a[64:67], v[192:195], v[0:3]
  ds_read_b64_tr_b16 a[124:125], v139 offset:256
  v_mfma_f32_16x16x32_bf16 v[4:7], a[64:67], v[196:199], v[4:7]
  ds_read_b64_tr_b16 a[126:127], v139 offset:2304
  s_waitcnt vmcnt(10)
  s_barrier
  v_mfma_f32_16x16x32_bf16 v[8:11], a[68:71], v[192:195], v[8:11]
  ds_read_b64_tr_b16 a[64:65], v132 offset:16384
  s_mov_b32 s45, 9216
  buffer_load_dwordx4 v[216:219], v141, s[28:31], s45 offen sc1
  v_mfma_f32_16x16x32_bf16 v[12:15], a[68:71], v[196:199], v[12:15]
  ds_read_b64_tr_b16 a[66:67], v132 offset:18432
  ds_read_b128 v[144:147], v140 offset:2816
  v_mfma_f32_16x16x32_bf16 v[16:19], a[72:75], v[192:195], v[16:19]
  s_waitcnt lgkmcnt(8)
  ds_read_b64_tr_b16 a[68:69], v133 offset:16384
  v_mfma_f32_16x16x32_bf16 v[20:23], a[72:75], v[196:199], v[20:23]
  ds_read_b64_tr_b16 a[70:71], v133 offset:18432
  ds_read_b128 v[148:151], v140 offset:2832
  v_mfma_f32_16x16x32_bf16 v[24:27], a[76:79], v[192:195], v[24:27]
  ds_read_b64_tr_b16 a[72:73], v134 offset:16384
  buffer_load_dwordx4 v[220:223], v142, s[28:31], s45 offen sc1
  v_mfma_f32_16x16x32_bf16 v[28:31], a[76:79], v[196:199], v[28:31]
  ds_read_b64_tr_b16 a[74:75], v134 offset:18432
  ds_read_b128 v[152:155], v140 offset:1024
  v_mfma_f32_16x16x32_bf16 v[32:35], a[80:83], v[192:195], v[32:35]
  ds_read_b64_tr_b16 a[76:77], v135 offset:16384
  v_mfma_f32_16x16x32_bf16 v[36:39], a[80:83], v[196:199], v[36:39]
  s_add_u32 m0, s40, 0x14000
  s_mov_b32 s44, 0x2c0000
  ds_read_b64_tr_b16 a[78:79], v135 offset:18432
  ds_read_b128 v[156:159], v140 offset:1040
  v_mfma_f32_16x16x32_bf16 v[40:43], a[84:87], v[192:195], v[40:43]
  ds_read_b64_tr_b16 a[80:81], v136 offset:16384
  buffer_load_dwordx4 v128, s[24:27], s44 offen offset:0 nt lds
  v_lshlrev_b32 v208, 16, v224
  v_mfma_f32_16x16x32_bf16 v[44:47], a[84:87], v[196:199], v[44:47]
  ds_read_b64_tr_b16 a[82:83], v136 offset:18432
  v_and_b32 v209, 0xffff0000, v224
  v_lshlrev_b32 v210, 16, v225
  v_and_b32 v211, 0xffff0000, v225
  v_mfma_f32_16x16x32_bf16 v[48:51], a[88:91], v[192:195], v[48:51]
  s_waitcnt lgkmcnt(8)
  ds_read_b64_tr_b16 a[84:85], v137 offset:16384
  v_fma_f32 v208, v208, v240, v248
  v_mfma_f32_16x16x32_bf16 v[52:55], a[88:91], v[196:199], v[52:55]
  ds_read_b64_tr_b16 a[86:87], v137 offset:18432
  v_fma_f32 v209, v209, v241, v249
  v_lshlrev_b32 v212, 16, v226
  v_and_b32 v213, 0xffff0000, v226
  v_mfma_f32_16x16x32_bf16 v[56:59], a[92:95], v[192:195], v[56:59]
  ds_read_b64_tr_b16 a[88:89], v138 offset:16384
  buffer_load_dwordx4 v129, s[24:27], s44 offen offset:1024 nt lds
  v_fma_f32 v210, v210, v242, v250
  v_mfma_f32_16x16x32_bf16 v[60:63], a[92:95], v[196:199], v[60:63]
  ds_read_b64_tr_b16 a[90:91], v138 offset:18432
  v_fma_f32 v211, v211, v243, v251
  v_cvt_pk_bf16_f32 v160, v208, v209
  v_lshlrev_b32 v214, 16, v227
  v_mfma_f32_16x16x32_bf16 v[64:67], a[96:99], v[192:195], v[64:67]
  ds_read_b64_tr_b16 a[92:93], v139 offset:16384
  v_and_b32 v215, 0xffff0000, v227
  v_fma_f32 v212, v212, v244, v252
  v_fma_f32 v213, v213, v245, v253
  v_mfma_f32_16x16x32_bf16 v[68:71], a[96:99], v[196:199], v[68:71]
  ds_read_b64_tr_b16 a[94:95], v139 offset:18432
  v_cvt_pk_bf16_f32 v161, v210, v211
  v_lshlrev_b32 v208, 16, v228
  v_and_b32 v209, 0xffff0000, v228
  v_mfma_f32_16x16x32_bf16 v[72:75], a[100:103], v[192:195], v[72:75]
  ds_read_b64_tr_b16 a[96:97], v132 offset:16640
  buffer_load_dwordx4 v130, s[24:27], s44 offen offset:2048 nt lds
  v_fma_f32 v214, v214, v246, v254
  v_mfma_f32_16x16x32_bf16 v[76:79], a[100:103], v[196:199], v[76:79]
  ds_read_b64_tr_b16 a[98:99], v132 offset:18688
  v_fma_f32 v215, v215, v247, v255
  v_cvt_pk_bf16_f32 v162, v212, v213
  v_lshlrev_b32 v210, 16, v229
  v_mfma_f32_16x16x32_bf16 v[80:83], a[104:107], v[192:195], v[80:83]
  s_waitcnt lgkmcnt(8)
  ds_read_b64_tr_b16 a[100:101], v133 offset:16640
  v_and_b32 v211, 0xffff0000, v229
  v_mfma_f32_16x16x32_bf16 v[84:87], a[104:107], v[196:199], v[84:87]
  ds_read_b64_tr_b16 a[102:103], v133 offset:18688
  v_fma_f32 v208, v208, v240, v248
  v_fma_f32 v209, v209, v241, v249
  v_cvt_pk_bf16_f32 v163, v214, v215
  v_mfma_f32_16x16x32_bf16 v[88:91], a[108:111], v[192:195], v[88:91]
  ds_read_b64_tr_b16 a[104:105], v134 offset:16640
  buffer_load_dwordx4 v131, s[24:27], s44 offen offset:3072 nt lds
  v_lshlrev_b32 v212, 16, v230
  v_mfma_f32_16x16x32_bf16 v[92:95], a[108:111], v[196:199], v[92:95]
  ds_read_b64_tr_b16 a[106:107], v134 offset:18688
  v_and_b32 v213, 0xffff0000, v230
  v_fma_f32 v210, v210, v242, v250
  v_mfma_f32_16x16x32_bf16 v[96:99], a[112:115], v[192:195], v[96:99]
  ds_read_b64_tr_b16 a[108:109], v135 offset:16640
  v_fma_f32 v211, v211, v243, v251
  v_cvt_pk_bf16_f32 v164, v208, v209
  v_mfma_f32_16x16x32_bf16 v[100:103], a[112:115], v[196:199], v[100:103]
  ds_read_b64_tr_b16 a[110:111], v135 offset:18688
  v_lshlrev_b32 v214, 16, v231
  v_and_b32 v215, 0xffff0000, v231
  v_mfma_f32_16x16x32_bf16 v[104:107], a[116:119], v[192:195], v[104:107]
  ds_read_b64_tr_b16 a[112:113], v136 offset:16640
  v_fma_f32 v212, v212, v244, v252
  v_fma_f32 v213, v213, v245, v253
  v_mfma_f32_16x16x32_bf16 v[108:111], a[116:119], v[196:199], v[108:111]
  ds_read_b64_tr_b16 a[114:115], v136 offset:18688
  v_cvt_pk_bf16_f32 v165, v210, v211
  v_fma_f32 v214, v214, v246, v254
  v_mfma_f32_16x16x32_bf16 v[112:115], a[120:123], v[192:195], v[112:115]
  s_waitcnt lgkmcnt(8)
  ds_read_b64_tr_b16 a[116:117], v137 offset:16640
  v_fma_f32 v215, v215, v247, v255
  v_mfma_f32_16x16x32_bf16 v[116:119], a[120:123], v[196:199], v[116:119]
  ds_read_b64_tr_b16 a[118:119], v137 offset:18688
  v_cvt_pk_bf16_f32 v166, v212, v213
  v_cvt_pk_bf16_f32 v167, v214, v215
  v_mfma_f32_16x16x32_bf16 v[120:123], a[124:127], v[192:195], v[120:123]
  ds_read_b64_tr_b16 a[120:121], v138 offset:16640
  v_mfma_f32_16x16x32_bf16 v[124:127], a[124:127], v[196:199], v[124:127]
  ds_read_b64_tr_b16 a[122:123], v138 offset:18688
  v_mfma_f32_16x16x32_bf16 v[0:3], a[64:67], v[160:163], v[0:3]
  ds_read_b64_tr_b16 a[124:125], v139 offset:16640
  v_mfma_f32_16x16x32_bf16 v[4:7], a[64:67], v[164:167], v[4:7]
  ds_read_b64_tr_b16 a[126:127], v139 offset:18688
  s_waitcnt vmcnt(10)
  v_mfma_f32_16x16x32_bf16 v[8:11], a[68:71], v[160:163], v[8:11]
  ds_read_b64_tr_b16 a[64:65], v132 offset:32768
  s_mov_b32 s45, 10240
  buffer_load_dwordx4 v[224:227], v141, s[28:31], s45 offen sc1
  v_lshlrev_b32 v208, 16, v232
  v_mfma_f32_16x16x32_bf16 v[12:15], a[68:71], v[164:167], v[12:15]
  ds_read_b64_tr_b16 a[66:67], v132 offset:34816
  ds_read_b128 v[240:243], v140 offset:2944
  v_and_b32 v209, 0xffff0000, v232
  v_mfma_f32_16x16x32_bf16 v[16:19], a[72:75], v[160:163], v[16:19]
  s_waitcnt lgkmcnt(8)
  ds_read_b64_tr_b16 a[68:69], v133 offset:32768
  v_lshlrev_b32 v210, 16, v233
  v_mfma_f32_16x16x32_bf16 v[20:23], a[72:75], v[164:167], v[20:23]
  ds_read_b64_tr_b16 a[70:71], v133 offset:34816
  ds_read_b128 v[244:247], v140 offset:2960
  v_and_b32 v211, 0xffff0000, v233
  v_mfma_f32_16x16x32_bf16 v[24:27], a[76:79], v[160:163], v[24:27]
  ds_read_b64_tr_b16 a[72:73], v134 offset:32768
  buffer_load_dwordx4 v[228:231], v142, s[28:31], s45 offen sc1
  v_fma_f32 v208, v208, v144, v152
  v_mfma_f32_16x16x32_bf16 v[28:31], a[76:79], v[164:167], v[28:31]
  ds_read_b64_tr_b16 a[74:75], v134 offset:34816
  ds_read_b128 v[248:251], v140 offset:1152
  v_fma_f32 v209, v209, v145, v153
  v_mfma_f32_16x16x32_bf16 v[32:35], a[80:83], v[160:163], v[32:35]
  ds_read_b64_tr_b16 a[76:77], v135 offset:32768
  v_lshlrev_b32 v212, 16, v234
  v_and_b32 v213, 0xffff0000, v234
  v_mfma_f32_16x16x32_bf16 v[36:39], a[80:83], v[164:167], v[36:39]
  s_add_u32 m0, s40, 0x18000
  s_mov_b32 s44, 0x300000
  ds_read_b64_tr_b16 a[78:79], v135 offset:34816
  ds_read_b128 v[252:255], v140 offset:1168
  v_fma_f32 v210, v210, v146, v154
  v_mfma_f32_16x16x32_bf16 v[40:43], a[84:87], v[160:163], v[40:43]
  ds_read_b64_tr_b16 a[80:81], v136 offset:32768
  buffer_load_dwordx4 v128, s[24:27], s44 offen offset:0 nt lds
  v_fma_f32 v211, v211, v147, v155
  v_mfma_f32_16x16x32_bf16 v[44:47], a[84:87], v[164:167], v[44:47]
  ds_read_b64_tr_b16 a[82:83], v136 offset:34816
  v_cvt_pk_bf16_f32 v192, v208, v209
  v_lshlrev_b32 v214, 16, v235
  v_mfma_f32_16x16x32_bf16 v[48:51], a[88:91], v[160:163], v[48:51]
  s_waitcnt lgkmcnt(8)
  ds_read_b64_tr_b16 a[84:85], v137 offset:32768
  v_and_b32 v215, 0xffff0000, v235
  v_mfma_f32_16x16x32_bf16 v[52:55], a[88:91], v[164:167], v[52:55]
  ds_read_b64_tr_b16 a[86:87], v137 offset:34816
  v_fma_f32 v212, v212, v148, v156
  v_fma_f32 v213, v213, v149, v157
  v_mfma_f32_16x16x32_bf16 v[56:59], a[92:95], v[160:163], v[56:59]
  ds_read_b64_tr_b16 a[88:89], v138 offset:32768
  buffer_load_dwordx4 v129, s[24:27], s44 offen offset:1024 nt lds
  v_cvt_pk_bf16_f32 v193, v210, v211
  v_mfma_f32_16x16x32_bf16 v[60:63], a[92:95], v[164:167], v[60:63]
  ds_read_b64_tr_b16 a[90:91], v138 offset:34816
  v_lshlrev_b32 v208, 16, v236
  v_and_b32 v209, 0xffff0000, v236
  v_mfma_f32_16x16x32_bf16 v[64:67], a[96:99], v[160:163], v[64:67]
  ds_read_b64_tr_b16 a[92:93], v139 offset:32768
  v_fma_f32 v214, v214, v150, v158
  v_fma_f32 v215, v215, v151, v159
  v_mfma_f32_16x16x32_bf16 v[68:71], a[96:99], v[164:167], v[68:71]
  ds_read_b64_tr_b16 a[94:95], v139 offset:34816
  v_cvt_pk_bf16_f32 v194, v212, v213
  v_lshlrev_b32 v210, 16, v237
  v_mfma_f32_16x16x32_bf16 v[72:75], a[100:103], v[160:163], v[72:75]
  ds_read_b64_tr_b16 a[96:97], v132 offset:33024
  buffer_load_dwordx4 v130, s[24:27], s44 offen offset:2048 nt lds
  v_and_b32 v211, 0xffff0000, v237
  v_mfma_f32_16x16x32_bf16 v[76:79], a[100:103], v[164:167], v[76:79]
  ds_read_b64_tr_b16 a[98:99], v132 offset:35072
  v_fma_f32 v208, v208, v144, v152
  v_fma_f32 v209, v209, v145, v153
  v_mfma_f32_16x16x32_bf16 v[80:83], a[104:107], v[160:163], v[80:83]
  s_waitcnt lgkmcnt(8)
  ds_read_b64_tr_b16 a[100:101], v133 offset:33024
  v_cvt_pk_bf16_f32 v195, v214, v215
  v_mfma_f32_16x16x32_bf16 v[84:87], a[104:107], v[164:167], v[84:87]
  ds_read_b64_tr_b16 a[102:103], v133 offset:35072
  v_lshlrev_b32 v212, 16, v238
  v_and_b32 v213, 0xffff0000, v238
  v_mfma_f32_16x16x32_bf16 v[88:91], a[108:111], v[160:163], v[88:91]
  ds_read_b64_tr_b16 a[104:105], v134 offset:33024
  buffer_load_dwordx4 v131, s[24:27], s44 offen offset:3072 nt lds
  v_mfma_f32_16x16x32_bf16 v[92:95], a[108:111], v[164:167], v[92:95]
  ds_read_b64_tr_b16 a[106:107], v134 offset:35072
  v_fma_f32 v210, v210, v146, v154
  v_fma_f32 v211, v211, v147, v155
  v_mfma_f32_16x16x32_bf16 v[96:99], a[112:115], v[160:163], v[96:99]
  ds_read_b64_tr_b16 a[108:109], v135 offset:33024
  v_cvt_pk_bf16_f32 v196, v208, v209
  v_lshlrev_b32 v214, 16, v239
  v_mfma_f32_16x16x32_bf16 v[100:103], a[112:115], v[164:167], v[100:103]
  ds_read_b64_tr_b16 a[110:111], v135 offset:35072
  v_and_b32 v215, 0xffff0000, v239
  v_fma_f32 v212, v212, v148, v156
  v_mfma_f32_16x16x32_bf16 v[104:107], a[116:119], v[160:163], v[104:107]
  ds_read_b64_tr_b16 a[112:113], v136 offset:33024
  v_fma_f32 v213, v213, v149, v157
  v_cvt_pk_bf16_f32 v197, v210, v211
  v_mfma_f32_16x16x32_bf16 v[108:111], a[116:119], v[164:167], v[108:111]
  ds_read_b64_tr_b16 a[114:115], v136 offset:35072
  v_fma_f32 v214, v214, v150, v158
  v_fma_f32 v215, v215, v151, v159
  v_mfma_f32_16x16x32_bf16 v[112:115], a[120:123], v[160:163], v[112:115]
  s_waitcnt lgkmcnt(8)
  ds_read_b64_tr_b16 a[116:117], v137 offset:33024
  v_mfma_f32_16x16x32_bf16 v[116:119], a[120:123], v[164:167], v[116:119]
  ds_read_b64_tr_b16 a[118:119], v137 offset:35072
  v_cvt_pk_bf16_f32 v198, v212, v213
  v_cvt_pk_bf16_f32 v199, v214, v215
  v_mfma_f32_16x16x32_bf16 v[120:123], a[124:127], v[160:163], v[120:123]
  ds_read_b64_tr_b16 a[120:121], v138 offset:33024
  v_mfma_f32_16x16x32_bf16 v[124:127], a[124:127], v[164:167], v[124:127]
  ds_read_b64_tr_b16 a[122:123], v138 offset:35072
  v_mfma_f32_16x16x32_bf16 v[0:3], a[64:67], v[192:195], v[0:3]
  ds_read_b64_tr_b16 a[124:125], v139 offset:33024
  v_mfma_f32_16x16x32_bf16 v[4:7], a[64:67], v[196:199], v[4:7]
  ds_read_b64_tr_b16 a[126:127], v139 offset:35072
  s_waitcnt vmcnt(10)
  s_barrier
  v_mfma_f32_16x16x32_bf16 v[8:11], a[68:71], v[192:195], v[8:11]
  ds_read_b64_tr_b16 a[64:65], v200 offset:0
  s_mov_b32 s45, 11264
  buffer_load_dwordx4 v[232:235], v141, s[28:31], s45 offen sc1
  v_mfma_f32_16x16x32_bf16 v[12:15], a[68:71], v[196:199], v[12:15]
  ds_read_b64_tr_b16 a[66:67], v200 offset:2048
  ds_read_b128 v[144:147], v140 offset:3072
  v_mfma_f32_16x16x32_bf16 v[16:19], a[72:75], v[192:195], v[16:19]
  s_waitcnt lgkmcnt(8)
  ds_read_b64_tr_b16 a[68:69], v201 offset:0
  v_mfma_f32_16x16x32_bf16 v[20:23], a[72:75], v[196:199], v[20:23]
  ds_read_b64_tr_b16 a[70:71], v201 offset:2048
  ds_read_b128 v[148:151], v140 offset:3088
  v_mfma_f32_16x16x32_bf16 v[24:27], a[76:79], v[192:195], v[24:27]
  ds_read_b64_tr_b16 a[72:73], v202 offset:0
  buffer_load_dwordx4 v[236:239], v142, s[28:31], s45 offen sc1
  v_mfma_f32_16x16x32_bf16 v[28:31], a[76:79], v[196:199], v[28:31]
  s_add_u32 m0, s40, 0x1c000
  s_mov_b32 s44, 0x340000
  ds_read_b64_tr_b16 a[74:75], v202 offset:2048
  ds_read_b128 v[152:155], v140 offset:1280
  v_mfma_f32_16x16x32_bf16 v[32:35], a[80:83], v[192:195], v[32:35]
  ds_read_b64_tr_b16 a[76:77], v203 offset:0
  buffer_load_dwordx4 v128, s[24:27], s44 offen offset:0 nt lds
  v_mfma_f32_16x16x32_bf16 v[36:39], a[80:83], v[196:199], v[36:39]
  ds_read_b64_tr_b16 a[78:79], v203 offset:2048
  ds_read_b128 v[156:159], v140 offset:1296
  v_mfma_f32_16x16x32_bf16 v[40:43], a[84:87], v[192:195], v[40:43]
  ds_read_b64_tr_b16 a[80:81], v204 offset:0
  v_lshlrev_b32 v208, 16, v216
  v_and_b32 v209, 0xffff0000, v216
  v_lshlrev_b32 v210, 16, v217
  v_mfma_f32_16x16x32_bf16 v[44:47], a[84:87], v[196:199], v[44:47]
  ds_read_b64_tr_b16 a[82:83], v204 offset:2048
  buffer_load_dwordx4 v129, s[24:27], s44 offen offset:1024 nt lds
  v_and_b32 v211, 0xffff0000, v217
  v_mfma_f32_16x16x32_bf16 v[48:51], a[88:91], v[192:195], v[48:51]
  s_waitcnt lgkmcnt(8)
  ds_read_b64_tr_b16 a[84:85], v205 offset:0
  v_fma_f32 v208, v208, v240, v248
  v_mfma_f32_16x16x32_bf16 v[52:55], a[88:91], v[196:199], v[52:55]
  ds_read_b64_tr_b16 a[86:87], v205 offset:2048
  v_fma_f32 v209, v209, v241, v249
  v_lshlrev_b32 v212, 16, v218
  v_and_b32 v213, 0xffff0000, v218
  v_mfma_f32_16x16x32_bf16 v[56:59], a[92:95], v[192:195], v[56:59]
  ds_read_b64_tr_b16 a[88:89], v206 offset:0
  buffer_load_dwordx4 v130, s[24:27], s44 offen offset:2048 nt lds
  v_fma_f32 v210, v210, v242, v250
  v_mfma_f32_16x16x32_bf16 v[60:63], a[92:95], v[196:199], v[60:63]
  ds_read_b64_tr_b16 a[90:91], v206 offset:2048
  v_fma_f32 v211, v211, v243, v251
  v_cvt_pk_bf16_f32 v160, v208, v209
  v_lshlrev_b32 v214, 16, v219
  v_mfma_f32_16x16x32_bf16 v[64:67], a[96:99], v[192:195], v[64:67]
  ds_read_b64_tr_b16 a[92:93], v207 offset:0
  v_and_b32 v215, 0xffff0000, v219
  v_fma_f32 v212, v212, v244, v252
  v_fma_f32 v213, v213, v245, v253
  v_mfma_f32_16x16x32_bf16 v[68:71], a[96:99], v[196:199], v[68:71]
  ds_read_b64_tr_b16 a[94:95], v207 offset:2048
  buffer_load_dwordx4 v131, s[24:27], s44 offen offset:3072 nt lds
  v_cvt_pk_bf16_f32 v161, v210, v211
  v_mfma_f32_16x16x32_bf16 v[72:75], a[100:103], v[192:195], v[72:75]
  ds_read_b64_tr_b16 a[96:97], v200 offset:256
  v_lshlrev_b32 v208, 16, v220
  v_and_b32 v209, 0xffff0000, v220
  v_fma_f32 v214, v214, v246, v254
  v_mfma_f32_16x16x32_bf16 v[76:79], a[100:103], v[196:199], v[76:79]
  ds_read_b64_tr_b16 a[98:99], v200 offset:2304
  v_fma_f32 v215, v215, v247, v255
  v_cvt_pk_bf16_f32 v162, v212, v213
  v_lshlrev_b32 v210, 16, v221
  v_mfma_f32_16x16x32_bf16 v[80:83], a[104:107], v[192:195], v[80:83]
  s_add_u32 m0, s40, 0x0
  s_mov_b32 s44, 0x0
  s_waitcnt lgkmcnt(8)
  ds_read_b64_tr_b16 a[100:101], v201 offset:256
  v_and_b32 v211, 0xffff0000, v221
  v_mfma_f32_16x16x32_bf16 v[84:87], a[104:107], v[196:199], v[84:87]
  ds_read_b64_tr_b16 a[102:103], v201 offset:2304
  buffer_load_dwordx4 v182, s[16:19], s44 offen offset:0 nt lds
  v_fma_f32 v208, v208, v240, v248
  v_mfma_f32_16x16x32_bf16 v[88:91], a[108:111], v[192:195], v[88:91]
  ds_read_b64_tr_b16 a[104:105], v202 offset:256
  v_fma_f32 v209, v209, v241, v249
  v_cvt_pk_bf16_f32 v163, v214, v215
  v_lshlrev_b32 v212, 16, v222
  v_mfma_f32_16x16x32_bf16 v[92:95], a[108:111], v[196:199], v[92:95]
  ds_read_b64_tr_b16 a[106:107], v202 offset:2304
  v_and_b32 v213, 0xffff0000, v222
  v_fma_f32 v210, v210, v242, v250
  v_fma_f32 v211, v211, v243, v251
  v_mfma_f32_16x16x32_bf16 v[96:99], a[112:115], v[192:195], v[96:99]
  ds_read_b64_tr_b16 a[108:109], v203 offset:256
  buffer_load_dwordx4 v183, s[16:19], s44 offen offset:1024 nt lds
  v_cvt_pk_bf16_f32 v164, v208, v209
  v_mfma_f32_16x16x32_bf16 v[100:103], a[112:115], v[196:199], v[100:103]
  ds_read_b64_tr_b16 a[110:111], v203 offset:2304
  v_lshlrev_b32 v214, 16, v223
  v_and_b32 v215, 0xffff0000, v223
  v_fma_f32 v212, v212, v244, v252
  v_mfma_f32_16x16x32_bf16 v[104:107], a[116:119], v[192:195], v[104:107]
  ds_read_b64_tr_b16 a[112:113], v204 offset:256
  v_fma_f32 v213, v213, v245, v253
  v_cvt_pk_bf16_f32 v165, v210, v211
  v_mfma_f32_16x16x32_bf16 v[108:111], a[116:119], v[196:199], v[108:111]
  ds_read_b64_tr_b16 a[114:115], v204 offset:2304
  buffer_load_dwordx4 v184, s[16:19], s44 offen offset:2048 nt lds
  v_fma_f32 v214, v214, v246, v254
  v_mfma_f32_16x16x32_bf16 v[112:115], a[120:123], v[192:195], v[112:115]
  s_waitcnt lgkmcnt(8)
  ds_read_b64_tr_b16 a[116:117], v205 offset:256
  v_fma_f32 v215, v215, v247, v255
  v_mfma_f32_16x16x32_bf16 v[116:119], a[120:123], v[196:199], v[116:119]
  ds_read_b64_tr_b16 a[118:119], v205 offset:2304
  v_cvt_pk_bf16_f32 v166, v212, v213
  v_cvt_pk_bf16_f32 v167, v214, v215
  v_mfma_f32_16x16x32_bf16 v[120:123], a[124:127], v[192:195], v[120:123]
  ds_read_b64_tr_b16 a[120:121], v206 offset:256
  buffer_load_dwordx4 v185, s[16:19], s44 offen offset:3072 nt lds
  v_mfma_f32_16x16x32_bf16 v[124:127], a[124:127], v[196:199], v[124:127]
  ds_read_b64_tr_b16 a[122:123], v206 offset:2304
  v_mfma_f32_16x16x32_bf16 v[0:3], a[64:67], v[160:163], v[0:3]
  ds_read_b64_tr_b16 a[124:125], v207 offset:256
  v_mfma_f32_16x16x32_bf16 v[4:7], a[64:67], v[164:167], v[4:7]
  ds_read_b64_tr_b16 a[126:127], v207 offset:2304
  s_waitcnt vmcnt(14)
  v_mfma_f32_16x16x32_bf16 v[8:11], a[68:71], v[160:163], v[8:11]
  ds_read_b64_tr_b16 a[64:65], v132 offset:49152
  s_mov_b32 s45, 12288
  buffer_load_dwordx4 v[216:219], v141, s[28:31], s45 offen sc1
  v_lshlrev_b32 v208, 16, v224
  v_mfma_f32_16x16x32_bf16 v[12:15], a[68:71], v[164:167], v[12:15]
  ds_read_b64_tr_b16 a[66:67], v132 offset:51200
  ds_read_b128 v[240:243], v140 offset:3200
  v_and_b32 v209, 0xffff0000, v224
  v_mfma_f32_16x16x32_bf16 v[16:19], a[72:75], v[160:163], v[16:19]
  s_waitcnt lgkmcnt(8)
  ds_read_b64_tr_b16 a[68:69], v133 offset:49152
  v_lshlrev_b32 v210, 16, v225
  v_mfma_f32_16x16x32_bf16 v[20:23], a[72:75], v[164:167], v[20:23]
  ds_read_b64_tr_b16 a[70:71], v133 offset:51200
  ds_read_b128 v[244:247], v140 offset:3216
  v_and_b32 v211, 0xffff0000, v225
  v_mfma_f32_16x16x32_bf16 v[24:27], a[76:79], v[160:163], v[24:27]
  ds_read_b64_tr_b16 a[72:73], v134 offset:49152
  buffer_load_dwordx4 v[220:223], v142, s[28:31], s45 offen sc1
  v_fma_f32 v208, v208, v144, v152
  v_mfma_f32_16x16x32_bf16 v[28:31], a[76:79], v[164:167], v[28:31]
  ds_read_b64_tr_b16 a[74:75], v134 offset:51200
  ds_read_b128 v[248:251], v140 offset:1408
  v_fma_f32 v209, v209, v145, v153
  v_mfma_f32_16x16x32_bf16 v[32:35], a[80:83], v[160:163], v[32:35]
  ds_read_b64_tr_b16 a[76:77], v135 offset:49152
  v_lshlrev_b32 v212, 16, v226
  v_and_b32 v213, 0xffff0000, v226
  v_mfma_f32_16x16x32_bf16 v[36:39], a[80:83], v[164:167], v[36:39]
  s_add_u32 m0, s40, 0x4000
  s_mov_b32 s44, 0x4000
  ds_read_b64_tr_b16 a[78:79], v135 offset:51200
  ds_read_b128 v[252:255], v140 offset:1424
  v_fma_f32 v210, v210, v146, v154
  v_mfma_f32_16x16x32_bf16 v[40:43], a[84:87], v[160:163], v[40:43]
  ds_read_b64_tr_b16 a[80:81], v136 offset:49152
  buffer_load_dwordx4 v182, s[16:19], s44 offen offset:0 nt lds
  v_fma_f32 v211, v211, v147, v155
  v_mfma_f32_16x16x32_bf16 v[44:47], a[84:87], v[164:167], v[44:47]
  ds_read_b64_tr_b16 a[82:83], v136 offset:51200
  v_cvt_pk_bf16_f32 v192, v208, v209
  v_lshlrev_b32 v214, 16, v227
  v_mfma_f32_16x16x32_bf16 v[48:51], a[88:91], v[160:163], v[48:51]
  s_waitcnt lgkmcnt(8)
  ds_read_b64_tr_b16 a[84:85], v137 offset:49152
  v_and_b32 v215, 0xffff0000, v227
  v_mfma_f32_16x16x32_bf16 v[52:55], a[88:91], v[164:167], v[52:55]
  ds_read_b64_tr_b16 a[86:87], v137 offset:51200
  v_fma_f32 v212, v212, v148, v156
  v_fma_f32 v213, v213, v149, v157
  v_mfma_f32_16x16x32_bf16 v[56:59], a[92:95], v[160:163], v[56:59]
  ds_read_b64_tr_b16 a[88:89], v138 offset:49152
  buffer_load_dwordx4 v183, s[16:19], s44 offen offset:1024 nt lds
  v_cvt_pk_bf16_f32 v193, v210, v211
  v_mfma_f32_16x16x32_bf16 v[60:63], a[92:95], v[164:167], v[60:63]
  ds_read_b64_tr_b16 a[90:91], v138 offset:51200
  v_lshlrev_b32 v208, 16, v228
  v_and_b32 v209, 0xffff0000, v228
  v_mfma_f32_16x16x32_bf16 v[64:67], a[96:99], v[160:163], v[64:67]
  ds_read_b64_tr_b16 a[92:93], v139 offset:49152
  v_fma_f32 v214, v214, v150, v158
  v_fma_f32 v215, v215, v151, v159
  v_mfma_f32_16x16x32_bf16 v[68:71], a[96:99], v[164:167], v[68:71]
  ds_read_b64_tr_b16 a[94:95], v139 offset:51200
  v_cvt_pk_bf16_f32 v194, v212, v213
  v_lshlrev_b32 v210, 16, v229
  v_mfma_f32_16x16x32_bf16 v[72:75], a[100:103], v[160:163], v[72:75]
  ds_read_b64_tr_b16 a[96:97], v132 offset:49408
  buffer_load_dwordx4 v184, s[16:19], s44 offen offset:2048 nt lds
  v_and_b32 v211, 0xffff0000, v229
  v_mfma_f32_16x16x32_bf16 v[76:79], a[100:103], v[164:167], v[76:79]
  ds_read_b64_tr_b16 a[98:99], v132 offset:51456
  v_fma_f32 v208, v208, v144, v152
  v_fma_f32 v209, v209, v145, v153
  v_mfma_f32_16x16x32_bf16 v[80:83], a[104:107], v[160:163], v[80:83]
  s_waitcnt lgkmcnt(8)
  ds_read_b64_tr_b16 a[100:101], v133 offset:49408
  v_cvt_pk_bf16_f32 v195, v214, v215
  v_mfma_f32_16x16x32_bf16 v[84:87], a[104:107], v[164:167], v[84:87]
  ds_read_b64_tr_b16 a[102:103], v133 offset:51456
  v_lshlrev_b32 v212, 16, v230
  v_and_b32 v213, 0xffff0000, v230
  v_mfma_f32_16x16x32_bf16 v[88:91], a[108:111], v[160:163], v[88:91]
  ds_read_b64_tr_b16 a[104:105], v134 offset:49408
  buffer_load_dwordx4 v185, s[16:19], s44 offen offset:3072 nt lds
  v_mfma_f32_16x16x32_bf16 v[92:95], a[108:111], v[164:167], v[92:95]
  ds_read_b64_tr_b16 a[106:107], v134 offset:51456
  v_fma_f32 v210, v210, v146, v154
  v_fma_f32 v211, v211, v147, v155
  v_mfma_f32_16x16x32_bf16 v[96:99], a[112:115], v[160:163], v[96:99]
  ds_read_b64_tr_b16 a[108:109], v135 offset:49408
  v_cvt_pk_bf16_f32 v196, v208, v209
  v_lshlrev_b32 v214, 16, v231
  v_mfma_f32_16x16x32_bf16 v[100:103], a[112:115], v[164:167], v[100:103]
  ds_read_b64_tr_b16 a[110:111], v135 offset:51456
  v_and_b32 v215, 0xffff0000, v231
  v_fma_f32 v212, v212, v148, v156
  v_mfma_f32_16x16x32_bf16 v[104:107], a[116:119], v[160:163], v[104:107]
  ds_read_b64_tr_b16 a[112:113], v136 offset:49408
  v_fma_f32 v213, v213, v149, v157
  v_cvt_pk_bf16_f32 v197, v210, v211
  v_mfma_f32_16x16x32_bf16 v[108:111], a[116:119], v[164:167], v[108:111]
  ds_read_b64_tr_b16 a[114:115], v136 offset:51456
  v_fma_f32 v214, v214, v150, v158
  v_fma_f32 v215, v215, v151, v159
  v_mfma_f32_16x16x32_bf16 v[112:115], a[120:123], v[160:163], v[112:115]
  s_waitcnt lgkmcnt(8)
  ds_read_b64_tr_b16 a[116:117], v137 offset:49408
  v_mfma_f32_16x16x32_bf16 v[116:119], a[120:123], v[164:167], v[116:119]
  ds_read_b64_tr_b16 a[118:119], v137 offset:51456
  v_cvt_pk_bf16_f32 v198, v212, v213
  v_cvt_pk_bf16_f32 v199, v214, v215
  v_mfma_f32_16x16x32_bf16 v[120:123], a[124:127], v[160:163], v[120:123]
  ds_read_b64_tr_b16 a[120:121], v138 offset:49408
  v_mfma_f32_16x16x32_bf16 v[124:127], a[124:127], v[164:167], v[124:127]
  ds_read_b64_tr_b16 a[122:123], v138 offset:51456
  v_mfma_f32_16x16x32_bf16 v[0:3], a[64:67], v[192:195], v[0:3]
  ds_read_b64_tr_b16 a[124:125], v139 offset:49408
  v_mfma_f32_16x16x32_bf16 v[4:7], a[64:67], v[196:199], v[4:7]
  ds_read_b64_tr_b16 a[126:127], v139 offset:51456
  s_waitcnt vmcnt(14)
  s_barrier
  v_mfma_f32_16x16x32_bf16 v[8:11], a[68:71], v[192:195], v[8:11]
  ds_read_b64_tr_b16 a[64:65], v200 offset:16384
  s_mov_b32 s45, 13312
  buffer_load_dwordx4 v[224:227], v141, s[28:31], s45 offen sc1
  v_mfma_f32_16x16x32_bf16 v[12:15], a[68:71], v[196:199], v[12:15]
  ds_read_b64_tr_b16 a[66:67], v200 offset:18432
  ds_read_b128 v[144:147], v140 offset:3328
  v_mfma_f32_16x16x32_bf16 v[16:19], a[72:75], v[192:195], v[16:19]
  s_waitcnt lgkmcnt(8)
  ds_read_b64_tr_b16 a[68:69], v201 offset:16384
  v_mfma_f32_16x16x32_bf16 v[20:23], a[72:75], v[196:199], v[20:23]
  ds_read_b64_tr_b16 a[70:71], v201 offset:18432
  ds_read_b128 v[148:151], v140 offset:3344
  v_mfma_f32_16x16x32_bf16 v[24:27], a[76:79], v[192:195], v[24:27]
  ds_read_b64_tr_b16 a[72:73], v202 offset:16384
  buffer_load_dwordx4 v[228:231], v142, s[28:31], s45 offen sc1
  v_mfma_f32_16x16x32_bf16 v[28:31], a[76:79], v[196:199], v[28:31]
  ds_read_b64_tr_b16 a[74:75], v202 offset:18432
  ds_read_b128 v[152:155], v140 offset:1536
  v_mfma_f32_16x16x32_bf16 v[32:35], a[80:83], v[192:195], v[32:35]
  ds_read_b64_tr_b16 a[76:77], v203 offset:16384
  v_mfma_f32_16x16x32_bf16 v[36:39], a[80:83], v[196:199], v[36:39]
  s_add_u32 m0, s40, 0x8000
  s_mov_b32 s44, 0x8000
  ds_read_b64_tr_b16 a[78:79], v203 offset:18432
  ds_read_b128 v[156:159], v140 offset:1552
  v_mfma_f32_16x16x32_bf16 v[40:43], a[84:87], v[192:195], v[40:43]
  ds_read_b64_tr_b16 a[80:81], v204 offset:16384
  buffer_load_dwordx4 v182, s[16:19], s44 offen offset:0 nt lds
  v_lshlrev_b32 v208, 16, v232
  v_mfma_f32_16x16x32_bf16 v[44:47], a[84:87], v[196:199], v[44:47]
  ds_read_b64_tr_b16 a[82:83], v204 offset:18432
  v_and_b32 v209, 0xffff0000, v232
  v_lshlrev_b32 v210, 16, v233
  v_and_b32 v211, 0xffff0000, v233
  v_mfma_f32_16x16x32_bf16 v[48:51], a[88:91], v[192:195], v[48:51]
  s_waitcnt lgkmcnt(8)
  ds_read_b64_tr_b16 a[84:85], v205 offset:16384
  v_fma_f32 v208, v208, v240, v248
  v_mfma_f32_16x16x32_bf16 v[52:55], a[88:91], v[196:199], v[52:55]
  ds_read_b64_tr_b16 a[86:87], v205 offset:18432
  v_fma_f32 v209, v209, v241, v249
  v_lshlrev_b32 v212, 16, v234
  v_and_b32 v213, 0xffff0000, v234
  v_mfma_f32_16x16x32_bf16 v[56:59], a[92:95], v[192:195], v[56:59]
  ds_read_b64_tr_b16 a[88:89], v206 offset:16384
  buffer_load_dwordx4 v183, s[16:19], s44 offen offset:1024 nt lds
  v_fma_f32 v210, v210, v242, v250
  v_mfma_f32_16x16x32_bf16 v[60:63], a[92:95], v[196:199], v[60:63]
  ds_read_b64_tr_b16 a[90:91], v206 offset:18432
  v_fma_f32 v211, v211, v243, v251
  v_cvt_pk_bf16_f32 v160, v208, v209
  v_lshlrev_b32 v214, 16, v235
  v_mfma_f32_16x16x32_bf16 v[64:67], a[96:99], v[192:195], v[64:67]
  ds_read_b64_tr_b16 a[92:93], v207 offset:16384
  v_and_b32 v215, 0xffff0000, v235
  v_fma_f32 v212, v212, v244, v252
  v_fma_f32 v213, v213, v245, v253
  v_mfma_f32_16x16x32_bf16 v[68:71], a[96:99], v[196:199], v[68:71]
  ds_read_b64_tr_b16 a[94:95], v207 offset:18432
  v_cvt_pk_bf16_f32 v161, v210, v211
  v_lshlrev_b32 v208, 16, v236
  v_and_b32 v209, 0xffff0000, v236
  v_mfma_f32_16x16x32_bf16 v[72:75], a[100:103], v[192:195], v[72:75]
  ds_read_b64_tr_b16 a[96:97], v200 offset:16640
  buffer_load_dwordx4 v184, s[16:19], s44 offen offset:2048 nt lds
  v_fma_f32 v214, v214, v246, v254
  v_mfma_f32_16x16x32_bf16 v[76:79], a[100:103], v[196:199], v[76:79]
  ds_read_b64_tr_b16 a[98:99], v200 offset:18688
  v_fma_f32 v215, v215, v247, v255
  v_cvt_pk_bf16_f32 v162, v212, v213
  v_lshlrev_b32 v210, 16, v237
  v_mfma_f32_16x16x32_bf16 v[80:83], a[104:107], v[192:195], v[80:83]
  s_waitcnt lgkmcnt(8)
  ds_read_b64_tr_b16 a[100:101], v201 offset:16640
  v_and_b32 v211, 0xffff0000, v237
  v_mfma_f32_16x16x32_bf16 v[84:87], a[104:107], v[196:199], v[84:87]
  ds_read_b64_tr_b16 a[102:103], v201 offset:18688
  v_fma_f32 v208, v208, v240, v248
  v_fma_f32 v209, v209, v241, v249
  v_cvt_pk_bf16_f32 v163, v214, v215
  v_mfma_f32_16x16x32_bf16 v[88:91], a[108:111], v[192:195], v[88:91]
  ds_read_b64_tr_b16 a[104:105], v202 offset:16640
  buffer_load_dwordx4 v185, s[16:19], s44 offen offset:3072 nt lds
  v_lshlrev_b32 v212, 16, v238
  v_mfma_f32_16x16x32_bf16 v[92:95], a[108:111], v[196:199], v[92:95]
  ds_read_b64_tr_b16 a[106:107], v202 offset:18688
  v_and_b32 v213, 0xffff0000, v238
  v_fma_f32 v210, v210, v242, v250
  v_mfma_f32_16x16x32_bf16 v[96:99], a[112:115], v[192:195], v[96:99]
  ds_read_b64_tr_b16 a[108:109], v203 offset:16640
  v_fma_f32 v211, v211, v243, v251
  v_cvt_pk_bf16_f32 v164, v208, v209
  v_mfma_f32_16x16x32_bf16 v[100:103], a[112:115], v[196:199], v[100:103]
  ds_read_b64_tr_b16 a[110:111], v203 offset:18688
  v_lshlrev_b32 v214, 16, v239
  v_and_b32 v215, 0xffff0000, v239
  v_mfma_f32_16x16x32_bf16 v[104:107], a[116:119], v[192:195], v[104:107]
  ds_read_b64_tr_b16 a[112:113], v204 offset:16640
  v_fma_f32 v212, v212, v244, v252
  v_fma_f32 v213, v213, v245, v253
  v_mfma_f32_16x16x32_bf16 v[108:111], a[116:119], v[196:199], v[108:111]
  ds_read_b64_tr_b16 a[114:115], v204 offset:18688
  v_cvt_pk_bf16_f32 v165, v210, v211
  v_fma_f32 v214, v214, v246, v254
  v_mfma_f32_16x16x32_bf16 v[112:115], a[120:123], v[192:195], v[112:115]
  s_waitcnt lgkmcnt(8)
  ds_read_b64_tr_b16 a[116:117], v205 offset:16640
  v_fma_f32 v215, v215, v247, v255
  v_mfma_f32_16x16x32_bf16 v[116:119], a[120:123], v[196:199], v[116:119]
  ds_read_b64_tr_b16 a[118:119], v205 offset:18688
  v_cvt_pk_bf16_f32 v166, v212, v213
  v_cvt_pk_bf16_f32 v167, v214, v215
  v_mfma_f32_16x16x32_bf16 v[120:123], a[124:127], v[192:195], v[120:123]
  ds_read_b64_tr_b16 a[120:121], v206 offset:16640
  v_mfma_f32_16x16x32_bf16 v[124:127], a[124:127], v[196:199], v[124:127]
  ds_read_b64_tr_b16 a[122:123], v206 offset:18688
  v_mfma_f32_16x16x32_bf16 v[0:3], a[64:67], v[160:163], v[0:3]
  ds_read_b64_tr_b16 a[124:125], v207 offset:16640
  v_mfma_f32_16x16x32_bf16 v[4:7], a[64:67], v[164:167], v[4:7]
  ds_read_b64_tr_b16 a[126:127], v207 offset:18688
  s_waitcnt vmcnt(10)
  v_mfma_f32_16x16x32_bf16 v[8:11], a[68:71], v[160:163], v[8:11]
  ds_read_b64_tr_b16 a[64:65], v200 offset:32768
  v_lshlrev_b32 v208, 16, v216
  v_and_b32 v209, 0xffff0000, v216
  v_mfma_f32_16x16x32_bf16 v[12:15], a[68:71], v[164:167], v[12:15]
  ds_read_b64_tr_b16 a[66:67], v200 offset:34816
  ds_read_b128 v[240:243], v140 offset:3456
  v_lshlrev_b32 v210, 16, v217
  v_mfma_f32_16x16x32_bf16 v[16:19], a[72:75], v[160:163], v[16:19]
  s_waitcnt lgkmcnt(8)
  ds_read_b64_tr_b16 a[68:69], v201 offset:32768
  v_and_b32 v211, 0xffff0000, v217
  v_mfma_f32_16x16x32_bf16 v[20:23], a[72:75], v[164:167], v[20:23]
  ds_read_b64_tr_b16 a[70:71], v201 offset:34816
  ds_read_b128 v[244:247], v140 offset:3472
  v_fma_f32 v208, v208, v144, v152
  v_mfma_f32_16x16x32_bf16 v[24:27], a[76:79], v[160:163], v[24:27]
  ds_read_b64_tr_b16 a[72:73], v202 offset:32768
  v_fma_f32 v209, v209, v145, v153
  v_lshlrev_b32 v212, 16, v218
  v_mfma_f32_16x16x32_bf16 v[28:31], a[76:79], v[164:167], v[28:31]
  ds_read_b64_tr_b16 a[74:75], v202 offset:34816
  ds_read_b128 v[248:251], v140 offset:1664
  v_and_b32 v213, 0xffff0000, v218
  v_mfma_f32_16x16x32_bf16 v[32:35], a[80:83], v[160:163], v[32:35]
  ds_read_b64_tr_b16 a[76:77], v203 offset:32768
  v_fma_f32 v210, v210, v146, v154
  v_fma_f32 v211, v211, v147, v155
  v_mfma_f32_16x16x32_bf16 v[36:39], a[80:83], v[164:167], v[36:39]
  s_add_u32 m0, s40, 0x10000
  s_mov_b32 s44, 0x0
  ds_read_b64_tr_b16 a[78:79], v203 offset:34816
  ds_read_b128 v[252:255], v140 offset:1680
  v_cvt_pk_bf16_f32 v192, v208, v209
  v_mfma_f32_16x16x32_bf16 v[40:43], a[84:87], v[160:163], v[40:43]
  ds_read_b64_tr_b16 a[80:81], v204 offset:32768
  buffer_load_dwordx4 v186, s[20:23], s44 offen offset:0 nt lds
  v_lshlrev_b32 v214, 16, v219
  v_mfma_f32_16x16x32_bf16 v[44:47], a[84:87], v[164:167], v[44:47]
  ds_read_b64_tr_b16 a[82:83], v204 offset:34816
  v_and_b32 v215, 0xffff0000, v219
  v_fma_f32 v212, v212, v148, v156
  v_mfma_f32_16x16x32_bf16 v[48:51], a[88:91], v[160:163], v[48:51]
  s_waitcnt lgkmcnt(8)
  ds_read_b64_tr_b16 a[84:85], v205 offset:32768
  v_fma_f32 v213, v213, v149, v157
  v_mfma_f32_16x16x32_bf16 v[52:55], a[88:91], v[164:167], v[52:55]
  ds_read_b64_tr_b16 a[86:87], v205 offset:34816
  v_cvt_pk_bf16_f32 v193, v210, v211
  v_lshlrev_b32 v208, 16, v220
  v_mfma_f32_16x16x32_bf16 v[56:59], a[92:95], v[160:163], v[56:59]
  ds_read_b64_tr_b16 a[88:89], v206 offset:32768
  buffer_load_dwordx4 v187, s[20:23], s44 offen offset:1024 nt lds
  v_and_b32 v209, 0xffff0000, v220
  v_mfma_f32_16x16x32_bf16 v[60:63], a[92:95], v[164:167], v[60:63]
  ds_read_b64_tr_b16 a[90:91], v206 offset:34816
  v_fma_f32 v214, v214, v150, v158
  v_fma_f32 v215, v215, v151, v159
  v_mfma_f32_16x16x32_bf16 v[64:67], a[96:99], v[160:163], v[64:67]
  ds_read_b64_tr_b16 a[92:93], v207 offset:32768
  v_cvt_pk_bf16_f32 v194, v212, v213
  v_lshlrev_b32 v210, 16, v221
  v_mfma_f32_16x16x32_bf16 v[68:71], a[96:99], v[164:167], v[68:71]
  ds_read_b64_tr_b16 a[94:95], v207 offset:34816
  v_and_b32 v211, 0xffff0000, v221
  v_fma_f32 v208, v208, v144, v152
  v_mfma_f32_16x16x32_bf16 v[72:75], a[100:103], v[160:163], v[72:75]
  ds_read_b64_tr_b16 a[96:97], v200 offset:33024
  buffer_load_dwordx4 v188, s[20:23], s44 offen offset:2048 nt lds
  v_mfma_f32_16x16x32_bf16 v[76:79], a[100:103], v[164:167], v[76:79]
  ds_read_b64_tr_b16 a[98:99], v200 offset:35072
  v_fma_f32 v209, v209, v145, v153
  v_cvt_pk_bf16_f32 v195, v214, v215
  v_mfma_f32_16x16x32_bf16 v[80:83], a[104:107], v[160:163], v[80:83]
  s_waitcnt lgkmcnt(8)
  ds_read_b64_tr_b16 a[100:101], v201 offset:33024
  v_mfma_f32_16x16x32_bf16 v[84:87], a[104:107], v[164:167], v[84:87]
  ds_read_b64_tr_b16 a[102:103], v201 offset:35072
  v_lshlrev_b32 v212, 16, v222
  v_and_b32 v213, 0xffff0000, v222
  v_mfma_f32_16x16x32_bf16 v[88:91], a[108:111], v[160:163], v[88:91]
  ds_read_b64_tr_b16 a[104:105], v202 offset:33024
  buffer_load_dwordx4 v189, s[20:23], s44 offen offset:3072 nt lds
  v_mfma_f32_16x16x32_bf16 v[92:95], a[108:111], v[164:167], v[92:95]
  ds_read_b64_tr_b16 a[106:107], v202 offset:35072
  v_fma_f32 v210, v210, v146, v154
  v_fma_f32 v211, v211, v147, v155
  v_mfma_f32_16x16x32_bf16 v[96:99], a[112:115], v[160:163], v[96:99]
  ds_read_b64_tr_b16 a[108:109], v203 offset:33024
  v_cvt_pk_bf16_f32 v196, v208, v209
  v_lshlrev_b32 v214, 16, v223
  v_mfma_f32_16x16x32_bf16 v[100:103], a[112:115], v[164:167], v[100:103]
  ds_read_b64_tr_b16 a[110:111], v203 offset:35072
  v_and_b32 v215, 0xffff0000, v223
  v_fma_f32 v212, v212, v148, v156
  v_mfma_f32_16x16x32_bf16 v[104:107], a[116:119], v[160:163], v[104:107]
  ds_read_b64_tr_b16 a[112:113], v204 offset:33024
  v_fma_f32 v213, v213, v149, v157
  v_cvt_pk_bf16_f32 v197, v210, v211
  v_mfma_f32_16x16x32_bf16 v[108:111], a[116:119], v[164:167], v[108:111]
  ds_read_b64_tr_b16 a[114:115], v204 offset:35072
  v_fma_f32 v214, v214, v150, v158
  v_fma_f32 v215, v215, v151, v159
  v_mfma_f32_16x16x32_bf16 v[112:115], a[120:123], v[160:163], v[112:115]
  s_waitcnt lgkmcnt(8)
  ds_read_b64_tr_b16 a[116:117], v205 offset:33024
  v_mfma_f32_16x16x32_bf16 v[116:119], a[120:123], v[164:167], v[116:119]
  ds_read_b64_tr_b16 a[118:119], v205 offset:35072
  v_cvt_pk_bf16_f32 v198, v212, v213
  v_cvt_pk_bf16_f32 v199, v214, v215
  v_mfma_f32_16x16x32_bf16 v[120:123], a[124:127], v[160:163], v[120:123]
  ds_read_b64_tr_b16 a[120:121], v206 offset:33024
  v_mfma_f32_16x16x32_bf16 v[124:127], a[124:127], v[164:167], v[124:127]
  ds_read_b64_tr_b16 a[122:123], v206 offset:35072
  v_mfma_f32_16x16x32_bf16 v[0:3], a[64:67], v[192:195], v[0:3]
  ds_read_b64_tr_b16 a[124:125], v207 offset:33024
  v_mfma_f32_16x16x32_bf16 v[4:7], a[64:67], v[196:199], v[4:7]
  ds_read_b64_tr_b16 a[126:127], v207 offset:35072
  s_waitcnt vmcnt(8)
  s_barrier
  v_mfma_f32_16x16x32_bf16 v[8:11], a[68:71], v[192:195], v[8:11]
  ds_read_b64_tr_b16 a[64:65], v200 offset:49152
  v_mfma_f32_16x16x32_bf16 v[12:15], a[68:71], v[196:199], v[12:15]
  ds_read_b64_tr_b16 a[66:67], v200 offset:51200
  v_mfma_f32_16x16x32_bf16 v[16:19], a[72:75], v[192:195], v[16:19]
  s_waitcnt lgkmcnt(8)
  ds_read_b64_tr_b16 a[68:69], v201 offset:49152
  v_mfma_f32_16x16x32_bf16 v[20:23], a[72:75], v[196:199], v[20:23]
  ds_read_b64_tr_b16 a[70:71], v201 offset:51200
  v_mfma_f32_16x16x32_bf16 v[24:27], a[76:79], v[192:195], v[24:27]
  ds_read_b64_tr_b16 a[72:73], v202 offset:49152
  v_mfma_f32_16x16x32_bf16 v[28:31], a[76:79], v[196:199], v[28:31]
  ds_read_b64_tr_b16 a[74:75], v202 offset:51200
  v_mfma_f32_16x16x32_bf16 v[32:35], a[80:83], v[192:195], v[32:35]
  ds_read_b64_tr_b16 a[76:77], v203 offset:49152
  v_mfma_f32_16x16x32_bf16 v[36:39], a[80:83], v[196:199], v[36:39]
  s_add_u32 m0, s40, 0xc000
  s_mov_b32 s44, 0xc000
  ds_read_b64_tr_b16 a[78:79], v203 offset:51200
  v_mfma_f32_16x16x32_bf16 v[40:43], a[84:87], v[192:195], v[40:43]
  ds_read_b64_tr_b16 a[80:81], v204 offset:49152
  buffer_load_dwordx4 v182, s[16:19], s44 offen offset:0 nt lds
  v_lshlrev_b32 v208, 16, v224
  v_mfma_f32_16x16x32_bf16 v[44:47], a[84:87], v[196:199], v[44:47]
  ds_read_b64_tr_b16 a[82:83], v204 offset:51200
  v_and_b32 v209, 0xffff0000, v224
  v_lshlrev_b32 v210, 16, v225
  v_and_b32 v211, 0xffff0000, v225
  v_mfma_f32_16x16x32_bf16 v[48:51], a[88:91], v[192:195], v[48:51]
  s_waitcnt lgkmcnt(8)
  ds_read_b64_tr_b16 a[84:85], v205 offset:49152
  v_fma_f32 v208, v208, v240, v248
  v_mfma_f32_16x16x32_bf16 v[52:55], a[88:91], v[196:199], v[52:55]
  ds_read_b64_tr_b16 a[86:87], v205 offset:51200
  v_fma_f32 v209, v209, v241, v249
  v_lshlrev_b32 v212, 16, v226
  v_and_b32 v213, 0xffff0000, v226
  v_mfma_f32_16x16x32_bf16 v[56:59], a[92:95], v[192:195], v[56:59]
  ds_read_b64_tr_b16 a[88:89], v206 offset:49152
  buffer_load_dwordx4 v183, s[16:19], s44 offen offset:1024 nt lds
  v_fma_f32 v210, v210, v242, v250
  v_mfma_f32_16x16x32_bf16 v[60:63], a[92:95], v[196:199], v[60:63]
  ds_read_b64_tr_b16 a[90:91], v206 offset:51200
  v_fma_f32 v211, v211, v243, v251
  v_cvt_pk_bf16_f32 v160, v208, v209
  v_lshlrev_b32 v214, 16, v227
  v_mfma_f32_16x16x32_bf16 v[64:67], a[96:99], v[192:195], v[64:67]
  ds_read_b64_tr_b16 a[92:93], v207 offset:49152
  v_and_b32 v215, 0xffff0000, v227
  v_fma_f32 v212, v212, v244, v252
  v_fma_f32 v213, v213, v245, v253
  v_mfma_f32_16x16x32_bf16 v[68:71], a[96:99], v[196:199], v[68:71]
  ds_read_b64_tr_b16 a[94:95], v207 offset:51200
  v_cvt_pk_bf16_f32 v161, v210, v211
  v_lshlrev_b32 v208, 16, v228
  v_and_b32 v209, 0xffff0000, v228
  v_mfma_f32_16x16x32_bf16 v[72:75], a[100:103], v[192:195], v[72:75]
  ds_read_b64_tr_b16 a[96:97], v200 offset:49408
  buffer_load_dwordx4 v184, s[16:19], s44 offen offset:2048 nt lds
  v_fma_f32 v214, v214, v246, v254
  v_mfma_f32_16x16x32_bf16 v[76:79], a[100:103], v[196:199], v[76:79]
  ds_read_b64_tr_b16 a[98:99], v200 offset:51456
  v_fma_f32 v215, v215, v247, v255
  v_cvt_pk_bf16_f32 v162, v212, v213
  v_lshlrev_b32 v210, 16, v229
  v_mfma_f32_16x16x32_bf16 v[80:83], a[104:107], v[192:195], v[80:83]
  s_waitcnt lgkmcnt(8)
  ds_read_b64_tr_b16 a[100:101], v201 offset:49408
  v_and_b32 v211, 0xffff0000, v229
  v_mfma_f32_16x16x32_bf16 v[84:87], a[104:107], v[196:199], v[84:87]
  ds_read_b64_tr_b16 a[102:103], v201 offset:51456
  v_fma_f32 v208, v208, v240, v248
  v_fma_f32 v209, v209, v241, v249
  v_cvt_pk_bf16_f32 v163, v214, v215
  v_mfma_f32_16x16x32_bf16 v[88:91], a[108:111], v[192:195], v[88:91]
  ds_read_b64_tr_b16 a[104:105], v202 offset:49408
  buffer_load_dwordx4 v185, s[16:19], s44 offen offset:3072 nt lds
  v_lshlrev_b32 v212, 16, v230
  v_mfma_f32_16x16x32_bf16 v[92:95], a[108:111], v[196:199], v[92:95]
  ds_read_b64_tr_b16 a[106:107], v202 offset:51456
  v_and_b32 v213, 0xffff0000, v230
  v_fma_f32 v210, v210, v242, v250
  v_mfma_f32_16x16x32_bf16 v[96:99], a[112:115], v[192:195], v[96:99]
  ds_read_b64_tr_b16 a[108:109], v203 offset:49408
  v_fma_f32 v211, v211, v243, v251
  v_cvt_pk_bf16_f32 v164, v208, v209
  v_mfma_f32_16x16x32_bf16 v[100:103], a[112:115], v[196:199], v[100:103]
  ds_read_b64_tr_b16 a[110:111], v203 offset:51456
  v_lshlrev_b32 v214, 16, v231
  v_and_b32 v215, 0xffff0000, v231
  v_mfma_f32_16x16x32_bf16 v[104:107], a[116:119], v[192:195], v[104:107]
  ds_read_b64_tr_b16 a[112:113], v204 offset:49408
  v_fma_f32 v212, v212, v244, v252
  v_fma_f32 v213, v213, v245, v253
  v_mfma_f32_16x16x32_bf16 v[108:111], a[116:119], v[196:199], v[108:111]
  ds_read_b64_tr_b16 a[114:115], v204 offset:51456
  v_cvt_pk_bf16_f32 v165, v210, v211
  v_fma_f32 v214, v214, v246, v254
  v_mfma_f32_16x16x32_bf16 v[112:115], a[120:123], v[192:195], v[112:115]
  s_waitcnt lgkmcnt(8)
  ds_read_b64_tr_b16 a[116:117], v205 offset:49408
  v_fma_f32 v215, v215, v247, v255
  v_mfma_f32_16x16x32_bf16 v[116:119], a[120:123], v[196:199], v[116:119]
  ds_read_b64_tr_b16 a[118:119], v205 offset:51456
  v_cvt_pk_bf16_f32 v166, v212, v213
  v_cvt_pk_bf16_f32 v167, v214, v215
  v_mfma_f32_16x16x32_bf16 v[120:123], a[124:127], v[192:195], v[120:123]
  ds_read_b64_tr_b16 a[120:121], v206 offset:49408
  v_mfma_f32_16x16x32_bf16 v[124:127], a[124:127], v[196:199], v[124:127]
  ds_read_b64_tr_b16 a[122:123], v206 offset:51456
  v_mfma_f32_16x16x32_bf16 v[0:3], a[64:67], v[160:163], v[0:3]
  ds_read_b64_tr_b16 a[124:125], v207 offset:49408
  v_mfma_f32_16x16x32_bf16 v[4:7], a[64:67], v[164:167], v[4:7]
  ds_read_b64_tr_b16 a[126:127], v207 offset:51456
  v_mfma_f32_16x16x32_bf16 v[8:11], a[68:71], v[160:163], v[8:11]
  ds_read_b128 a[0:3], v170 offset:0
  v_mfma_f32_16x16x32_bf16 v[12:15], a[68:71], v[164:167], v[12:15]
  ds_read_b128 a[4:7], v171 offset:0
  v_mfma_f32_16x16x32_bf16 v[16:19], a[72:75], v[160:163], v[16:19]
  s_waitcnt lgkmcnt(8)
  ds_read_b128 a[8:11], v172 offset:0
  v_mfma_f32_16x16x32_bf16 v[20:23], a[72:75], v[164:167], v[20:23]
  ds_read_b128 a[12:15], v173 offset:0
  v_mfma_f32_16x16x32_bf16 v[24:27], a[76:79], v[160:163], v[24:27]
  ds_read_b128 a[16:19], v170 offset:256
  v_mfma_f32_16x16x32_bf16 v[28:31], a[76:79], v[164:167], v[28:31]
  ds_read_b128 a[20:23], v171 offset:256
  v_mfma_f32_16x16x32_bf16 v[32:35], a[80:83], v[160:163], v[32:35]
  ds_read_b128 a[24:27], v172 offset:256
  v_cvt_pk_bf16_f32 v192, v0, v1
  v_mfma_f32_16x16x32_bf16 v[36:39], a[80:83], v[164:167], v[36:39]
  s_add_u32 m0, s40, 0x14000
  s_mov_b32 s44, 0x4000
  ds_read_b128 a[28:31], v173 offset:256
  v_cvt_pk_bf16_f32 v193, v2, v3
  v_mfma_f32_16x16x32_bf16 v[40:43], a[84:87], v[160:163], v[40:43]
  ds_read_b128 a[32:35], v170 offset:8192
  buffer_load_dwordx4 v186, s[20:23], s44 offen offset:0 nt lds
  v_cvt_pk_bf16_f32 v194, v8, v9
  v_mfma_f32_16x16x32_bf16 v[44:47], a[84:87], v[164:167], v[44:47]
  ds_read_b128 a[36:39], v171 offset:8192
  v_cvt_pk_bf16_f32 v195, v10, v11
  v_mfma_f32_16x16x32_bf16 v[48:51], a[88:91], v[160:163], v[48:51]
  s_waitcnt lgkmcnt(8)
  ds_read_b128 a[40:43], v172 offset:8192
  v_cvt_pk_bf16_f32 v196, v4, v5
  v_mfma_f32_16x16x32_bf16 v[52:55], a[88:91], v[164:167], v[52:55]
  ds_read_b128 a[44:47], v173 offset:8192
  v_cvt_pk_bf16_f32 v197, v6, v7
  v_mfma_f32_16x16x32_bf16 v[56:59], a[92:95], v[160:163], v[56:59]
  ds_read_b128 a[48:51], v170 offset:8448
  buffer_load_dwordx4 v187, s[20:23], s44 offen offset:1024 nt lds
  v_cvt_pk_bf16_f32 v198, v12, v13
  v_mfma_f32_16x16x32_bf16 v[60:63], a[92:95], v[164:167], v[60:63]
  ds_read_b128 a[52:55], v171 offset:8448
  v_cvt_pk_bf16_f32 v199, v14, v15
  v_mfma_f32_16x16x32_bf16 v[64:67], a[96:99], v[160:163], v[64:67]
  ds_read_b128 a[56:59], v172 offset:8448
  v_permlane32_swap_b32 v192, v194
  v_mfma_f32_16x16x32_bf16 v[68:71], a[96:99], v[164:167], v[68:71]
  ds_read_b128 a[60:63], v173 offset:8448
  v_permlane32_swap_b32 v193, v195
  v_mfma_f32_16x16x32_bf16 v[72:75], a[100:103], v[160:163], v[72:75]
  buffer_load_dwordx4 v188, s[20:23], s44 offen offset:2048 nt lds
  v_permlane32_swap_b32 v196, v198
  v_permlane32_swap_b32 v197, v199
  v_permlane16_swap_b32 v192, v194
  v_mfma_f32_16x16x32_bf16 v[76:79], a[100:103], v[164:167], v[76:79]
  v_permlane16_swap_b32 v193, v195
  v_permlane16_swap_b32 v196, v198
  v_permlane16_swap_b32 v197, v199
  v_mfma_f32_16x16x32_bf16 v[80:83], a[104:107], v[160:163], v[80:83]
  s_waitcnt lgkmcnt(8)
  v_cvt_pk_bf16_f32 v200, v16, v17
  v_cvt_pk_bf16_f32 v201, v18, v19
  v_cvt_pk_bf16_f32 v202, v24, v25
  v_mfma_f32_16x16x32_bf16 v[84:87], a[104:107], v[164:167], v[84:87]
  v_cvt_pk_bf16_f32 v203, v26, v27
  v_cvt_pk_bf16_f32 v204, v20, v21
  v_cvt_pk_bf16_f32 v205, v22, v23
  v_mfma_f32_16x16x32_bf16 v[88:91], a[108:111], v[160:163], v[88:91]
  buffer_load_dwordx4 v189, s[20:23], s44 offen offset:3072 nt lds
  v_cvt_pk_bf16_f32 v206, v28, v29
  v_cvt_pk_bf16_f32 v207, v30, v31
  v_permlane32_swap_b32 v200, v202
  v_mfma_f32_16x16x32_bf16 v[92:95], a[108:111], v[164:167], v[92:95]
  v_permlane32_swap_b32 v201, v203
  v_permlane32_swap_b32 v204, v206
  v_permlane32_swap_b32 v205, v207
  v_mfma_f32_16x16x32_bf16 v[96:99], a[112:115], v[160:163], v[96:99]
  v_permlane16_swap_b32 v200, v202
  v_permlane16_swap_b32 v201, v203
  v_permlane16_swap_b32 v204, v206
  v_mfma_f32_16x16x32_bf16 v[100:103], a[112:115], v[164:167], v[100:103]
  v_permlane16_swap_b32 v205, v207
  v_cvt_pk_bf16_f32 v208, v32, v33
  v_cvt_pk_bf16_f32 v209, v34, v35
  v_mfma_f32_16x16x32_bf16 v[104:107], a[116:119], v[160:163], v[104:107]
  v_cvt_pk_bf16_f32 v210, v40, v41
  v_cvt_pk_bf16_f32 v211, v42, v43
  v_cvt_pk_bf16_f32 v212, v36, v37
  v_mfma_f32_16x16x32_bf16 v[108:111], a[116:119], v[164:167], v[108:111]
  v_cvt_pk_bf16_f32 v213, v38, v39
  v_cvt_pk_bf16_f32 v214, v44, v45
  v_cvt_pk_bf16_f32 v215, v46, v47
  v_mfma_f32_16x16x32_bf16 v[112:115], a[120:123], v[160:163], v[112:115]
  s_waitcnt lgkmcnt(8)
  v_permlane32_swap_b32 v208, v210
  v_permlane32_swap_b32 v209, v211
  v_permlane32_swap_b32 v212, v214
  v_mfma_f32_16x16x32_bf16 v[116:119], a[120:123], v[164:167], v[116:119]
  v_permlane32_swap_b32 v213, v215
  v_permlane16_swap_b32 v208, v210
  v_permlane16_swap_b32 v209, v211
  v_mfma_f32_16x16x32_bf16 v[120:123], a[124:127], v[160:163], v[120:123]
  v_permlane16_swap_b32 v212, v214
  v_permlane16_swap_b32 v213, v215
  v_cvt_pk_bf16_f32 v216, v48, v49
  v_mfma_f32_16x16x32_bf16 v[124:127], a[124:127], v[164:167], v[124:127]
  v_cvt_pk_bf16_f32 v217, v50, v51
  v_cvt_pk_bf16_f32 v218, v56, v57
  v_cvt_pk_bf16_f32 v219, v58, v59
  s_waitcnt lgkmcnt(0)
  s_barrier
  s_nop 1
  v_mfma_f32_16x16x32_bf16 v[128:131], a[0:3], v[192:195], 0
  s_add_u32 m0, s40, 0x18000
  s_mov_b32 s44, 0x8000
  v_cvt_pk_bf16_f32 v220, v52, v53
  v_mfma_f32_16x16x32_bf16 v[132:135], a[0:3], v[196:199], 0
  ds_read_b128 a[0:3], v170 offset:16384
  v_cvt_pk_bf16_f32 v221, v54, v55
  v_cvt_pk_bf16_f32 v222, v60, v61
  v_mfma_f32_16x16x32_bf16 v[136:139], a[32:35], v[192:195], 0
  buffer_load_dwordx4 v186, s[20:23], s44 offen offset:0 nt lds
  v_cvt_pk_bf16_f32 v223, v62, v63
  v_mfma_f32_16x16x32_bf16 v[140:143], a[32:35], v[196:199], 0
  ds_read_b128 a[32:35], v170 offset:24576
  v_permlane32_swap_b32 v216, v218
  v_permlane32_swap_b32 v217, v219
  v_mfma_f32_16x16x32_bf16 v[128:131], a[4:7], v[200:203], v[128:131]
  buffer_load_dwordx4 v187, s[20:23], s44 offen offset:1024 nt lds
  v_permlane32_swap_b32 v220, v222
  v_mfma_f32_16x16x32_bf16 v[132:135], a[4:7], v[204:207], v[132:135]
  ds_read_b128 a[4:7], v171 offset:16384
  v_permlane32_swap_b32 v221, v223
  v_permlane16_swap_b32 v216, v218
  v_mfma_f32_16x16x32_bf16 v[136:139], a[36:39], v[200:203], v[136:139]
  buffer_load_dwordx4 v188, s[20:23], s44 offen offset:2048 nt lds
  v_permlane16_swap_b32 v217, v219
  v_mfma_f32_16x16x32_bf16 v[140:143], a[36:39], v[204:207], v[140:143]
  ds_read_b128 a[36:39], v171 offset:24576
  v_permlane16_swap_b32 v220, v222
  v_permlane16_swap_b32 v221, v223
  v_mfma_f32_16x16x32_bf16 v[128:131], a[8:11], v[208:211], v[128:131]
  buffer_load_dwordx4 v189, s[20:23], s44 offen offset:3072 nt lds
  v_cvt_pk_bf16_f32 v224, v64, v65
  v_mfma_f32_16x16x32_bf16 v[132:135], a[8:11], v[212:215], v[132:135]
  ds_read_b128 a[8:11], v172 offset:16384
  v_cvt_pk_bf16_f32 v225, v66, v67
  v_cvt_pk_bf16_f32 v226, v72, v73
  v_mfma_f32_16x16x32_bf16 v[136:139], a[40:43], v[208:211], v[136:139]
  s_add_u32 m0, s40, 0x0
  s_mov_b32 s44, 0x10000
  v_cvt_pk_bf16_f32 v227, v74, v75
  v_mfma_f32_16x16x32_bf16 v[140:143], a[40:43], v[212:215], v[140:143]
  ds_read_b128 a[40:43], v172 offset:24576
  v_cvt_pk_bf16_f32 v228, v68, v69
  v_cvt_pk_bf16_f32 v229, v70, v71
  v_mfma_f32_16x16x32_bf16 v[128:131], a[12:15], v[216:219], v[128:131]
  buffer_load_dwordx4 v182, s[16:19], s44 offen offset:0 nt lds
  v_cvt_pk_bf16_f32 v230, v76, v77
  v_mfma_f32_16x16x32_bf16 v[132:135], a[12:15], v[220:223], v[132:135]
  ds_read_b128 a[12:15], v173 offset:16384
  v_cvt_pk_bf16_f32 v231, v78, v79
  v_permlane32_swap_b32 v224, v226
  v_mfma_f32_16x16x32_bf16 v[136:139], a[44:47], v[216:219], v[136:139]
  buffer_load_dwordx4 v183, s[16:19], s44 offen offset:1024 nt lds
  v_permlane32_swap_b32 v225, v227
  v_mfma_f32_16x16x32_bf16 v[140:143], a[44:47], v[220:223], v[140:143]
  ds_read_b128 a[44:47], v173 offset:24576
  v_permlane32_swap_b32 v228, v230
  v_permlane32_swap_b32 v229, v231
  v_permlane16_swap_b32 v224, v226
  v_permlane16_swap_b32 v225, v227
  v_permlane16_swap_b32 v228, v230
  v_permlane16_swap_b32 v229, v231
  s_nop 1
  v_mfma_f32_16x16x32_bf16 v[128:131], a[16:19], v[224:227], v[128:131]
  buffer_load_dwordx4 v184, s[16:19], s44 offen offset:2048 nt lds
  v_cvt_pk_bf16_f32 v232, v80, v81
  v_mfma_f32_16x16x32_bf16 v[132:135], a[16:19], v[228:231], v[132:135]
  ds_read_b128 a[16:19], v170 offset:16640
  v_cvt_pk_bf16_f32 v233, v82, v83
  v_cvt_pk_bf16_f32 v234, v88, v89
  v_mfma_f32_16x16x32_bf16 v[136:139], a[48:51], v[224:227], v[136:139]
  buffer_load_dwordx4 v185, s[16:19], s44 offen offset:3072 nt lds
  v_cvt_pk_bf16_f32 v235, v90, v91
  v_mfma_f32_16x16x32_bf16 v[140:143], a[48:51], v[228:231], v[140:143]
  ds_read_b128 a[48:51], v170 offset:24832
  v_cvt_pk_bf16_f32 v236, v84, v85
  v_cvt_pk_bf16_f32 v237, v86, v87
  v_cvt_pk_bf16_f32 v238, v92, v93
  v_cvt_pk_bf16_f32 v239, v94, v95
  v_permlane32_swap_b32 v232, v234
  v_permlane32_swap_b32 v233, v235
  v_permlane32_swap_b32 v236, v238
  v_permlane32_swap_b32 v237, v239
  v_permlane16_swap_b32 v232, v234
  v_permlane16_swap_b32 v233, v235
  v_permlane16_swap_b32 v236, v238
  v_permlane16_swap_b32 v237, v239
  s_nop 1
  v_mfma_f32_16x16x32_bf16 v[128:131], a[20:23], v[232:235], v[128:131]
  v_cvt_pk_bf16_f32 v240, v96, v97
  v_cvt_pk_bf16_f32 v241, v98, v99
  v_cvt_pk_bf16_f32 v242, v104, v105
  v_mfma_f32_16x16x32_bf16 v[132:135], a[20:23], v[236:239], v[132:135]
  ds_read_b128 a[20:23], v171 offset:16640
  v_cvt_pk_bf16_f32 v243, v106, v107
  v_cvt_pk_bf16_f32 v244, v100, v101
  v_mfma_f32_16x16x32_bf16 v[136:139], a[52:55], v[232:235], v[136:139]
  v_cvt_pk_bf16_f32 v245, v102, v103
  v_cvt_pk_bf16_f32 v246, v108, v109
  v_cvt_pk_bf16_f32 v247, v110, v111
  v_mfma_f32_16x16x32_bf16 v[140:143], a[52:55], v[236:239], v[140:143]
  ds_read_b128 a[52:55], v171 offset:24832
  v_permlane32_swap_b32 v240, v242
  v_permlane32_swap_b32 v241, v243
  v_permlane32_swap_b32 v244, v246
  v_permlane32_swap_b32 v245, v247
  v_permlane16_swap_b32 v240, v242
  v_permlane16_swap_b32 v241, v243
  v_permlane16_swap_b32 v244, v246
  v_permlane16_swap_b32 v245, v247
  s_nop 1
  v_mfma_f32_16x16x32_bf16 v[128:131], a[24:27], v[240:243], v[128:131]
  v_cvt_pk_bf16_f32 v248, v112, v113
  v_cvt_pk_bf16_f32 v249, v114, v115
  v_cvt_pk_bf16_f32 v250, v120, v121
  v_mfma_f32_16x16x32_bf16 v[132:135], a[24:27], v[244:247], v[132:135]
  ds_read_b128 a[24:27], v172 offset:16640
  v_cvt_pk_bf16_f32 v251, v122, v123
  v_cvt_pk_bf16_f32 v252, v116, v117
  v_mfma_f32_16x16x32_bf16 v[136:139], a[56:59], v[240:243], v[136:139]
  v_cvt_pk_bf16_f32 v253, v118, v119
  v_cvt_pk_bf16_f32 v254, v124, v125
  v_cvt_pk_bf16_f32 v255, v126, v127
  v_mfma_f32_16x16x32_bf16 v[140:143], a[56:59], v[244:247], v[140:143]
  ds_read_b128 a[56:59], v172 offset:24832
  v_permlane32_swap_b32 v248, v250
  v_permlane32_swap_b32 v249, v251
  v_permlane32_swap_b32 v252, v254
  v_permlane32_swap_b32 v253, v255
  v_permlane16_swap_b32 v248, v250
  v_permlane16_swap_b32 v249, v251
  v_permlane16_swap_b32 v252, v254
  v_permlane16_swap_b32 v253, v255
  s_nop 1
  v_mfma_f32_16x16x32_bf16 v[128:131], a[28:31], v[248:251], v[128:131]
  v_mov_b64 v[0:1], 0
  v_mov_b64 v[2:3], 0
  v_mov_b64 v[8:9], 0
  v_mfma_f32_16x16x32_bf16 v[132:135], a[28:31], v[252:255], v[132:135]
  ds_read_b128 a[28:31], v173 offset:16640
  v_mov_b64 v[10:11], 0
  v_mov_b64 v[4:5], 0
  v_mfma_f32_16x16x32_bf16 v[136:139], a[60:63], v[248:251], v[136:139]
  v_mov_b64 v[6:7], 0
  v_mov_b64 v[12:13], 0
  v_mov_b64 v[14:15], 0
  v_mfma_f32_16x16x32_bf16 v[140:143], a[60:63], v[252:255], v[140:143]
  ds_read_b128 a[60:63], v173 offset:24832
  v_mov_b64 v[16:17], 0
  v_mov_b64 v[18:19], 0
  v_mov_b64 v[24:25], 0
  v_mov_b64 v[26:27], 0
  v_mov_b64 v[20:21], 0
  v_mov_b64 v[22:23], 0
  v_mov_b64 v[28:29], 0
  v_mov_b64 v[30:31], 0
  v_mov_b64 v[32:33], 0
  v_mov_b64 v[34:35], 0
  v_mov_b64 v[40:41], 0
  v_mov_b64 v[42:43], 0
  v_mov_b64 v[36:37], 0
  v_mov_b64 v[38:39], 0
  v_mov_b64 v[44:45], 0
  v_mov_b64 v[46:47], 0
  v_mov_b64 v[48:49], 0
  v_mov_b64 v[50:51], 0
  v_mov_b64 v[56:57], 0
  v_mov_b64 v[58:59], 0
  v_mov_b64 v[52:53], 0
  v_mov_b64 v[54:55], 0
  v_mov_b64 v[60:61], 0
  v_mov_b64 v[62:63], 0
  v_mov_b64 v[64:65], 0
  v_mov_b64 v[66:67], 0
  v_mov_b64 v[72:73], 0
  v_mov_b64 v[74:75], 0
  v_mov_b64 v[68:69], 0
  v_mov_b64 v[70:71], 0
  v_mov_b64 v[76:77], 0
  v_mov_b64 v[78:79], 0
  v_mov_b64 v[80:81], 0
  v_mov_b64 v[82:83], 0
  v_mov_b64 v[88:89], 0
  v_mov_b64 v[90:91], 0
  v_mov_b64 v[84:85], 0
  v_mov_b64 v[86:87], 0
  v_mov_b64 v[92:93], 0
  v_mov_b64 v[94:95], 0
  v_mov_b64 v[96:97], 0
  v_mov_b64 v[98:99], 0
  v_mov_b64 v[104:105], 0
  v_mov_b64 v[106:107], 0
  v_mov_b64 v[100:101], 0
  v_mov_b64 v[102:103], 0
  v_mov_b64 v[108:109], 0
  v_mov_b64 v[110:111], 0
  v_mov_b64 v[112:113], 0
  v_mov_b64 v[114:115], 0
  v_mov_b64 v[120:121], 0
  v_mov_b64 v[122:123], 0
  v_mov_b64 v[116:117], 0
  v_mov_b64 v[118:119], 0
  v_mov_b64 v[124:125], 0
  v_mov_b64 v[126:127], 0
  v_max3_f32 v160, v128, v129, v130
  v_max3_f32 v161, v131, v136, v137
  v_max3_f32 v160, v160, v138, v139
  v_max_f32 v160, v160, v161
  v_max3_f32 v164, v132, v133, v134
  v_max3_f32 v165, v135, v140, v141
  v_max3_f32 v164, v164, v142, v143
  v_max_f32 v164, v164, v165
  v_mov_b32 v161, v160
  s_nop 1
  v_permlane32_swap_b32 v160, v161
  s_nop 1
  v_max_f32 v160, v160, v161
  v_mov_b32 v161, v160
  s_nop 1
  v_permlane16_swap_b32 v160, v161
  s_nop 1
  v_max_f32 v160, v160, v161
  v_mov_b32 v165, v164
  s_nop 1
  v_permlane32_swap_b32 v164, v165
  s_nop 1
  v_max_f32 v164, v164, v165
  v_mov_b32 v165, v164
  s_nop 1
  v_permlane16_swap_b32 v164, v165
  s_nop 1
  v_max_f32 v164, v164, v165
  v_sub_f32 v160, 0, v160
  v_mov_b32 v161, v160
  v_mov_b32 v162, v160
  v_mov_b32 v163, v160
  v_sub_f32 v164, 0, v164
  v_mov_b32 v165, v164
  v_mov_b32 v166, v164
  v_mov_b32 v167, v164
  v_add_f32 v128, v128, v161
  v_add_f32 v129, v129, v162
  v_add_f32 v130, v130, v163
  v_add_f32 v131, v131, v160
  v_add_f32 v132, v132, v165
  v_add_f32 v133, v133, v166
  v_add_f32 v134, v134, v167
  v_add_f32 v135, v135, v164
  v_add_f32 v136, v136, v161
  v_add_f32 v137, v137, v162
  v_add_f32 v138, v138, v163
  v_add_f32 v139, v139, v160
  v_add_f32 v140, v140, v165
  v_add_f32 v141, v141, v166
  v_add_f32 v142, v142, v167
  v_add_f32 v143, v143, v164
  v_exp_f32 v128, v128
  v_exp_f32 v129, v129
  v_exp_f32 v130, v130
  v_exp_f32 v131, v131
  v_exp_f32 v132, v132
  v_exp_f32 v133, v133
  v_exp_f32 v134, v134
  v_exp_f32 v135, v135
  v_exp_f32 v136, v136
  v_exp_f32 v137, v137
  v_exp_f32 v138, v138
  v_exp_f32 v139, v139
  v_exp_f32 v140, v140
  v_exp_f32 v141, v141
  v_exp_f32 v142, v142
  v_exp_f32 v143, v143
  v_add_f32 v168, v128, v129
  v_add_f32 v169, v132, v133
  v_add_f32 v168, v130, v168
  v_add_f32 v168, v131, v168
  v_add_f32 v169, v134, v169
  v_add_f32 v169, v135, v169
  v_add_f32 v168, v136, v168
  v_add_f32 v168, v137, v168
  v_add_f32 v168, v138, v168
  v_add_f32 v168, v139, v168
  v_add_f32 v169, v140, v169
  v_add_f32 v169, v141, v169
  v_add_f32 v169, v142, v169
  v_add_f32 v169, v143, v169
  v_cvt_pk_bf16_f32 v144, v128, v129
  v_cvt_pk_bf16_f32 v145, v130, v131
  v_cvt_pk_bf16_f32 v148, v132, v133
  v_cvt_pk_bf16_f32 v149, v134, v135
  v_cvt_pk_bf16_f32 v146, v136, v137
  v_cvt_pk_bf16_f32 v147, v138, v139
  v_cvt_pk_bf16_f32 v150, v140, v141
  v_cvt_pk_bf16_f32 v151, v142, v143
  s_add_u32 s32, s10, 0x30000
  s_addc_u32 s33, s11, 0
  s_and_b32 s33, s33, 0xffff
  s_mov_b32 s34, 0x4000
  s_mov_b32 s35, 0x20000
  s_mov_b32 s42, 49152
  s_mov_b32 s41, 81920
  buffer_load_dwordx4 a[128:131], v190, s[76:79], s47 offen
  s_getpc_b64 s[24:25]
K2_pc2:
  s_add_u32 s24, s24, K2_tail-K2_pc2
  s_addc_u32 s25, s25, 0
  s_and_b32 s25, s25, 0xffff
  s_mov_b32 s26, K2_fb-K2_tail
  s_mov_b32 s27, 0x20000
  v_and_b32 v128, 0x3ff, v190
  v_lshlrev_b32 v128, 3, v128
  s_lshl_b32 s44, s14, 13
  buffer_load_dword a128, v128, s[24:27], s44 offen
.p2align 6
K2_loop:
  s_waitcnt vmcnt(16) lgkmcnt(0)
  s_barrier
  v_mfma_f32_16x16x32_bf16 v[128:131], a[0:3], v[192:195], v[160:163]
  ds_read_b64_tr_b16 a[64:65], v174 offset:0
  ds_read_b64_tr_b16 a[66:67], v174 offset:8192
  v_mfma_f32_16x16x32_bf16 v[128:131], a[4:7], v[200:203], v[128:131]
  s_add_u32 m0, s40, 0x1c000
  ds_read_b64_tr_b16 a[68:69], v175 offset:0
  v_mfma_f32_16x16x32_bf16 v[128:131], a[8:11], v[208:211], v[128:131]
  ds_read_b64_tr_b16 a[70:71], v175 offset:8192
  ds_read_b64_tr_b16 a[72:73], v176 offset:0
  v_mfma_f32_16x16x32_bf16 v[128:131], a[12:15], v[216:219], v[128:131]
  buffer_load_dwordx4 v186, s[20:23], s42 offen offset:0 nt lds
  v_mfma_f32_16x16x32_bf16 v[128:131], a[16:19], v[224:227], v[128:131]
  ds_read_b64_tr_b16 a[74:75], v176 offset:8192
  ds_read_b64_tr_b16 a[76:77], v177 offset:0
  v_mfma_f32_16x16x32_bf16 v[128:131], a[20:23], v[232:235], v[128:131]
  ds_read_b64_tr_b16 a[78:79], v177 offset:8192
  ds_read_b64_tr_b16 a[80:81], v178 offset:0
  v_mfma_f32_16x16x32_bf16 v[128:131], a[24:27], v[240:243], v[128:131]
  ds_read_b64_tr_b16 a[82:83], v178 offset:8192
  v_mfma_f32_16x16x32_bf16 v[128:131], a[28:31], v[248:251], v[128:131]
  ds_read_b64_tr_b16 a[84:85], v179 offset:0
  ds_read_b64_tr_b16 a[86:87], v179 offset:8192
  v_mfma_f32_16x16x32_bf16 v[132:135], a[0:3], v[196:199], v[164:167]
  ds_read_b64_tr_b16 a[88:89], v180 offset:0
  v_mfma_f32_16x16x32_bf16 v[132:135], a[4:7], v[204:207], v[132:135]
  ds_read_b64_tr_b16 a[90:91], v180 offset:8192
  ds_read_b64_tr_b16 a[92:93], v181 offset:0
  v_mfma_f32_16x16x32_bf16 v[132:135], a[8:11], v[212:215], v[132:135]
  ds_read_b64_tr_b16 a[94:95], v181 offset:8192
  ds_read_b64_tr_b16 a[96:97], v174 offset:256
  v_mfma_f32_16x16x32_bf16 v[132:135], a[12:15], v[220:223], v[132:135]
  buffer_load_dwordx4 v187, s[20:23], s42 offen offset:1024 nt lds
  v_mfma_f32_16x16x32_bf16 v[132:135], a[16:19], v[228:231], v[132:135]
  v_exp_f32 v128, v128
  v_mfma_f32_16x16x32_bf16 v[132:135], a[20:23], v[236:239], v[132:135]
  ds_read_b128 a[0:3], v170 offset:32768
  v_add_f32 v168, v128, v168
  v_mfma_f32_16x16x32_bf16 v[132:135], a[24:27], v[244:247], v[132:135]
  v_exp_f32 v129, v129
  v_mfma_f32_16x16x32_bf16 v[132:135], a[28:31], v[252:255], v[132:135]
  ds_read_b64_tr_b16 a[98:99], v174 offset:8448
  ds_read_b64_tr_b16 a[100:101], v175 offset:256
  v_mfma_f32_16x16x32_bf16 v[136:139], a[32:35], v[192:195], v[160:163]
  ds_read_b128 a[4:7], v171 offset:32768
  v_add_f32 v168, v129, v168
  v_mfma_f32_16x16x32_bf16 v[136:139], a[36:39], v[200:203], v[136:139]
  v_exp_f32 v130, v130
  v_mfma_f32_16x16x32_bf16 v[136:139], a[40:43], v[208:211], v[136:139]
  ds_read_b128 a[8:11], v172 offset:32768
  v_cvt_pk_bf16_f32 v152, v128, v129
  v_mfma_f32_16x16x32_bf16 v[136:139], a[44:47], v[216:219], v[136:139]
  buffer_load_dwordx4 v188, s[20:23], s42 offen offset:2048 nt lds
  v_mfma_f32_16x16x32_bf16 v[136:139], a[48:51], v[224:227], v[136:139]
  v_exp_f32 v131, v131
  v_mfma_f32_16x16x32_bf16 v[136:139], a[52:55], v[232:235], v[136:139]
  ds_read_b64_tr_b16 a[102:103], v175 offset:8448
  ds_read_b64_tr_b16 a[104:105], v176 offset:256
  v_mfma_f32_16x16x32_bf16 v[136:139], a[56:59], v[240:243], v[136:139]
  ds_read_b128 a[12:15], v173 offset:32768
  v_add_f32 v168, v130, v168
  v_mfma_f32_16x16x32_bf16 v[136:139], a[60:63], v[248:251], v[136:139]
  v_exp_f32 v132, v132
  v_mfma_f32_16x16x32_bf16 v[140:143], a[32:35], v[196:199], v[164:167]
  ds_read_b128 a[16:19], v170 offset:33024
  v_add_f32 v168, v131, v168
  v_mfma_f32_16x16x32_bf16 v[140:143], a[36:39], v[204:207], v[140:143]
  ds_read_b64_tr_b16 a[106:107], v176 offset:8448
  ds_read_b64_tr_b16 a[108:109], v177 offset:256
  v_mfma_f32_16x16x32_bf16 v[140:143], a[40:43], v[212:215], v[140:143]
  s_waitcnt lgkmcnt(15)
  v_exp_f32 v133, v133
  v_mfma_f32_16x16x32_bf16 v[140:143], a[44:47], v[220:223], v[140:143]
  buffer_load_dwordx4 v189, s[20:23], s42 offen offset:3072 nt lds
  v_mfma_f32_16x16x32_bf16 v[140:143], a[48:51], v[228:231], v[140:143]
  ds_read_b128 a[20:23], v171 offset:33024
  v_cvt_pk_bf16_f32 v153, v130, v131
  v_mfma_f32_16x16x32_bf16 v[140:143], a[52:55], v[236:239], v[140:143]
  s_add_u32 m0, s40, 0x4000
  v_exp_f32 v134, v134
  v_mfma_f32_16x16x32_bf16 v[140:143], a[56:59], v[244:247], v[140:143]
  ds_read_b128 a[24:27], v172 offset:33024
  v_add_f32 v169, v132, v169
  v_mfma_f32_16x16x32_bf16 v[140:143], a[60:63], v[252:255], v[140:143]
  ds_read_b64_tr_b16 a[110:111], v177 offset:8448
  ds_read_b64_tr_b16 a[112:113], v178 offset:256
  v_mfma_f32_16x16x32_bf16 v[0:3], a[64:67], v[144:147], v[0:3]
  v_exp_f32 v135, v135
  v_mfma_f32_16x16x32_bf16 v[4:7], a[64:67], v[148:151], v[4:7]
  ds_read_b128 a[28:31], v173 offset:33024
  v_add_f32 v169, v133, v169
  v_mfma_f32_16x16x32_bf16 v[8:11], a[68:71], v[144:147], v[8:11]
  s_add_u32 s42, s42, 16384
  v_exp_f32 v136, v136
  v_mfma_f32_16x16x32_bf16 v[12:15], a[68:71], v[148:151], v[12:15]
  buffer_load_dwordx4 v182, s[16:19], s41 offen offset:0 nt lds
  v_mfma_f32_16x16x32_bf16 v[16:19], a[72:75], v[144:147], v[16:19]
  ds_read_b128 a[32:35], v170 offset:40960
  v_cvt_pk_bf16_f32 v156, v132, v133
  v_mfma_f32_16x16x32_bf16 v[20:23], a[72:75], v[148:151], v[20:23]
  s_waitcnt lgkmcnt(15)
  v_exp_f32 v137, v137
  v_mfma_f32_16x16x32_bf16 v[24:27], a[76:79], v[144:147], v[24:27]
  ds_read_b64_tr_b16 a[114:115], v178 offset:8448
  ds_read_b64_tr_b16 a[116:117], v179 offset:256
  v_mfma_f32_16x16x32_bf16 v[28:31], a[76:79], v[148:151], v[28:31]
  ds_read_b128 a[36:39], v171 offset:40960
  v_add_f32 v169, v134, v169
  v_mfma_f32_16x16x32_bf16 v[32:35], a[80:83], v[144:147], v[32:35]
  v_exp_f32 v138, v138
  v_mfma_f32_16x16x32_bf16 v[36:39], a[80:83], v[148:151], v[36:39]
  ds_read_b128 a[40:43], v172 offset:40960
  v_add_f32 v169, v135, v169
  v_mfma_f32_16x16x32_bf16 v[40:43], a[84:87], v[144:147], v[40:43]
  v_exp_f32 v139, v139
  v_mfma_f32_16x16x32_bf16 v[44:47], a[84:87], v[148:151], v[44:47]
  buffer_load_dwordx4 v183, s[16:19], s41 offen offset:1024 nt lds
  v_mfma_f32_16x16x32_bf16 v[48:51], a[88:91], v[144:147], v[48:51]
  ds_read_b64_tr_b16 a[118:119], v179 offset:8448
  ds_read_b64_tr_b16 a[120:121], v180 offset:256
  v_mfma_f32_16x16x32_bf16 v[52:55], a[88:91], v[148:151], v[52:55]
  s_waitcnt lgkmcnt(9)
  v_exp_f32 v140, v140
  v_mfma_f32_16x16x32_bf16 v[56:59], a[92:95], v[144:147], v[56:59]
  ds_read_b128 a[44:47], v173 offset:40960
  v_cvt_pk_bf16_f32 v157, v134, v135
  v_mfma_f32_16x16x32_bf16 v[60:63], a[92:95], v[148:151], v[60:63]
  ds_read_b128 a[48:51], v170 offset:41216
  v_add_f32 v168, v136, v168
  v_mfma_f32_16x16x32_bf16 v[64:67], a[96:99], v[144:147], v[64:67]
  v_exp_f32 v141, v141
  v_mfma_f32_16x16x32_bf16 v[68:71], a[96:99], v[148:151], v[68:71]
  ds_read_b64_tr_b16 a[122:123], v180 offset:8448
  ds_read_b64_tr_b16 a[124:125], v181 offset:256
  v_mfma_f32_16x16x32_bf16 v[72:75], a[100:103], v[144:147], v[72:75]
  v_exp_f32 v142, v142
  v_mfma_f32_16x16x32_bf16 v[76:79], a[100:103], v[148:151], v[76:79]
  buffer_load_dwordx4 v184, s[16:19], s41 offen offset:2048 nt lds
  v_mfma_f32_16x16x32_bf16 v[80:83], a[104:107], v[144:147], v[80:83]
  ds_read_b64_tr_b16 a[126:127], v181 offset:8448
  v_add_f32 v168, v137, v168
  v_mfma_f32_16x16x32_bf16 v[84:87], a[104:107], v[148:151], v[84:87]
  s_waitcnt lgkmcnt(6)
  v_exp_f32 v143, v143
  v_mfma_f32_16x16x32_bf16 v[88:91], a[108:111], v[144:147], v[88:91]
  ds_read_b128 a[52:55], v171 offset:41216
  v_cvt_pk_bf16_f32 v154, v136, v137
  v_mfma_f32_16x16x32_bf16 v[92:95], a[108:111], v[148:151], v[92:95]
  ds_read_b128 a[56:59], v172 offset:41216
  v_add_f32 v168, v138, v168
  v_mfma_f32_16x16x32_bf16 v[96:99], a[112:115], v[144:147], v[96:99]
  ds_read_b128 a[60:63], v173 offset:41216
  v_add_f32 v168, v139, v168
  v_mfma_f32_16x16x32_bf16 v[100:103], a[112:115], v[148:151], v[100:103]
  v_cvt_pk_bf16_f32 v155, v138, v139
  v_add_f32 v169, v140, v169
  v_mfma_f32_16x16x32_bf16 v[104:107], a[116:119], v[144:147], v[104:107]
  s_waitcnt lgkmcnt(3)
  v_add_f32 v169, v141, v169
  v_mfma_f32_16x16x32_bf16 v[108:111], a[116:119], v[148:151], v[108:111]
  buffer_load_dwordx4 v185, s[16:19], s41 offen offset:3072 nt lds
  v_mfma_f32_16x16x32_bf16 v[112:115], a[120:123], v[144:147], v[112:115]
  s_add_u32 s41, s41, 16384
  v_cvt_pk_bf16_f32 v158, v140, v141
  v_mfma_f32_16x16x32_bf16 v[116:119], a[120:123], v[148:151], v[116:119]
  v_add_f32 v169, v142, v169
  v_add_f32 v169, v143, v169
  v_mfma_f32_16x16x32_bf16 v[120:123], a[124:127], v[144:147], v[120:123]
  v_cvt_pk_bf16_f32 v159, v142, v143
  v_mfma_f32_16x16x32_bf16 v[124:127], a[124:127], v[148:151], v[124:127]
  s_waitcnt vmcnt(16) lgkmcnt(0)
  s_barrier
  v_mfma_f32_16x16x32_bf16 v[128:131], a[0:3], v[192:195], v[160:163]
  ds_read_b64_tr_b16 a[64:65], v174 offset:16384
  ds_read_b64_tr_b16 a[66:67], v174 offset:24576
  v_mfma_f32_16x16x32_bf16 v[128:131], a[4:7], v[200:203], v[128:131]
  s_add_u32 m0, s40, 0x10000
  ds_read_b64_tr_b16 a[68:69], v175 offset:16384
  v_mfma_f32_16x16x32_bf16 v[128:131], a[8:11], v[208:211], v[128:131]
  ds_read_b64_tr_b16 a[70:71], v175 offset:24576
  ds_read_b64_tr_b16 a[72:73], v176 offset:16384
  v_mfma_f32_16x16x32_bf16 v[128:131], a[12:15], v[216:219], v[128:131]
  buffer_load_dwordx4 v186, s[20:23], s42 offen offset:0 nt lds
  v_mfma_f32_16x16x32_bf16 v[128:131], a[16:19], v[224:227], v[128:131]
  ds_read_b64_tr_b16 a[74:75], v176 offset:24576
  ds_read_b64_tr_b16 a[76:77], v177 offset:16384
  v_mfma_f32_16x16x32_bf16 v[128:131], a[20:23], v[232:235], v[128:131]
  ds_read_b64_tr_b16 a[78:79], v177 offset:24576
  ds_read_b64_tr_b16 a[80:81], v178 offset:16384
  v_mfma_f32_16x16x32_bf16 v[128:131], a[24:27], v[240:243], v[128:131]
  ds_read_b64_tr_b16 a[82:83], v178 offset:24576
  v_mfma_f32_16x16x32_bf16 v[128:131], a[28:31], v[248:251], v[128:131]
  ds_read_b64_tr_b16 a[84:85], v179 offset:16384
  ds_read_b64_tr_b16 a[86:87], v179 offset:24576
  v_mfma_f32_16x16x32_bf16 v[132:135], a[0:3], v[196:199], v[164:167]
  ds_read_b64_tr_b16 a[88:89], v180 offset:16384
  v_mfma_f32_16x16x32_bf16 v[132:135], a[4:7], v[204:207], v[132:135]
  ds_read_b64_tr_b16 a[90:91], v180 offset:24576
  ds_read_b64_tr_b16 a[92:93], v181 offset:16384
  v_mfma_f32_16x16x32_bf16 v[132:135], a[8:11], v[212:215], v[132:135]
  ds_read_b64_tr_b16 a[94:95], v181 offset:24576
  ds_read_b64_tr_b16 a[96:97], v174 offset:16640
  v_mfma_f32_16x16x32_bf16 v[132:135], a[12:15], v[220:223], v[132:135]
  buffer_load_dwordx4 v187, s[20:23], s42 offen offset:1024 nt lds
  v_mfma_f32_16x16x32_bf16 v[132:135], a[16:19], v[228:231], v[132:135]
  v_exp_f32 v128, v128
  v_mfma_f32_16x16x32_bf16 v[132:135], a[20:23], v[236:239], v[132:135]
  ds_read_b128 a[0:3], v170 offset:49152
  v_add_f32 v168, v128, v168
  v_mfma_f32_16x16x32_bf16 v[132:135], a[24:27], v[244:247], v[132:135]
  v_exp_f32 v129, v129
  v_mfma_f32_16x16x32_bf16 v[132:135], a[28:31], v[252:255], v[132:135]
  ds_read_b64_tr_b16 a[98:99], v174 offset:24832
  ds_read_b64_tr_b16 a[100:101], v175 offset:16640
  v_mfma_f32_16x16x32_bf16 v[136:139], a[32:35], v[192:195], v[160:163]
  ds_read_b128 a[4:7], v171 offset:49152
  v_add_f32 v168, v129, v168
  v_mfma_f32_16x16x32_bf16 v[136:139], a[36:39], v[200:203], v[136:139]
  v_exp_f32 v130, v130
  v_mfma_f32_16x16x32_bf16 v[136:139], a[40:43], v[208:211], v[136:139]
  ds_read_b128 a[8:11], v172 offset:49152
  v_cvt_pk_bf16_f32 v144, v128, v129
  v_mfma_f32_16x16x32_bf16 v[136:139], a[44:47], v[216:219], v[136:139]
  buffer_load_dwordx4 v188, s[20:23], s42 offen offset:2048 nt lds
  v_mfma_f32_16x16x32_bf16 v[136:139], a[48:51], v[224:227], v[136:139]
  v_exp_f32 v131, v131
  v_mfma_f32_16x16x32_bf16 v[136:139], a[52:55], v[232:235], v[136:139]
  ds_read_b64_tr_b16 a[102:103], v175 offset:24832
  ds_read_b64_tr_b16 a[104:105], v176 offset:16640
  v_mfma_f32_16x16x32_bf16 v[136:139], a[56:59], v[240:243], v[136:139]
  ds_read_b128 a[12:15], v173 offset:49152
  v_add_f32 v168, v130, v168
  v_mfma_f32_16x16x32_bf16 v[136:139], a[60:63], v[248:251], v[136:139]
  v_exp_f32 v132, v132
  v_mfma_f32_16x16x32_bf16 v[140:143], a[32:35], v[196:199], v[164:167]
  ds_read_b128 a[16:19], v170 offset:49408
  v_add_f32 v168, v131, v168
  v_mfma_f32_16x16x32_bf16 v[140:143], a[36:39], v[204:207], v[140:143]
  ds_read_b64_tr_b16 a[106:107], v176 offset:24832
  ds_read_b64_tr_b16 a[108:109], v177 offset:16640
  v_mfma_f32_16x16x32_bf16 v[140:143], a[40:43], v[212:215], v[140:143]
  s_waitcnt lgkmcnt(15)
  v_exp_f32 v133, v133
  v_mfma_f32_16x16x32_bf16 v[140:143], a[44:47], v[220:223], v[140:143]
  buffer_load_dwordx4 v189, s[20:23], s42 offen offset:3072 nt lds
  v_mfma_f32_16x16x32_bf16 v[140:143], a[48:51], v[228:231], v[140:143]
  ds_read_b128 a[20:23], v171 offset:49408
  v_cvt_pk_bf16_f32 v145, v130, v131
  v_mfma_f32_16x16x32_bf16 v[140:143], a[52:55], v[236:239], v[140:143]
  s_add_u32 m0, s40, 0x8000
  v_exp_f32 v134, v134
  v_mfma_f32_16x16x32_bf16 v[140:143], a[56:59], v[244:247], v[140:143]
  ds_read_b128 a[24:27], v172 offset:49408
  v_add_f32 v169, v132, v169
  v_mfma_f32_16x16x32_bf16 v[140:143], a[60:63], v[252:255], v[140:143]
  ds_read_b64_tr_b16 a[110:111], v177 offset:24832
  ds_read_b64_tr_b16 a[112:113], v178 offset:16640
  v_mfma_f32_16x16x32_bf16 v[0:3], a[64:67], v[152:155], v[0:3]
  v_exp_f32 v135, v135
  v_mfma_f32_16x16x32_bf16 v[4:7], a[64:67], v[156:159], v[4:7]
  ds_read_b128 a[28:31], v173 offset:49408
  v_add_f32 v169, v133, v169
  v_mfma_f32_16x16x32_bf16 v[8:11], a[68:71], v[152:155], v[8:11]
  s_add_u32 s42, s42, 16384
  v_exp_f32 v136, v136
  v_mfma_f32_16x16x32_bf16 v[12:15], a[68:71], v[156:159], v[12:15]
  buffer_load_dwordx4 v182, s[16:19], s41 offen offset:0 nt lds
  v_mfma_f32_16x16x32_bf16 v[16:19], a[72:75], v[152:155], v[16:19]
  ds_read_b128 a[32:35], v170 offset:57344
  v_cvt_pk_bf16_f32 v148, v132, v133
  v_mfma_f32_16x16x32_bf16 v[20:23], a[72:75], v[156:159], v[20:23]
  s_waitcnt lgkmcnt(15)
  v_exp_f32 v137, v137
  v_mfma_f32_16x16x32_bf16 v[24:27], a[76:79], v[152:155], v[24:27]
  ds_read_b64_tr_b16 a[114:115], v178 offset:24832
  ds_read_b64_tr_b16 a[116:117], v179 offset:16640
  v_mfma_f32_16x16x32_bf16 v[28:31], a[76:79], v[156:159], v[28:31]
  ds_read_b128 a[36:39], v171 offset:57344
  v_add_f32 v169, v134, v169
  v_mfma_f32_16x16x32_bf16 v[32:35], a[80:83], v[152:155], v[32:35]
  v_exp_f32 v138, v138
  v_mfma_f32_16x16x32_bf16 v[36:39], a[80:83], v[156:159], v[36:39]
  ds_read_b128 a[40:43], v172 offset:57344
  v_add_f32 v169, v135, v169
  v_mfma_f32_16x16x32_bf16 v[40:43], a[84:87], v[152:155], v[40:43]
  v_exp_f32 v139, v139
  v_mfma_f32_16x16x32_bf16 v[44:47], a[84:87], v[156:159], v[44:47]
  buffer_load_dwordx4 v183, s[16:19], s41 offen offset:1024 nt lds
  v_mfma_f32_16x16x32_bf16 v[48:51], a[88:91], v[152:155], v[48:51]
  ds_read_b64_tr_b16 a[118:119], v179 offset:24832
  ds_read_b64_tr_b16 a[120:121], v180 offset:16640
  v_mfma_f32_16x16x32_bf16 v[52:55], a[88:91], v[156:159], v[52:55]
  s_waitcnt lgkmcnt(9)
  v_exp_f32 v140, v140
  v_mfma_f32_16x16x32_bf16 v[56:59], a[92:95], v[152:155], v[56:59]
  ds_read_b128 a[44:47], v173 offset:57344
  v_cvt_pk_bf16_f32 v149, v134, v135
  v_mfma_f32_16x16x32_bf16 v[60:63], a[92:95], v[156:159], v[60:63]
  ds_read_b128 a[48:51], v170 offset:57600
  v_add_f32 v168, v136, v168
  v_mfma_f32_16x16x32_bf16 v[64:67], a[96:99], v[152:155], v[64:67]
  v_exp_f32 v141, v141
  v_mfma_f32_16x16x32_bf16 v[68:71], a[96:99], v[156:159], v[68:71]
  ds_read_b64_tr_b16 a[122:123], v180 offset:24832
  ds_read_b64_tr_b16 a[124:125], v181 offset:16640
  v_mfma_f32_16x16x32_bf16 v[72:75], a[100:103], v[152:155], v[72:75]
  v_exp_f32 v142, v142
  v_mfma_f32_16x16x32_bf16 v[76:79], a[100:103], v[156:159], v[76:79]
  buffer_load_dwordx4 v184, s[16:19], s41 offen offset:2048 nt lds
  v_mfma_f32_16x16x32_bf16 v[80:83], a[104:107], v[152:155], v[80:83]
  ds_read_b64_tr_b16 a[126:127], v181 offset:24832
  v_add_f32 v168, v137, v168
  v_mfma_f32_16x16x32_bf16 v[84:87], a[104:107], v[156:159], v[84:87]
  s_waitcnt lgkmcnt(6)
  v_exp_f32 v143, v143
  v_mfma_f32_16x16x32_bf16 v[88:91], a[108:111], v[152:155], v[88:91]
  ds_read_b128 a[52:55], v171 offset:57600
  v_cvt_pk_bf16_f32 v146, v136, v137
  v_mfma_f32_16x16x32_bf16 v[92:95], a[108:111], v[156:159], v[92:95]
  ds_read_b128 a[56:59], v172 offset:57600
  v_add_f32 v168, v138, v168
  v_mfma_f32_16x16x32_bf16 v[96:99], a[112:115], v[152:155], v[96:99]
  ds_read_b128 a[60:63], v173 offset:57600
  v_add_f32 v168, v139, v168
  v_mfma_f32_16x16x32_bf16 v[100:103], a[112:115], v[156:159], v[100:103]
  v_cvt_pk_bf16_f32 v147, v138, v139
  v_add_f32 v169, v140, v169
  v_mfma_f32_16x16x32_bf16 v[104:107], a[116:119], v[152:155], v[104:107]
  s_waitcnt lgkmcnt(3)
  v_add_f32 v169, v141, v169
  v_mfma_f32_16x16x32_bf16 v[108:111], a[116:119], v[156:159], v[108:111]
  buffer_load_dwordx4 v185, s[16:19], s41 offen offset:3072 nt lds
  v_mfma_f32_16x16x32_bf16 v[112:115], a[120:123], v[152:155], v[112:115]
  s_add_u32 s41, s41, 16384
  v_cvt_pk_bf16_f32 v150, v140, v141
  v_mfma_f32_16x16x32_bf16 v[116:119], a[120:123], v[156:159], v[116:119]
  v_add_f32 v169, v142, v169
  v_add_f32 v169, v143, v169
  v_mfma_f32_16x16x32_bf16 v[120:123], a[124:127], v[152:155], v[120:123]
  v_cvt_pk_bf16_f32 v151, v142, v143
  v_mfma_f32_16x16x32_bf16 v[124:127], a[124:127], v[156:159], v[124:127]
  s_waitcnt vmcnt(16) lgkmcnt(0)
  s_barrier
  v_mfma_f32_16x16x32_bf16 v[128:131], a[0:3], v[192:195], v[160:163]
  ds_read_b64_tr_b16 a[64:65], v174 offset:32768
  ds_read_b64_tr_b16 a[66:67], v174 offset:40960
  v_mfma_f32_16x16x32_bf16 v[128:131], a[4:7], v[200:203], v[128:131]
  s_add_u32 m0, s40, 0x14000
  ds_read_b64_tr_b16 a[68:69], v175 offset:32768
  v_mfma_f32_16x16x32_bf16 v[128:131], a[8:11], v[208:211], v[128:131]
  ds_read_b64_tr_b16 a[70:71], v175 offset:40960
  ds_read_b64_tr_b16 a[72:73], v176 offset:32768
  v_mfma_f32_16x16x32_bf16 v[128:131], a[12:15], v[216:219], v[128:131]
  buffer_load_dwordx4 v186, s[20:23], s42 offen offset:0 nt lds
  v_mfma_f32_16x16x32_bf16 v[128:131], a[16:19], v[224:227], v[128:131]
  ds_read_b64_tr_b16 a[74:75], v176 offset:40960
  ds_read_b64_tr_b16 a[76:77], v177 offset:32768
  v_mfma_f32_16x16x32_bf16 v[128:131], a[20:23], v[232:235], v[128:131]
  ds_read_b64_tr_b16 a[78:79], v177 offset:40960
  ds_read_b64_tr_b16 a[80:81], v178 offset:32768
  v_mfma_f32_16x16x32_bf16 v[128:131], a[24:27], v[240:243], v[128:131]
  ds_read_b64_tr_b16 a[82:83], v178 offset:40960
  v_mfma_f32_16x16x32_bf16 v[128:131], a[28:31], v[248:251], v[128:131]
  ds_read_b64_tr_b16 a[84:85], v179 offset:32768
  ds_read_b64_tr_b16 a[86:87], v179 offset:40960
  v_mfma_f32_16x16x32_bf16 v[132:135], a[0:3], v[196:199], v[164:167]
  ds_read_b64_tr_b16 a[88:89], v180 offset:32768
  v_mfma_f32_16x16x32_bf16 v[132:135], a[4:7], v[204:207], v[132:135]
  ds_read_b64_tr_b16 a[90:91], v180 offset:40960
  ds_read_b64_tr_b16 a[92:93], v181 offset:32768
  v_mfma_f32_16x16x32_bf16 v[132:135], a[8:11], v[212:215], v[132:135]
  ds_read_b64_tr_b16 a[94:95], v181 offset:40960
  ds_read_b64_tr_b16 a[96:97], v174 offset:33024
  v_mfma_f32_16x16x32_bf16 v[132:135], a[12:15], v[220:223], v[132:135]
  buffer_load_dwordx4 v187, s[20:23], s42 offen offset:1024 nt lds
  v_mfma_f32_16x16x32_bf16 v[132:135], a[16:19], v[228:231], v[132:135]
  v_exp_f32 v128, v128
  v_mfma_f32_16x16x32_bf16 v[132:135], a[20:23], v[236:239], v[132:135]
  ds_read_b128 a[0:3], v170 offset:0
  v_add_f32 v168, v128, v168
  v_mfma_f32_16x16x32_bf16 v[132:135], a[24:27], v[244:247], v[132:135]
  v_exp_f32 v129, v129
  v_mfma_f32_16x16x32_bf16 v[132:135], a[28:31], v[252:255], v[132:135]
  ds_read_b64_tr_b16 a[98:99], v174 offset:41216
  ds_read_b64_tr_b16 a[100:101], v175 offset:33024
  v_mfma_f32_16x16x32_bf16 v[136:139], a[32:35], v[192:195], v[160:163]
  ds_read_b128 a[4:7], v171 offset:0
  v_add_f32 v168, v129, v168
  v_mfma_f32_16x16x32_bf16 v[136:139], a[36:39], v[200:203], v[136:139]
  v_exp_f32 v130, v130
  v_mfma_f32_16x16x32_bf16 v[136:139], a[40:43], v[208:211], v[136:139]
  ds_read_b128 a[8:11], v172 offset:0
  v_cvt_pk_bf16_f32 v152, v128, v129
  v_mfma_f32_16x16x32_bf16 v[136:139], a[44:47], v[216:219], v[136:139]
  buffer_load_dwordx4 v188, s[20:23], s42 offen offset:2048 nt lds
  v_mfma_f32_16x16x32_bf16 v[136:139], a[48:51], v[224:227], v[136:139]
  v_exp_f32 v131, v131
  v_mfma_f32_16x16x32_bf16 v[136:139], a[52:55], v[232:235], v[136:139]
  ds_read_b64_tr_b16 a[102:103], v175 offset:41216
  ds_read_b64_tr_b16 a[104:105], v176 offset:33024
  v_mfma_f32_16x16x32_bf16 v[136:139], a[56:59], v[240:243], v[136:139]
  ds_read_b128 a[12:15], v173 offset:0
  v_add_f32 v168, v130, v168
  v_mfma_f32_16x16x32_bf16 v[136:139], a[60:63], v[248:251], v[136:139]
  v_exp_f32 v132, v132
  v_mfma_f32_16x16x32_bf16 v[140:143], a[32:35], v[196:199], v[164:167]
  ds_read_b128 a[16:19], v170 offset:256
  v_add_f32 v168, v131, v168
  v_mfma_f32_16x16x32_bf16 v[140:143], a[36:39], v[204:207], v[140:143]
  ds_read_b64_tr_b16 a[106:107], v176 offset:41216
  ds_read_b64_tr_b16 a[108:109], v177 offset:33024
  v_mfma_f32_16x16x32_bf16 v[140:143], a[40:43], v[212:215], v[140:143]
  s_waitcnt lgkmcnt(15)
  v_exp_f32 v133, v133
  v_mfma_f32_16x16x32_bf16 v[140:143], a[44:47], v[220:223], v[140:143]
  buffer_load_dwordx4 v189, s[20:23], s42 offen offset:3072 nt lds
  v_mfma_f32_16x16x32_bf16 v[140:143], a[48:51], v[228:231], v[140:143]
  ds_read_b128 a[20:23], v171 offset:256
  v_cvt_pk_bf16_f32 v153, v130, v131
  v_mfma_f32_16x16x32_bf16 v[140:143], a[52:55], v[236:239], v[140:143]
  s_add_u32 m0, s40, 0xc000
  v_exp_f32 v134, v134
  v_mfma_f32_16x16x32_bf16 v[140:143], a[56:59], v[244:247], v[140:143]
  ds_read_b128 a[24:27], v172 offset:256
  v_add_f32 v169, v132, v169
  v_mfma_f32_16x16x32_bf16 v[140:143], a[60:63], v[252:255], v[140:143]
  ds_read_b64_tr_b16 a[110:111], v177 offset:41216
  ds_read_b64_tr_b16 a[112:113], v178 offset:33024
  v_mfma_f32_16x16x32_bf16 v[0:3], a[64:67], v[144:147], v[0:3]
  v_exp_f32 v135, v135
  v_mfma_f32_16x16x32_bf16 v[4:7], a[64:67], v[148:151], v[4:7]
  ds_read_b128 a[28:31], v173 offset:256
  v_add_f32 v169, v133, v169
  v_mfma_f32_16x16x32_bf16 v[8:11], a[68:71], v[144:147], v[8:11]
  s_add_u32 s42, s42, 16384
  v_exp_f32 v136, v136
  v_mfma_f32_16x16x32_bf16 v[12:15], a[68:71], v[148:151], v[12:15]
  buffer_load_dwordx4 v182, s[16:19], s41 offen offset:0 nt lds
  v_mfma_f32_16x16x32_bf16 v[16:19], a[72:75], v[144:147], v[16:19]
  ds_read_b128 a[32:35], v170 offset:8192
  v_cvt_pk_bf16_f32 v156, v132, v133
  v_mfma_f32_16x16x32_bf16 v[20:23], a[72:75], v[148:151], v[20:23]
  s_waitcnt lgkmcnt(15)
  v_exp_f32 v137, v137
  v_mfma_f32_16x16x32_bf16 v[24:27], a[76:79], v[144:147], v[24:27]
  ds_read_b64_tr_b16 a[114:115], v178 offset:41216
  ds_read_b64_tr_b16 a[116:117], v179 offset:33024
  v_mfma_f32_16x16x32_bf16 v[28:31], a[76:79], v[148:151], v[28:31]
  ds_read_b128 a[36:39], v171 offset:8192
  v_add_f32 v169, v134, v169
  v_mfma_f32_16x16x32_bf16 v[32:35], a[80:83], v[144:147], v[32:35]
  v_exp_f32 v138, v138
  v_mfma_f32_16x16x32_bf16 v[36:39], a[80:83], v[148:151], v[36:39]
  ds_read_b128 a[40:43], v172 offset:8192
  v_add_f32 v169, v135, v169
  v_mfma_f32_16x16x32_bf16 v[40:43], a[84:87], v[144:147], v[40:43]
  v_exp_f32 v139, v139
  v_mfma_f32_16x16x32_bf16 v[44:47], a[84:87], v[148:151], v[44:47]
  buffer_load_dwordx4 v183, s[16:19], s41 offen offset:1024 nt lds
  v_mfma_f32_16x16x32_bf16 v[48:51], a[88:91], v[144:147], v[48:51]
  ds_read_b64_tr_b16 a[118:119], v179 offset:41216
  ds_read_b64_tr_b16 a[120:121], v180 offset:33024
  v_mfma_f32_16x16x32_bf16 v[52:55], a[88:91], v[148:151], v[52:55]
  s_waitcnt lgkmcnt(9)
  v_exp_f32 v140, v140
  v_mfma_f32_16x16x32_bf16 v[56:59], a[92:95], v[144:147], v[56:59]
  ds_read_b128 a[44:47], v173 offset:8192
  v_cvt_pk_bf16_f32 v157, v134, v135
  v_mfma_f32_16x16x32_bf16 v[60:63], a[92:95], v[148:151], v[60:63]
  ds_read_b128 a[48:51], v170 offset:8448
  v_add_f32 v168, v136, v168
  v_mfma_f32_16x16x32_bf16 v[64:67], a[96:99], v[144:147], v[64:67]
  v_exp_f32 v141, v141
  v_mfma_f32_16x16x32_bf16 v[68:71], a[96:99], v[148:151], v[68:71]
  ds_read_b64_tr_b16 a[122:123], v180 offset:41216
  ds_read_b64_tr_b16 a[124:125], v181 offset:33024
  v_mfma_f32_16x16x32_bf16 v[72:75], a[100:103], v[144:147], v[72:75]
  v_exp_f32 v142, v142
  v_mfma_f32_16x16x32_bf16 v[76:79], a[100:103], v[148:151], v[76:79]
  buffer_load_dwordx4 v184, s[16:19], s41 offen offset:2048 nt lds
  v_mfma_f32_16x16x32_bf16 v[80:83], a[104:107], v[144:147], v[80:83]
  ds_read_b64_tr_b16 a[126:127], v181 offset:41216
  v_add_f32 v168, v137, v168
  v_mfma_f32_16x16x32_bf16 v[84:87], a[104:107], v[148:151], v[84:87]
  s_waitcnt lgkmcnt(6)
  v_exp_f32 v143, v143
  v_mfma_f32_16x16x32_bf16 v[88:91], a[108:111], v[144:147], v[88:91]
  ds_read_b128 a[52:55], v171 offset:8448
  v_cvt_pk_bf16_f32 v154, v136, v137
  v_mfma_f32_16x16x32_bf16 v[92:95], a[108:111], v[148:151], v[92:95]
  ds_read_b128 a[56:59], v172 offset:8448
  v_add_f32 v168, v138, v168
  v_mfma_f32_16x16x32_bf16 v[96:99], a[112:115], v[144:147], v[96:99]
  ds_read_b128 a[60:63], v173 offset:8448
  v_add_f32 v168, v139, v168
  v_mfma_f32_16x16x32_bf16 v[100:103], a[112:115], v[148:151], v[100:103]
  v_cvt_pk_bf16_f32 v155, v138, v139
  v_add_f32 v169, v140, v169
  v_mfma_f32_16x16x32_bf16 v[104:107], a[116:119], v[144:147], v[104:107]
  s_waitcnt lgkmcnt(3)
  v_add_f32 v169, v141, v169
  v_mfma_f32_16x16x32_bf16 v[108:111], a[116:119], v[148:151], v[108:111]
  buffer_load_dwordx4 v185, s[16:19], s41 offen offset:3072 nt lds
  v_mfma_f32_16x16x32_bf16 v[112:115], a[120:123], v[144:147], v[112:115]
  s_add_u32 s41, s41, 16384
  v_cvt_pk_bf16_f32 v158, v140, v141
  v_mfma_f32_16x16x32_bf16 v[116:119], a[120:123], v[148:151], v[116:119]
  v_add_f32 v169, v142, v169
  v_add_f32 v169, v143, v169
  v_mfma_f32_16x16x32_bf16 v[120:123], a[124:127], v[144:147], v[120:123]
  s_cmp_eq_u32 s42, 0x108000
  v_cvt_pk_bf16_f32 v159, v142, v143
  v_mfma_f32_16x16x32_bf16 v[124:127], a[124:127], v[148:151], v[124:127]
  s_cbranch_scc1 K2_tail
  s_waitcnt vmcnt(16) lgkmcnt(0)
  s_barrier
  v_mfma_f32_16x16x32_bf16 v[128:131], a[0:3], v[192:195], v[160:163]
  ds_read_b64_tr_b16 a[64:65], v174 offset:49152
  ds_read_b64_tr_b16 a[66:67], v174 offset:57344
  v_mfma_f32_16x16x32_bf16 v[128:131], a[4:7], v[200:203], v[128:131]
  s_add_u32 m0, s40, 0x18000
  ds_read_b64_tr_b16 a[68:69], v175 offset:49152
  v_mfma_f32_16x16x32_bf16 v[128:131], a[8:11], v[208:211], v[128:131]
  ds_read_b64_tr_b16 a[70:71], v175 offset:57344
  ds_read_b64_tr_b16 a[72:73], v176 offset:49152
  v_mfma_f32_16x16x32_bf16 v[128:131], a[12:15], v[216:219], v[128:131]
  buffer_load_dwordx4 v186, s[20:23], s42 offen offset:0 nt lds
  v_mfma_f32_16x16x32_bf16 v[128:131], a[16:19], v[224:227], v[128:131]
  ds_read_b64_tr_b16 a[74:75], v176 offset:57344
  ds_read_b64_tr_b16 a[76:77], v177 offset:49152
  v_mfma_f32_16x16x32_bf16 v[128:131], a[20:23], v[232:235], v[128:131]
  ds_read_b64_tr_b16 a[78:79], v177 offset:57344
  ds_read_b64_tr_b16 a[80:81], v178 offset:49152
  v_mfma_f32_16x16x32_bf16 v[128:131], a[24:27], v[240:243], v[128:131]
  ds_read_b64_tr_b16 a[82:83], v178 offset:57344
  v_mfma_f32_16x16x32_bf16 v[128:131], a[28:31], v[248:251], v[128:131]
  ds_read_b64_tr_b16 a[84:85], v179 offset:49152
  ds_read_b64_tr_b16 a[86:87], v179 offset:57344
  v_mfma_f32_16x16x32_bf16 v[132:135], a[0:3], v[196:199], v[164:167]
  ds_read_b64_tr_b16 a[88:89], v180 offset:49152
  v_mfma_f32_16x16x32_bf16 v[132:135], a[4:7], v[204:207], v[132:135]
  ds_read_b64_tr_b16 a[90:91], v180 offset:57344
  ds_read_b64_tr_b16 a[92:93], v181 offset:49152
  v_mfma_f32_16x16x32_bf16 v[132:135], a[8:11], v[212:215], v[132:135]
  ds_read_b64_tr_b16 a[94:95], v181 offset:57344
  ds_read_b64_tr_b16 a[96:97], v174 offset:49408
  v_mfma_f32_16x16x32_bf16 v[132:135], a[12:15], v[220:223], v[132:135]
  buffer_load_dwordx4 v187, s[20:23], s42 offen offset:1024 nt lds
  v_mfma_f32_16x16x32_bf16 v[132:135], a[16:19], v[228:231], v[132:135]
  v_exp_f32 v128, v128
  v_mfma_f32_16x16x32_bf16 v[132:135], a[20:23], v[236:239], v[132:135]
  ds_read_b128 a[0:3], v170 offset:16384
  v_add_f32 v168, v128, v168
  v_mfma_f32_16x16x32_bf16 v[132:135], a[24:27], v[244:247], v[132:135]
  v_exp_f32 v129, v129
  v_mfma_f32_16x16x32_bf16 v[132:135], a[28:31], v[252:255], v[132:135]
  ds_read_b64_tr_b16 a[98:99], v174 offset:57600
  ds_read_b64_tr_b16 a[100:101], v175 offset:49408
  v_mfma_f32_16x16x32_bf16 v[136:139], a[32:35], v[192:195], v[160:163]
  ds_read_b128 a[4:7], v171 offset:16384
  v_add_f32 v168, v129, v168
  v_mfma_f32_16x16x32_bf16 v[136:139], a[36:39], v[200:203], v[136:139]
  v_exp_f32 v130, v130
  v_mfma_f32_16x16x32_bf16 v[136:139], a[40:43], v[208:211], v[136:139]
  ds_read_b128 a[8:11], v172 offset:16384
  v_cvt_pk_bf16_f32 v144, v128, v129
  v_mfma_f32_16x16x32_bf16 v[136:139], a[44:47], v[216:219], v[136:139]
  buffer_load_dwordx4 v188, s[20:23], s42 offen offset:2048 nt lds
  v_mfma_f32_16x16x32_bf16 v[136:139], a[48:51], v[224:227], v[136:139]
  v_exp_f32 v131, v131
  v_mfma_f32_16x16x32_bf16 v[136:139], a[52:55], v[232:235], v[136:139]
  ds_read_b64_tr_b16 a[102:103], v175 offset:57600
  ds_read_b64_tr_b16 a[104:105], v176 offset:49408
  v_mfma_f32_16x16x32_bf16 v[136:139], a[56:59], v[240:243], v[136:139]
  ds_read_b128 a[12:15], v173 offset:16384
  v_add_f32 v168, v130, v168
  v_mfma_f32_16x16x32_bf16 v[136:139], a[60:63], v[248:251], v[136:139]
  v_exp_f32 v132, v132
  v_mfma_f32_16x16x32_bf16 v[140:143], a[32:35], v[196:199], v[164:167]
  ds_read_b128 a[16:19], v170 offset:16640
  v_add_f32 v168, v131, v168
  v_mfma_f32_16x16x32_bf16 v[140:143], a[36:39], v[204:207], v[140:143]
  ds_read_b64_tr_b16 a[106:107], v176 offset:57600
  ds_read_b64_tr_b16 a[108:109], v177 offset:49408
  v_mfma_f32_16x16x32_bf16 v[140:143], a[40:43], v[212:215], v[140:143]
  s_waitcnt lgkmcnt(15)
  v_exp_f32 v133, v133
  v_mfma_f32_16x16x32_bf16 v[140:143], a[44:47], v[220:223], v[140:143]
  buffer_load_dwordx4 v189, s[20:23], s42 offen offset:3072 nt lds
  v_mfma_f32_16x16x32_bf16 v[140:143], a[48:51], v[228:231], v[140:143]
  ds_read_b128 a[20:23], v171 offset:16640
  v_cvt_pk_bf16_f32 v145, v130, v131
  v_mfma_f32_16x16x32_bf16 v[140:143], a[52:55], v[236:239], v[140:143]
  s_add_u32 m0, s40, 0x0
  v_exp_f32 v134, v134
  v_mfma_f32_16x16x32_bf16 v[140:143], a[56:59], v[244:247], v[140:143]
  ds_read_b128 a[24:27], v172 offset:16640
  v_add_f32 v169, v132, v169
  v_mfma_f32_16x16x32_bf16 v[140:143], a[60:63], v[252:255], v[140:143]
  ds_read_b64_tr_b16 a[110:111], v177 offset:57600
  ds_read_b64_tr_b16 a[112:113], v178 offset:49408
  v_mfma_f32_16x16x32_bf16 v[0:3], a[64:67], v[152:155], v[0:3]
  v_exp_f32 v135, v135
  v_mfma_f32_16x16x32_bf16 v[4:7], a[64:67], v[156:159], v[4:7]
  ds_read_b128 a[28:31], v173 offset:16640
  v_add_f32 v169, v133, v169
  v_mfma_f32_16x16x32_bf16 v[8:11], a[68:71], v[152:155], v[8:11]
  s_add_u32 s42, s42, 16384
  v_exp_f32 v136, v136
  v_mfma_f32_16x16x32_bf16 v[12:15], a[68:71], v[156:159], v[12:15]
  buffer_load_dwordx4 v182, s[16:19], s41 offen offset:0 nt lds
  v_mfma_f32_16x16x32_bf16 v[16:19], a[72:75], v[152:155], v[16:19]
  ds_read_b128 a[32:35], v170 offset:24576
  v_cvt_pk_bf16_f32 v148, v132, v133
  v_mfma_f32_16x16x32_bf16 v[20:23], a[72:75], v[156:159], v[20:23]
  s_waitcnt lgkmcnt(15)
  v_exp_f32 v137, v137
  v_mfma_f32_16x16x32_bf16 v[24:27], a[76:79], v[152:155], v[24:27]
  ds_read_b64_tr_b16 a[114:115], v178 offset:57600
  ds_read_b64_tr_b16 a[116:117], v179 offset:49408
  v_mfma_f32_16x16x32_bf16 v[28:31], a[76:79], v[156:159], v[28:31]
  ds_read_b128 a[36:39], v171 offset:24576
  v_add_f32 v169, v134, v169
  v_mfma_f32_16x16x32_bf16 v[32:35], a[80:83], v[152:155], v[32:35]
  v_exp_f32 v138, v138
  v_mfma_f32_16x16x32_bf16 v[36:39], a[80:83], v[156:159], v[36:39]
  ds_read_b128 a[40:43], v172 offset:24576
  v_add_f32 v169, v135, v169
  v_mfma_f32_16x16x32_bf16 v[40:43], a[84:87], v[152:155], v[40:43]
  v_exp_f32 v139, v139
  v_mfma_f32_16x16x32_bf16 v[44:47], a[84:87], v[156:159], v[44:47]
  buffer_load_dwordx4 v183, s[16:19], s41 offen offset:1024 nt lds
  v_mfma_f32_16x16x32_bf16 v[48:51], a[88:91], v[152:155], v[48:51]
  ds_read_b64_tr_b16 a[118:119], v179 offset:57600
  ds_read_b64_tr_b16 a[120:121], v180 offset:49408
  v_mfma_f32_16x16x32_bf16 v[52:55], a[88:91], v[156:159], v[52:55]
  s_waitcnt lgkmcnt(9)
  v_exp_f32 v140, v140
  v_mfma_f32_16x16x32_bf16 v[56:59], a[92:95], v[152:155], v[56:59]
  ds_read_b128 a[44:47], v173 offset:24576
  v_cvt_pk_bf16_f32 v149, v134, v135
  v_mfma_f32_16x16x32_bf16 v[60:63], a[92:95], v[156:159], v[60:63]
  ds_read_b128 a[48:51], v170 offset:24832
  v_add_f32 v168, v136, v168
  v_mfma_f32_16x16x32_bf16 v[64:67], a[96:99], v[152:155], v[64:67]
  v_exp_f32 v141, v141
  v_mfma_f32_16x16x32_bf16 v[68:71], a[96:99], v[156:159], v[68:71]
  ds_read_b64_tr_b16 a[122:123], v180 offset:57600
  ds_read_b64_tr_b16 a[124:125], v181 offset:49408
  v_mfma_f32_16x16x32_bf16 v[72:75], a[100:103], v[152:155], v[72:75]
  v_exp_f32 v142, v142
  v_mfma_f32_16x16x32_bf16 v[76:79], a[100:103], v[156:159], v[76:79]
  buffer_load_dwordx4 v184, s[16:19], s41 offen offset:2048 nt lds
  v_mfma_f32_16x16x32_bf16 v[80:83], a[104:107], v[152:155], v[80:83]
  ds_read_b64_tr_b16 a[126:127], v181 offset:57600
  v_add_f32 v168, v137, v168
  v_mfma_f32_16x16x32_bf16 v[84:87], a[104:107], v[156:159], v[84:87]
  s_waitcnt lgkmcnt(6)
  v_exp_f32 v143, v143
  v_mfma_f32_16x16x32_bf16 v[88:91], a[108:111], v[152:155], v[88:91]
  ds_read_b128 a[52:55], v171 offset:24832
  v_cvt_pk_bf16_f32 v146, v136, v137
  v_mfma_f32_16x16x32_bf16 v[92:95], a[108:111], v[156:159], v[92:95]
  ds_read_b128 a[56:59], v172 offset:24832
  v_add_f32 v168, v138, v168
  v_mfma_f32_16x16x32_bf16 v[96:99], a[112:115], v[152:155], v[96:99]
  ds_read_b128 a[60:63], v173 offset:24832
  v_add_f32 v168, v139, v168
  v_mfma_f32_16x16x32_bf16 v[100:103], a[112:115], v[156:159], v[100:103]
  v_cvt_pk_bf16_f32 v147, v138, v139
  v_add_f32 v169, v140, v169
  v_mfma_f32_16x16x32_bf16 v[104:107], a[116:119], v[152:155], v[104:107]
  s_waitcnt lgkmcnt(3)
  v_add_f32 v169, v141, v169
  v_mfma_f32_16x16x32_bf16 v[108:111], a[116:119], v[156:159], v[108:111]
  buffer_load_dwordx4 v185, s[16:19], s41 offen offset:3072 nt lds
  v_mfma_f32_16x16x32_bf16 v[112:115], a[120:123], v[152:155], v[112:115]
  s_add_u32 s41, s41, 16384
  v_cvt_pk_bf16_f32 v150, v140, v141
  v_mfma_f32_16x16x32_bf16 v[116:119], a[120:123], v[156:159], v[116:119]
  v_add_f32 v169, v142, v169
  v_add_f32 v169, v143, v169
  v_mfma_f32_16x16x32_bf16 v[120:123], a[124:127], v[152:155], v[120:123]
  v_cvt_pk_bf16_f32 v151, v142, v143
  v_mfma_f32_16x16x32_bf16 v[124:127], a[124:127], v[156:159], v[124:127]
  s_add_u32 s53, s53, 1024
  buffer_load_dwordx4 a[128:131], v190, s[56:59], s53 offen
  s_branch K2_loop
K2_tail:
  s_waitcnt vmcnt(0) lgkmcnt(0)
  s_barrier
  ds_read_b64_tr_b16 a[64:65], v174 offset:49152
  ds_read_b64_tr_b16 a[66:67], v174 offset:57344
  ds_read_b64_tr_b16 a[68:69], v175 offset:49152
  ds_read_b64_tr_b16 a[70:71], v175 offset:57344
  ds_read_b64_tr_b16 a[72:73], v176 offset:49152
  ds_read_b64_tr_b16 a[74:75], v176 offset:57344
  ds_read_b64_tr_b16 a[76:77], v177 offset:49152
  ds_read_b64_tr_b16 a[78:79], v177 offset:57344
  ds_read_b64_tr_b16 a[80:81], v178 offset:49152
  ds_read_b64_tr_b16 a[82:83], v178 offset:57344
  ds_read_b64_tr_b16 a[84:85], v179 offset:49152
  ds_read_b64_tr_b16 a[86:87], v179 offset:57344
  ds_read_b64_tr_b16 a[88:89], v180 offset:49152
  ds_read_b64_tr_b16 a[90:91], v180 offset:57344
  ds_read_b64_tr_b16 a[92:93], v181 offset:49152
  ds_read_b64_tr_b16 a[94:95], v181 offset:57344
  ds_read_b64_tr_b16 a[96:97], v174 offset:49408
  ds_read_b64_tr_b16 a[98:99], v174 offset:57600
  ds_read_b64_tr_b16 a[100:101], v175 offset:49408
  ds_read_b64_tr_b16 a[102:103], v175 offset:57600
  ds_read_b64_tr_b16 a[104:105], v176 offset:49408
  ds_read_b64_tr_b16 a[106:107], v176 offset:57600
  ds_read_b64_tr_b16 a[108:109], v177 offset:49408
  ds_read_b64_tr_b16 a[110:111], v177 offset:57600
  ds_read_b64_tr_b16 a[112:113], v178 offset:49408
  ds_read_b64_tr_b16 a[114:115], v178 offset:57600
  ds_read_b64_tr_b16 a[116:117], v179 offset:49408
  ds_read_b64_tr_b16 a[118:119], v179 offset:57600
  ds_read_b64_tr_b16 a[120:121], v180 offset:49408
  ds_read_b64_tr_b16 a[122:123], v180 offset:57600
  ds_read_b64_tr_b16 a[124:125], v181 offset:49408
  ds_read_b64_tr_b16 a[126:127], v181 offset:57600
  v_mov_b32 v128, v168
  s_nop 1
  v_permlane32_swap_b32 v168, v128
  s_nop 1
  v_add_f32 v168, v168, v128
  v_mov_b32 v128, v168
  s_nop 1
  v_permlane16_swap_b32 v168, v128
  s_nop 1
  v_add_f32 v168, v168, v128
  v_mov_b32 v132, v169
  s_nop 1
  v_permlane32_swap_b32 v169, v132
  s_nop 1
  v_add_f32 v169, v169, v132
  v_mov_b32 v132, v169
  s_nop 1
  v_permlane16_swap_b32 v169, v132
  s_nop 1
  v_add_f32 v169, v169, v132
  s_mov_b32 s44, 0x67800000
  v_add_f32 v129, v168, v169
  v_cmp_ngt_f32 vcc, s44, v129
  v_rcp_f32 v168, v168
  v_rcp_f32 v169, v169
  s_cmp_lg_u64 vcc, 0
  s_cselect_b32 s45, 1, 0
  v_mov_b32 v130, s45
  s_lshl_b32 s44, s14, 2
  s_add_u32 s44, s44, 98304
  v_mov_b32 v131, s44
  ds_write_b32 v131, v130
  s_waitcnt lgkmcnt(15)
  v_mfma_f32_16x16x32_bf16 v[0:3], a[64:67], v[152:155], v[0:3]
  v_mfma_f32_16x16x32_bf16 v[4:7], a[64:67], v[156:159], v[4:7]
  v_mfma_f32_16x16x32_bf16 v[8:11], a[68:71], v[152:155], v[8:11]
  v_mfma_f32_16x16x32_bf16 v[12:15], a[68:71], v[156:159], v[12:15]
  v_mfma_f32_16x16x32_bf16 v[16:19], a[72:75], v[152:155], v[16:19]
  v_mfma_f32_16x16x32_bf16 v[20:23], a[72:75], v[156:159], v[20:23]
  v_mfma_f32_16x16x32_bf16 v[24:27], a[76:79], v[152:155], v[24:27]
  v_mfma_f32_16x16x32_bf16 v[28:31], a[76:79], v[156:159], v[28:31]
  s_waitcnt lgkmcnt(15)
  v_mfma_f32_16x16x32_bf16 v[32:35], a[80:83], v[152:155], v[32:35]
  v_mfma_f32_16x16x32_bf16 v[36:39], a[80:83], v[156:159], v[36:39]
  v_mfma_f32_16x16x32_bf16 v[40:43], a[84:87], v[152:155], v[40:43]
  v_mul_f32 v0, v0, v168
  v_mul_f32 v8, v8, v168
  v_mfma_f32_16x16x32_bf16 v[44:47], a[84:87], v[156:159], v[44:47]
  v_mul_f32 v1, v1, v168
  v_mul_f32 v9, v9, v168
  v_mfma_f32_16x16x32_bf16 v[48:51], a[88:91], v[152:155], v[48:51]
  v_mul_f32 v2, v2, v168
  v_mul_f32 v10, v10, v168
  v_mfma_f32_16x16x32_bf16 v[52:55], a[88:91], v[156:159], v[52:55]
  v_mul_f32 v3, v3, v168
  v_mul_f32 v11, v11, v168
  v_mfma_f32_16x16x32_bf16 v[56:59], a[92:95], v[152:155], v[56:59]
  v_cvt_pk_bf16_f32 v0, v0, v1
  v_cvt_pk_bf16_f32 v1, v2, v3
  v_mfma_f32_16x16x32_bf16 v[60:63], a[92:95], v[156:159], v[60:63]
  v_cvt_pk_bf16_f32 v2, v8, v9
  v_cvt_pk_bf16_f32 v3, v10, v11
  s_waitcnt lgkmcnt(9)
  v_mfma_f32_16x16x32_bf16 v[64:67], a[96:99], v[152:155], v[64:67]
  buffer_store_dwordx4 v[0:3], v190, s[36:39], 0 offen offset:0 sc1
  v_mfma_f32_16x16x32_bf16 v[68:71], a[96:99], v[156:159], v[68:71]
  v_mul_f32 v4, v4, v169
  v_mul_f32 v12, v12, v169
  v_mfma_f32_16x16x32_bf16 v[72:75], a[100:103], v[152:155], v[72:75]
  v_mul_f32 v5, v5, v169
  v_mul_f32 v13, v13, v169
  v_mfma_f32_16x16x32_bf16 v[76:79], a[100:103], v[156:159], v[76:79]
  v_mul_f32 v6, v6, v169
  v_mul_f32 v14, v14, v169
  v_mfma_f32_16x16x32_bf16 v[80:83], a[104:107], v[152:155], v[80:83]
  v_mul_f32 v7, v7, v169
  v_mul_f32 v15, v15, v169
  v_mfma_f32_16x16x32_bf16 v[84:87], a[104:107], v[156:159], v[84:87]
  v_cvt_pk_bf16_f32 v4, v4, v5
  v_cvt_pk_bf16_f32 v5, v6, v7
  v_mfma_f32_16x16x32_bf16 v[88:91], a[108:111], v[152:155], v[88:91]
  v_cvt_pk_bf16_f32 v6, v12, v13
  v_cvt_pk_bf16_f32 v7, v14, v15
  v_mfma_f32_16x16x32_bf16 v[92:95], a[108:111], v[156:159], v[92:95]
  buffer_store_dwordx4 v[4:7], v191, s[36:39], 0 offen offset:0 sc1
  s_waitcnt lgkmcnt(1)
  v_mfma_f32_16x16x32_bf16 v[96:99], a[112:115], v[152:155], v[96:99]
  v_mul_f32 v16, v16, v168
  v_mul_f32 v24, v24, v168
  v_mfma_f32_16x16x32_bf16 v[100:103], a[112:115], v[156:159], v[100:103]
  v_mul_f32 v17, v17, v168
  v_mul_f32 v25, v25, v168
  v_mfma_f32_16x16x32_bf16 v[104:107], a[116:119], v[152:155], v[104:107]
  v_mul_f32 v18, v18, v168
  v_mul_f32 v26, v26, v168
  v_mfma_f32_16x16x32_bf16 v[108:111], a[116:119], v[156:159], v[108:111]
  v_mul_f32 v19, v19, v168
  v_mul_f32 v27, v27, v168
  v_mfma_f32_16x16x32_bf16 v[112:115], a[120:123], v[152:155], v[112:115]
  v_cvt_pk_bf16_f32 v16, v16, v17
  v_cvt_pk_bf16_f32 v17, v18, v19
  v_mfma_f32_16x16x32_bf16 v[116:119], a[120:123], v[156:159], v[116:119]
  v_cvt_pk_bf16_f32 v18, v24, v25
  v_cvt_pk_bf16_f32 v19, v26, v27
  v_mfma_f32_16x16x32_bf16 v[120:123], a[124:127], v[152:155], v[120:123]
  buffer_store_dwordx4 v[16:19], v190, s[36:39], 0 offen offset:1024 sc1
  v_mfma_f32_16x16x32_bf16 v[124:127], a[124:127], v[156:159], v[124:127]
  v_mul_f32 v20, v20, v169
  v_mul_f32 v28, v28, v169
  v_mul_f32 v21, v21, v169
  v_mul_f32 v29, v29, v169
  v_mul_f32 v22, v22, v169
  v_mul_f32 v30, v30, v169
  v_mul_f32 v23, v23, v169
  v_mul_f32 v31, v31, v169
  v_cvt_pk_bf16_f32 v20, v20, v21
  v_cvt_pk_bf16_f32 v21, v22, v23
  v_cvt_pk_bf16_f32 v22, v28, v29
  v_cvt_pk_bf16_f32 v23, v30, v31
  buffer_store_dwordx4 v[20:23], v191, s[36:39], 0 offen offset:1024 sc1
  v_mul_f32 v32, v32, v168
  v_mul_f32 v40, v40, v168
  v_mul_f32 v33, v33, v168
  v_mul_f32 v41, v41, v168
  v_mul_f32 v34, v34, v168
  v_mul_f32 v42, v42, v168
  v_mul_f32 v35, v35, v168
  v_mul_f32 v43, v43, v168
  v_cvt_pk_bf16_f32 v32, v32, v33
  v_cvt_pk_bf16_f32 v33, v34, v35
  v_cvt_pk_bf16_f32 v34, v40, v41
  v_cvt_pk_bf16_f32 v35, v42, v43
  buffer_store_dwordx4 v[32:35], v190, s[36:39], 0 offen offset:2048 sc1
  v_mul_f32 v36, v36, v169
  v_mul_f32 v44, v44, v169
  v_mul_f32 v37, v37, v169
  v_mul_f32 v45, v45, v169
  v_mul_f32 v38, v38, v169
  v_mul_f32 v46, v46, v169
  v_mul_f32 v39, v39, v169
  v_mul_f32 v47, v47, v169
  v_cvt_pk_bf16_f32 v36, v36, v37
  v_cvt_pk_bf16_f32 v37, v38, v39
  v_cvt_pk_bf16_f32 v38, v44, v45
  v_cvt_pk_bf16_f32 v39, v46, v47
  buffer_store_dwordx4 v[36:39], v191, s[36:39], 0 offen offset:2048 sc1
  v_pk_mul_f32 v[48:49], v[48:49], v[168:169] op_sel:[0,0] op_sel_hi:[1,0]
  v_pk_mul_f32 v[50:51], v[50:51], v[168:169] op_sel:[0,0] op_sel_hi:[1,0]
  v_pk_mul_f32 v[56:57], v[56:57], v[168:169] op_sel:[0,0] op_sel_hi:[1,0]
  v_pk_mul_f32 v[58:59], v[58:59], v[168:169] op_sel:[0,0] op_sel_hi:[1,0]
  v_cvt_pk_bf16_f32 v48, v48, v49
  v_cvt_pk_bf16_f32 v49, v50, v51
  v_cvt_pk_bf16_f32 v50, v56, v57
  v_cvt_pk_bf16_f32 v51, v58, v59
  buffer_store_dwordx4 v[48:51], v190, s[36:39], 0 offen offset:3072 sc1
  v_pk_mul_f32 v[52:53], v[52:53], v[168:169] op_sel:[0,1] op_sel_hi:[1,1]
  v_pk_mul_f32 v[54:55], v[54:55], v[168:169] op_sel:[0,1] op_sel_hi:[1,1]
  v_pk_mul_f32 v[60:61], v[60:61], v[168:169] op_sel:[0,1] op_sel_hi:[1,1]
  v_pk_mul_f32 v[62:63], v[62:63], v[168:169] op_sel:[0,1] op_sel_hi:[1,1]
  v_cvt_pk_bf16_f32 v52, v52, v53
  v_cvt_pk_bf16_f32 v53, v54, v55
  v_cvt_pk_bf16_f32 v54, v60, v61
  v_cvt_pk_bf16_f32 v55, v62, v63
  buffer_store_dwordx4 v[52:55], v191, s[36:39], 0 offen offset:3072 sc1
  v_pk_mul_f32 v[64:65], v[64:65], v[168:169] op_sel:[0,0] op_sel_hi:[1,0]
  v_pk_mul_f32 v[66:67], v[66:67], v[168:169] op_sel:[0,0] op_sel_hi:[1,0]
  v_pk_mul_f32 v[72:73], v[72:73], v[168:169] op_sel:[0,0] op_sel_hi:[1,0]
  v_pk_mul_f32 v[74:75], v[74:75], v[168:169] op_sel:[0,0] op_sel_hi:[1,0]
  v_cvt_pk_bf16_f32 v64, v64, v65
  v_cvt_pk_bf16_f32 v65, v66, v67
  v_cvt_pk_bf16_f32 v66, v72, v73
  v_cvt_pk_bf16_f32 v67, v74, v75
  buffer_store_dwordx4 v[64:67], v190, s[36:39], s46 offen offset:0 sc1
  v_pk_mul_f32 v[68:69], v[68:69], v[168:169] op_sel:[0,1] op_sel_hi:[1,1]
  v_pk_mul_f32 v[70:71], v[70:71], v[168:169] op_sel:[0,1] op_sel_hi:[1,1]
  v_pk_mul_f32 v[76:77], v[76:77], v[168:169] op_sel:[0,1] op_sel_hi:[1,1]
  v_pk_mul_f32 v[78:79], v[78:79], v[168:169] op_sel:[0,1] op_sel_hi:[1,1]
  v_cvt_pk_bf16_f32 v68, v68, v69
  v_cvt_pk_bf16_f32 v69, v70, v71
  v_cvt_pk_bf16_f32 v70, v76, v77
  v_cvt_pk_bf16_f32 v71, v78, v79
  buffer_store_dwordx4 v[68:71], v191, s[36:39], s46 offen offset:0 sc1
  v_pk_mul_f32 v[80:81], v[80:81], v[168:169] op_sel:[0,0] op_sel_hi:[1,0]
  v_pk_mul_f32 v[82:83], v[82:83], v[168:169] op_sel:[0,0] op_sel_hi:[1,0]
  v_pk_mul_f32 v[88:89], v[88:89], v[168:169] op_sel:[0,0] op_sel_hi:[1,0]
  v_pk_mul_f32 v[90:91], v[90:91], v[168:169] op_sel:[0,0] op_sel_hi:[1,0]
  v_cvt_pk_bf16_f32 v80, v80, v81
  v_cvt_pk_bf16_f32 v81, v82, v83
  v_cvt_pk_bf16_f32 v82, v88, v89
  v_cvt_pk_bf16_f32 v83, v90, v91
  buffer_store_dwordx4 v[80:83], v190, s[36:39], s46 offen offset:1024 sc1
  v_pk_mul_f32 v[84:85], v[84:85], v[168:169] op_sel:[0,1] op_sel_hi:[1,1]
  v_pk_mul_f32 v[86:87], v[86:87], v[168:169] op_sel:[0,1] op_sel_hi:[1,1]
  v_pk_mul_f32 v[92:93], v[92:93], v[168:169] op_sel:[0,1] op_sel_hi:[1,1]
  v_pk_mul_f32 v[94:95], v[94:95], v[168:169] op_sel:[0,1] op_sel_hi:[1,1]
  v_cvt_pk_bf16_f32 v84, v84, v85
  v_cvt_pk_bf16_f32 v85, v86, v87
  v_cvt_pk_bf16_f32 v86, v92, v93
  v_cvt_pk_bf16_f32 v87, v94, v95
  buffer_store_dwordx4 v[84:87], v191, s[36:39], s46 offen offset:1024 sc1
  v_pk_mul_f32 v[96:97], v[96:97], v[168:169] op_sel:[0,0] op_sel_hi:[1,0]
  v_pk_mul_f32 v[98:99], v[98:99], v[168:169] op_sel:[0,0] op_sel_hi:[1,0]
  v_pk_mul_f32 v[104:105], v[104:105], v[168:169] op_sel:[0,0] op_sel_hi:[1,0]
  v_pk_mul_f32 v[106:107], v[106:107], v[168:169] op_sel:[0,0] op_sel_hi:[1,0]
  v_cvt_pk_bf16_f32 v96, v96, v97
  v_cvt_pk_bf16_f32 v97, v98, v99
  v_cvt_pk_bf16_f32 v98, v104, v105
  v_cvt_pk_bf16_f32 v99, v106, v107
  buffer_store_dwordx4 v[96:99], v190, s[36:39], s46 offen offset:2048 sc1
  v_pk_mul_f32 v[100:101], v[100:101], v[168:169] op_sel:[0,1] op_sel_hi:[1,1]
  v_pk_mul_f32 v[102:103], v[102:103], v[168:169] op_sel:[0,1] op_sel_hi:[1,1]
  v_pk_mul_f32 v[108:109], v[108:109], v[168:169] op_sel:[0,1] op_sel_hi:[1,1]
  v_pk_mul_f32 v[110:111], v[110:111], v[168:169] op_sel:[0,1] op_sel_hi:[1,1]
  v_cvt_pk_bf16_f32 v100, v100, v101
  v_cvt_pk_bf16_f32 v101, v102, v103
  v_cvt_pk_bf16_f32 v102, v108, v109
  v_cvt_pk_bf16_f32 v103, v110, v111
  buffer_store_dwordx4 v[100:103], v191, s[36:39], s46 offen offset:2048 sc1
  v_pk_mul_f32 v[112:113], v[112:113], v[168:169] op_sel:[0,0] op_sel_hi:[1,0]
  v_pk_mul_f32 v[114:115], v[114:115], v[168:169] op_sel:[0,0] op_sel_hi:[1,0]
  v_pk_mul_f32 v[120:121], v[120:121], v[168:169] op_sel:[0,0] op_sel_hi:[1,0]
  v_pk_mul_f32 v[122:123], v[122:123], v[168:169] op_sel:[0,0] op_sel_hi:[1,0]
  v_cvt_pk_bf16_f32 v112, v112, v113
  v_cvt_pk_bf16_f32 v113, v114, v115
  v_cvt_pk_bf16_f32 v114, v120, v121
  v_cvt_pk_bf16_f32 v115, v122, v123
  buffer_store_dwordx4 v[112:115], v190, s[36:39], s46 offen offset:3072 sc1
  v_pk_mul_f32 v[116:117], v[116:117], v[168:169] op_sel:[0,1] op_sel_hi:[1,1]
  v_pk_mul_f32 v[118:119], v[118:119], v[168:169] op_sel:[0,1] op_sel_hi:[1,1]
  v_pk_mul_f32 v[124:125], v[124:125], v[168:169] op_sel:[0,1] op_sel_hi:[1,1]
  v_pk_mul_f32 v[126:127], v[126:127], v[168:169] op_sel:[0,1] op_sel_hi:[1,1]
  v_cvt_pk_bf16_f32 v116, v116, v117
  v_cvt_pk_bf16_f32 v117, v118, v119
  v_cvt_pk_bf16_f32 v118, v124, v125
  v_cvt_pk_bf16_f32 v119, v126, v127
  buffer_store_dwordx4 v[116:119], v191, s[36:39], s46 offen offset:3072 sc1
  s_cmp_ge_u32 s68, 28
  s_cbranch_scc1 K2_np
  v_mbcnt_lo_u32_b32 v148, -1, 0
  v_mbcnt_hi_u32_b32 v148, -1, v148
  v_bfe_u32 v149, v148, 4, 2
  v_lshlrev_b32 v149, 1, v149
  v_and_b32 v150, 7, v148
  v_xor_b32 v149, v149, v150
  v_lshlrev_b32 v149, 4, v149
  v_lshrrev_b32 v150, 3, v148
  v_mul_u32_u24 v150, 896, v150
  v_add_u32 v144, v149, v150
  v_add_u32 v145, 6144, v144
  v_add_u32 v146, 12288, v144
  v_add_u32 v147, 18432, v144
  s_mul_i32 s73, s14, 114688
  s_lshl_b32 s74, s70, 7
  s_add_u32 s73, s73, s74
  s_mov_b32 s24, s60
  s_mov_b32 s25, s61
  s_add_u32 s24, s24, s73
  s_addc_u32 s25, s25, 0
  s_and_b32 s25, s25, 0xffff
  s_mov_b32 s26, 0x0
  s_mov_b32 s27, 0x20000
  s_sub_u32 s26, 3670016, s73
  s_and_b32 s72, s2, 7
  s_mul_i32 s72, s72, 32
  s_lshr_b32 s72, s72, 3
  s_mov_b32 s49, s72
  s_and_b32 s49, s2, 7
  s_lshl_b32 s49, s49, 4
  s_add_u32 s48, s70, s69
  s_add_u32 m0, s71, 0
  s_add_u32 s73, s48, 0
  s_and_b32 s73, s73, 3
  s_add_u32 s51, s49, s73
  s_mul_i32 s50, s51, 28672
  s_lshl_b32 s51, s51, 10
  buffer_load_dwordx4 v144, s[24:27], s50 offen offset:0 lds
  buffer_load_dwordx4 v145, s[24:27], s50 offen offset:1024 lds
  buffer_load_dwordx4 v146, s[24:27], s50 offen offset:2048 lds
  buffer_load_dwordx4 v147, s[24:27], s50 offen offset:3072 lds
  s_add_u32 m0, s71, 4096
  s_add_u32 s73, s48, 1
  s_and_b32 s73, s73, 3
  s_add_u32 s51, s49, s73
  s_mul_i32 s50, s51, 28672
  s_lshl_b32 s51, s51, 10
  buffer_load_dwordx4 v144, s[24:27], s50 offen offset:0 lds
  buffer_load_dwordx4 v145, s[24:27], s50 offen offset:1024 lds
  buffer_load_dwordx4 v146, s[24:27], s50 offen offset:2048 lds
  buffer_load_dwordx4 v147, s[24:27], s50 offen offset:3072 lds
  s_waitcnt vmcnt(8)
  s_branch K2_nj
K2_np:
  s_waitcnt vmcnt(0)
K2_nj:
  v_mov_b32 v131, 98304
  s_waitcnt lgkmcnt(0)
  s_barrier
  s_cmp_lg_u32 s43, 0
  s_cbranch_scc1 K2_go
  ds_read_b128 v[132:135], v131
  s_waitcnt lgkmcnt(0)
  v_or3_b32 v132, v132, v133, v134
  v_or_b32 v132, v132, v135
  s_nop 0
  v_readfirstlane_b32 s44, v132
  s_nop 3
  s_cmp_lg_u32 s44, 0
  s_cbranch_scc1 K2_fb
K2_go:
  s_lshl_b32 s44, s13, 7
  s_lshl_b32 s45, s12, 2
  s_add_u32 s44, s44, s45
  s_cmp_lg_u32 s14, 0
  s_cbranch_scc1 K2_a_nf
  v_mov_b32 v8, 0
  v_mov_b32 v9, s75
  s_mov_b64 exec, 1
  buffer_store_dword v9, v8, s[32:35], s44 offen sc1
  s_mov_b64 exec, -1
K2_a_nf:
  s_cmp_ge_u32 s68, 28
  s_cbranch_scc1 K2_uw
  s_add_u32 m0, s71, 8192
  s_add_u32 s73, s48, 2
  s_and_b32 s73, s73, 3
  s_add_u32 s51, s49, s73
  s_mul_i32 s50, s51, 28672
  s_lshl_b32 s51, s51, 10
  buffer_load_dwordx4 v144, s[24:27], s50 offen offset:0 lds
  buffer_load_dwordx4 v145, s[24:27], s50 offen offset:1024 lds
  buffer_load_dwordx4 v146, s[24:27], s50 offen offset:2048 lds
  buffer_load_dwordx4 v147, s[24:27], s50 offen offset:3072 lds
  s_add_u32 m0, s71, 12288
  s_add_u32 s73, s48, 3
  s_and_b32 s73, s73, 3
  s_add_u32 s51, s49, s73
  s_mul_i32 s50, s51, 28672
  s_lshl_b32 s51, s51, 10
  buffer_load_dwordx4 v144, s[24:27], s50 offen offset:0 lds
  buffer_load_dwordx4 v145, s[24:27], s50 offen offset:1024 lds
  buffer_load_dwordx4 v146, s[24:27], s50 offen offset:2048 lds
  buffer_load_dwordx4 v147, s[24:27], s50 offen offset:3072 lds
  s_add_u32 s51, s49, 16
  s_and_b32 s51, s51, 127
  s_add_u32 m0, s71, 16384
  s_add_u32 s73, s48, 0
  s_and_b32 s73, s73, 3
  s_add_u32 s51, s51, s73
  s_mul_i32 s50, s51, 28672
  buffer_load_dwordx4 v144, s[24:27], s50 offen offset:0 lds
  buffer_load_dwordx4 v145, s[24:27], s50 offen offset:1024 lds
  buffer_load_dwordx4 v146, s[24:27], s50 offen offset:2048 lds
  buffer_load_dwordx4 v147, s[24:27], s50 offen offset:3072 lds
  s_add_u32 s51, s49, 16
  s_and_b32 s51, s51, 127
  s_add_u32 m0, s71, 20480
  s_add_u32 s73, s48, 1
  s_and_b32 s73, s73, 3
  s_add_u32 s51, s51, s73
  s_mul_i32 s50, s51, 28672
  buffer_load_dwordx4 v144, s[24:27], s50 offen offset:0 lds
  buffer_load_dwordx4 v145, s[24:27], s50 offen offset:1024 lds
  buffer_load_dwordx4 v146, s[24:27], s50 offen offset:2048 lds
  buffer_load_dwordx4 v147, s[24:27], s50 offen offset:3072 lds
  s_add_u32 s51, s49, 16
  s_and_b32 s51, s51, 127
  s_add_u32 m0, s71, 24576
  s_add_u32 s73, s48, 2
  s_and_b32 s73, s73, 3
  s_add_u32 s51, s51, s73
  s_mul_i32 s50, s51, 28672
  buffer_load_dwordx4 v144, s[24:27], s50 offen offset:0 lds
  buffer_load_dwordx4 v145, s[24:27], s50 offen offset:1024 lds
  buffer_load_dwordx4 v146, s[24:27], s50 offen offset:2048 lds
  buffer_load_dwordx4 v147, s[24:27], s50 offen offset:3072 lds
  v_mbcnt_lo_u32_b32 v156, -1, 0
  v_mbcnt_hi_u32_b32 v156, -1, v156
  v_bfe_u32 v157, v156, 4, 2
  v_lshlrev_b32 v152, 4, v156
  v_mov_b32 v243, v152
  s_add_u32 s73, s14, 0
  s_and_b32 s73, s73, 3
  s_mul_i32 s73, s73, 131072
  v_add_u32 v152, s73, v243
  s_add_u32 s73, s14, 1
  s_and_b32 s73, s73, 3
  s_mul_i32 s73, s73, 131072
  v_add_u32 v153, s73, v243
  s_add_u32 s73, s14, 2
  s_and_b32 s73, s73, 3
  s_mul_i32 s73, s73, 131072
  v_add_u32 v154, s73, v243
  s_add_u32 s73, s14, 3
  s_and_b32 s73, s73, 3
  s_mul_i32 s73, s73, 131072
  v_add_u32 v155, s73, v243
  s_mul_i32 s73, s69, 524288
  s_mul_i32 s74, s14, 4096
  s_add_u32 s73, s73, s74
  s_add_u32 s28, s10, 0x1000000
  s_addc_u32 s29, s11, 0
  s_add_u32 s28, s28, s73
  s_addc_u32 s29, s29, 0
  s_and_b32 s29, s29, 0xffff
  s_mov_b32 s30, 0x0
  s_mov_b32 s31, 0x20000
  s_sub_u32 s30, 16777216, s73
  v_bfe_u32 v158, v156, 2, 4
  v_bfe_u32 v159, v158, 1, 2
  v_lshlrev_b32 v158, 7, v158
  v_and_b32 v136, 3, v156
  v_lshl_add_u32 v158, v136, 3, v158
  v_add_u32 v158, s71, v158
  v_xor_b32 v136, 0, v159
  v_lshl_add_u32 v148, v136, 5, v158
  v_xor_b32 v136, 1, v159
  v_lshl_add_u32 v149, v136, 5, v158
  v_xor_b32 v136, 2, v159
  v_lshl_add_u32 v150, v136, 5, v158
  v_xor_b32 v136, 3, v159
  v_lshl_add_u32 v151, v136, 5, v158
  s_lshr_b32 s44, s69, 1
  s_lshl_b32 s44, s44, 7
  v_lshlrev_b32 v158, 2, v156
  v_add_u32 v158, s44, v158
  v_add_u32 v0, 8640, v243
  s_and_b32 s45, s2, 7
  s_lshl_b32 s45, s45, 1
  s_lshl_b32 s43, 1, s45
  s_mov_b32 s74, 0x8000
K2_a_pl:
  buffer_load_dword v159, v158, s[32:35], 0 offen sc1
  buffer_load_dword v1, v0, s[32:35], 0 offen sc1
  s_waitcnt vmcnt(0)
  v_cmp_eq_u32 vcc, s75, v1
  s_nop 1
  s_bcnt1_i32_b64 s46, vcc
  v_cmp_eq_u32 vcc, s75, v159
  s_nop 1
  s_lshr_b32 s73, vcc_lo, 1
  s_and_b32 s73, s73, vcc_lo
  s_and_b32 s72, s73, 0x5555
  s_cmp_ge_u32 s46, 56
  s_cselect_b32 s73, s72, 0
  s_and_b32 s73, s73, s43
  s_cbranch_scc1 K2_a_pd
  s_sleep 2
  s_sub_u32 s74, s74, 1
  s_cmp_lg_u32 s74, 0
  s_cbranch_scc1 K2_a_pl
K2_a_pd:
  s_add_u32 s73, s48, 0
  s_and_b32 s73, s73, 3
  s_add_u32 s51, s49, s73
  s_lshl_b32 s51, s51, 10
  buffer_load_dwordx4 v[96:99], v152, s[28:31], s51 offen sc1
  buffer_load_dwordx4 v[100:103], v153, s[28:31], s51 offen sc1
  buffer_load_dwordx4 v[104:107], v154, s[28:31], s51 offen sc1
  buffer_load_dwordx4 v[108:111], v155, s[28:31], s51 offen sc1
  ds_read_b64_tr_b16 v[64:65], v148 offset:0
  ds_read_b64_tr_b16 v[66:67], v148 offset:2048
  ds_read_b64_tr_b16 v[68:69], v149 offset:0
  ds_read_b64_tr_b16 v[70:71], v149 offset:2048
  ds_read_b64_tr_b16 v[72:73], v150 offset:0
  ds_read_b64_tr_b16 v[74:75], v150 offset:2048
  ds_read_b64_tr_b16 v[76:77], v151 offset:0
  ds_read_b64_tr_b16 v[78:79], v151 offset:2048
  s_add_u32 s73, s48, 1
  s_and_b32 s73, s73, 3
  s_add_u32 s51, s49, s73
  s_lshl_b32 s51, s51, 10
  buffer_load_dwordx4 v[112:115], v152, s[28:31], s51 offen sc1
  buffer_load_dwordx4 v[116:119], v153, s[28:31], s51 offen sc1
  buffer_load_dwordx4 v[120:123], v154, s[28:31], s51 offen sc1
  buffer_load_dwordx4 v[124:127], v155, s[28:31], s51 offen sc1
  s_add_u32 s73, s48, 2
  s_and_b32 s73, s73, 3
  s_add_u32 s51, s49, s73
  s_lshl_b32 s51, s51, 10
  buffer_load_dwordx4 v[128:131], v152, s[28:31], s51 offen sc1
  buffer_load_dwordx4 v[132:135], v153, s[28:31], s51 offen sc1
  buffer_load_dwordx4 v[136:139], v154, s[28:31], s51 offen sc1
  buffer_load_dwordx4 v[140:143], v155, s[28:31], s51 offen sc1
  s_add_u32 s73, s48, 3
  s_and_b32 s73, s73, 3
  s_add_u32 s51, s49, s73
  s_lshl_b32 s51, s51, 10
  buffer_load_dwordx4 v[160:163], v152, s[28:31], s51 offen sc1
  buffer_load_dwordx4 v[164:167], v153, s[28:31], s51 offen sc1
  buffer_load_dwordx4 v[168:171], v154, s[28:31], s51 offen sc1
  buffer_load_dwordx4 v[172:175], v155, s[28:31], s51 offen sc1
  s_add_u32 s49, s49, 16
  s_and_b32 s49, s49, 127
  s_lshr_b32 s73, s49, 3
  s_lshl_b32 s43, 1, s73
  s_mov_b32 s74, 0x8000
K2_d1_l:
  s_and_b32 s73, s72, s43
  s_cbranch_scc1 K2_d1_g
  buffer_load_dword v159, v158, s[32:35], 0 offen sc1
  s_waitcnt vmcnt(0)
  v_cmp_eq_u32 vcc, s75, v159
  s_nop 1
  s_lshr_b32 s73, vcc_lo, 1
  s_and_b32 s73, s73, vcc_lo
  s_and_b32 s72, s73, 0x5555
  s_and_b32 s73, s72, s43
  s_cbranch_scc1 K2_d1_g
  s_sleep 4
  s_sub_u32 s74, s74, 1
  s_cmp_lg_u32 s74, 0
  s_cbranch_scc1 K2_d1_l
  s_mov_b32 s72, 0x5555
  s_branch K2_d1_l
K2_d1_g:
  s_add_u32 s73, s48, 0
  s_and_b32 s73, s73, 3
  s_add_u32 s51, s49, s73
  s_lshl_b32 s51, s51, 10
  buffer_load_dwordx4 v[176:179], v152, s[28:31], s51 offen sc1
  buffer_load_dwordx4 v[180:183], v153, s[28:31], s51 offen sc1
  buffer_load_dwordx4 v[184:187], v154, s[28:31], s51 offen sc1
  buffer_load_dwordx4 v[188:191], v155, s[28:31], s51 offen sc1
  s_add_u32 s73, s48, 1
  s_and_b32 s73, s73, 3
  s_add_u32 s51, s49, s73
  s_lshl_b32 s51, s51, 10
  buffer_load_dwordx4 v[192:195], v152, s[28:31], s51 offen sc1
  buffer_load_dwordx4 v[196:199], v153, s[28:31], s51 offen sc1
  buffer_load_dwordx4 v[200:203], v154, s[28:31], s51 offen sc1
  buffer_load_dwordx4 v[204:207], v155, s[28:31], s51 offen sc1
  s_add_u32 s73, s48, 2
  s_and_b32 s73, s73, 3
  s_add_u32 s51, s49, s73
  s_lshl_b32 s51, s51, 10
  buffer_load_dwordx4 v[208:211], v152, s[28:31], s51 offen sc1
  buffer_load_dwordx4 v[212:215], v153, s[28:31], s51 offen sc1
  buffer_load_dwordx4 v[216:219], v154, s[28:31], s51 offen sc1
  buffer_load_dwordx4 v[220:223], v155, s[28:31], s51 offen sc1
  s_waitcnt vmcnt(20) lgkmcnt(0)
  v_mfma_f32_16x16x32_bf16 v[0:3], v[64:67], v[96:99], 0
  ds_read_b64_tr_b16 v[80:81], v148 offset:4096
  s_add_u32 m0, s71, 28672
  s_add_u32 s73, s48, 3
  s_and_b32 s73, s73, 3
  s_add_u32 s51, s49, s73
  s_mul_i32 s50, s51, 28672
  s_lshl_b32 s51, s51, 10
  v_mfma_f32_16x16x32_bf16 v[4:7], v[64:67], v[100:103], 0
  ds_read_b64_tr_b16 v[82:83], v148 offset:6144
  v_mfma_f32_16x16x32_bf16 v[8:11], v[64:67], v[104:107], 0
  ds_read_b64_tr_b16 v[84:85], v149 offset:4096
  v_mfma_f32_16x16x32_bf16 v[12:15], v[64:67], v[108:111], 0
  ds_read_b64_tr_b16 v[86:87], v149 offset:6144
  v_mfma_f32_16x16x32_bf16 v[16:19], v[68:71], v[96:99], 0
  ds_read_b64_tr_b16 v[88:89], v150 offset:4096
  v_mfma_f32_16x16x32_bf16 v[20:23], v[68:71], v[100:103], 0
  ds_read_b64_tr_b16 v[90:91], v150 offset:6144
  v_mfma_f32_16x16x32_bf16 v[24:27], v[68:71], v[104:107], 0
  ds_read_b64_tr_b16 v[92:93], v151 offset:4096
  v_mfma_f32_16x16x32_bf16 v[28:31], v[68:71], v[108:111], 0
  ds_read_b64_tr_b16 v[94:95], v151 offset:6144
  v_mfma_f32_16x16x32_bf16 v[32:35], v[72:75], v[96:99], 0
  buffer_load_dwordx4 v144, s[24:27], s50 offen offset:0 lds
  v_mfma_f32_16x16x32_bf16 v[36:39], v[72:75], v[100:103], 0
  buffer_load_dwordx4 v[224:227], v152, s[28:31], s51 offen sc1
  v_mfma_f32_16x16x32_bf16 v[40:43], v[72:75], v[104:107], 0
  buffer_load_dwordx4 v145, s[24:27], s50 offen offset:1024 lds
  v_mfma_f32_16x16x32_bf16 v[44:47], v[72:75], v[108:111], 0
  buffer_load_dwordx4 v[228:231], v153, s[28:31], s51 offen sc1
  v_mfma_f32_16x16x32_bf16 v[48:51], v[76:79], v[96:99], 0
  buffer_load_dwordx4 v146, s[24:27], s50 offen offset:2048 lds
  v_mfma_f32_16x16x32_bf16 v[52:55], v[76:79], v[100:103], 0
  buffer_load_dwordx4 v[232:235], v154, s[28:31], s51 offen sc1
  v_mfma_f32_16x16x32_bf16 v[56:59], v[76:79], v[104:107], 0
  buffer_load_dwordx4 v147, s[24:27], s50 offen offset:3072 lds
  v_mfma_f32_16x16x32_bf16 v[60:63], v[76:79], v[108:111], 0
  buffer_load_dwordx4 v[236:239], v155, s[28:31], s51 offen sc1
  s_waitcnt vmcnt(24) lgkmcnt(0)
  v_mfma_f32_16x16x32_bf16 v[0:3], v[80:83], v[112:115], v[0:3]
  ds_read_b64_tr_b16 v[64:65], v148 offset:8192
  s_add_u32 s49, s49, 16
  s_and_b32 s49, s49, 127
  s_lshr_b32 s73, s49, 3
  s_lshl_b32 s43, 1, s73
  s_mov_b32 s74, 0x8000
K2_d2_l:
  s_and_b32 s73, s72, s43
  s_cbranch_scc1 K2_d2_g
  buffer_load_dword v159, v158, s[32:35], 0 offen sc1
  s_waitcnt vmcnt(0)
  v_cmp_eq_u32 vcc, s75, v159
  s_nop 1
  s_lshr_b32 s73, vcc_lo, 1
  s_and_b32 s73, s73, vcc_lo
  s_and_b32 s72, s73, 0x5555
  s_and_b32 s73, s72, s43
  s_cbranch_scc1 K2_d2_g
  s_sleep 4
  s_sub_u32 s74, s74, 1
  s_cmp_lg_u32 s74, 0
  s_cbranch_scc1 K2_d2_l
  s_mov_b32 s72, 0x5555
  s_branch K2_d2_l
K2_d2_g:
  s_add_u32 m0, s71, 0
  s_add_u32 s73, s48, 0
  s_and_b32 s73, s73, 3
  s_add_u32 s51, s49, s73
  s_mul_i32 s50, s51, 28672
  s_lshl_b32 s51, s51, 10
  v_mfma_f32_16x16x32_bf16 v[4:7], v[80:83], v[116:119], v[4:7]
  ds_read_b64_tr_b16 v[66:67], v148 offset:10240
  v_mfma_f32_16x16x32_bf16 v[8:11], v[80:83], v[120:123], v[8:11]
  ds_read_b64_tr_b16 v[68:69], v149 offset:8192
  v_mfma_f32_16x16x32_bf16 v[12:15], v[80:83], v[124:127], v[12:15]
  ds_read_b64_tr_b16 v[70:71], v149 offset:10240
  v_mfma_f32_16x16x32_bf16 v[16:19], v[84:87], v[112:115], v[16:19]
  ds_read_b64_tr_b16 v[72:73], v150 offset:8192
  v_mfma_f32_16x16x32_bf16 v[20:23], v[84:87], v[116:119], v[20:23]
  ds_read_b64_tr_b16 v[74:75], v150 offset:10240
  v_mfma_f32_16x16x32_bf16 v[24:27], v[84:87], v[120:123], v[24:27]
  ds_read_b64_tr_b16 v[76:77], v151 offset:8192
  v_mfma_f32_16x16x32_bf16 v[28:31], v[84:87], v[124:127], v[28:31]
  ds_read_b64_tr_b16 v[78:79], v151 offset:10240
  v_mfma_f32_16x16x32_bf16 v[32:35], v[88:91], v[112:115], v[32:35]
  buffer_load_dwordx4 v144, s[24:27], s50 offen offset:0 lds
  v_mfma_f32_16x16x32_bf16 v[36:39], v[88:91], v[116:119], v[36:39]
  buffer_load_dwordx4 v[96:99], v152, s[28:31], s51 offen sc1
  v_mfma_f32_16x16x32_bf16 v[40:43], v[88:91], v[120:123], v[40:43]
  buffer_load_dwordx4 v145, s[24:27], s50 offen offset:1024 lds
  v_mfma_f32_16x16x32_bf16 v[44:47], v[88:91], v[124:127], v[44:47]
  buffer_load_dwordx4 v[100:103], v153, s[28:31], s51 offen sc1
  v_mfma_f32_16x16x32_bf16 v[48:51], v[92:95], v[112:115], v[48:51]
  buffer_load_dwordx4 v146, s[24:27], s50 offen offset:2048 lds
  v_mfma_f32_16x16x32_bf16 v[52:55], v[92:95], v[116:119], v[52:55]
  buffer_load_dwordx4 v[104:107], v154, s[28:31], s51 offen sc1
  v_mfma_f32_16x16x32_bf16 v[56:59], v[92:95], v[120:123], v[56:59]
  buffer_load_dwordx4 v147, s[24:27], s50 offen offset:3072 lds
  v_mfma_f32_16x16x32_bf16 v[60:63], v[92:95], v[124:127], v[60:63]
  buffer_load_dwordx4 v[108:111], v155, s[28:31], s51 offen sc1
  s_waitcnt vmcnt(28) lgkmcnt(0)
  v_mfma_f32_16x16x32_bf16 v[0:3], v[64:67], v[128:131], v[0:3]
  ds_read_b64_tr_b16 v[80:81], v148 offset:12288
  s_add_u32 m0, s71, 4096
  s_add_u32 s73, s48, 1
  s_and_b32 s73, s73, 3
  s_add_u32 s51, s49, s73
  s_mul_i32 s50, s51, 28672
  s_lshl_b32 s51, s51, 10
  v_mfma_f32_16x16x32_bf16 v[4:7], v[64:67], v[132:135], v[4:7]
  ds_read_b64_tr_b16 v[82:83], v148 offset:14336
  v_mfma_f32_16x16x32_bf16 v[8:11], v[64:67], v[136:139], v[8:11]
  ds_read_b64_tr_b16 v[84:85], v149 offset:12288
  v_mfma_f32_16x16x32_bf16 v[12:15], v[64:67], v[140:143], v[12:15]
  ds_read_b64_tr_b16 v[86:87], v149 offset:14336
  v_mfma_f32_16x16x32_bf16 v[16:19], v[68:71], v[128:131], v[16:19]
  ds_read_b64_tr_b16 v[88:89], v150 offset:12288
  v_mfma_f32_16x16x32_bf16 v[20:23], v[68:71], v[132:135], v[20:23]
  ds_read_b64_tr_b16 v[90:91], v150 offset:14336
  v_mfma_f32_16x16x32_bf16 v[24:27], v[68:71], v[136:139], v[24:27]
  ds_read_b64_tr_b16 v[92:93], v151 offset:12288
  v_mfma_f32_16x16x32_bf16 v[28:31], v[68:71], v[140:143], v[28:31]
  ds_read_b64_tr_b16 v[94:95], v151 offset:14336
  v_mfma_f32_16x16x32_bf16 v[32:35], v[72:75], v[128:131], v[32:35]
  buffer_load_dwordx4 v144, s[24:27], s50 offen offset:0 lds
  v_mfma_f32_16x16x32_bf16 v[36:39], v[72:75], v[132:135], v[36:39]
  buffer_load_dwordx4 v[112:115], v152, s[28:31], s51 offen sc1
  v_mfma_f32_16x16x32_bf16 v[40:43], v[72:75], v[136:139], v[40:43]
  buffer_load_dwordx4 v145, s[24:27], s50 offen offset:1024 lds
  v_mfma_f32_16x16x32_bf16 v[44:47], v[72:75], v[140:143], v[44:47]
  buffer_load_dwordx4 v[116:119], v153, s[28:31], s51 offen sc1
  v_mfma_f32_16x16x32_bf16 v[48:51], v[76:79], v[128:131], v[48:51]
  buffer_load_dwordx4 v146, s[24:27], s50 offen offset:2048 lds
  v_mfma_f32_16x16x32_bf16 v[52:55], v[76:79], v[132:135], v[52:55]
  buffer_load_dwordx4 v[120:123], v154, s[28:31], s51 offen sc1
  v_mfma_f32_16x16x32_bf16 v[56:59], v[76:79], v[136:139], v[56:59]
  buffer_load_dwordx4 v147, s[24:27], s50 offen offset:3072 lds
  v_mfma_f32_16x16x32_bf16 v[60:63], v[76:79], v[140:143], v[60:63]
  buffer_load_dwordx4 v[124:127], v155, s[28:31], s51 offen sc1
  s_waitcnt vmcnt(32) lgkmcnt(0)
  v_mfma_f32_16x16x32_bf16 v[0:3], v[80:83], v[160:163], v[0:3]
  ds_read_b64_tr_b16 v[64:65], v148 offset:16384
  s_add_u32 m0, s71, 8192
  s_add_u32 s73, s48, 2
  s_and_b32 s73, s73, 3
  s_add_u32 s51, s49, s73
  s_mul_i32 s50, s51, 28672
  s_lshl_b32 s51, s51, 10
  v_mfma_f32_16x16x32_bf16 v[4:7], v[80:83], v[164:167], v[4:7]
  ds_read_b64_tr_b16 v[66:67], v148 offset:18432
  v_mfma_f32_16x16x32_bf16 v[8:11], v[80:83], v[168:171], v[8:11]
  ds_read_b64_tr_b16 v[68:69], v149 offset:16384
  v_mfma_f32_16x16x32_bf16 v[12:15], v[80:83], v[172:175], v[12:15]
  ds_read_b64_tr_b16 v[70:71], v149 offset:18432
  v_mfma_f32_16x16x32_bf16 v[16:19], v[84:87], v[160:163], v[16:19]
  ds_read_b64_tr_b16 v[72:73], v150 offset:16384
  v_mfma_f32_16x16x32_bf16 v[20:23], v[84:87], v[164:167], v[20:23]
  ds_read_b64_tr_b16 v[74:75], v150 offset:18432
  v_mfma_f32_16x16x32_bf16 v[24:27], v[84:87], v[168:171], v[24:27]
  ds_read_b64_tr_b16 v[76:77], v151 offset:16384
  v_mfma_f32_16x16x32_bf16 v[28:31], v[84:87], v[172:175], v[28:31]
  ds_read_b64_tr_b16 v[78:79], v151 offset:18432
  v_mfma_f32_16x16x32_bf16 v[32:35], v[88:91], v[160:163], v[32:35]
  buffer_load_dwordx4 v144, s[24:27], s50 offen offset:0 lds
  v_mfma_f32_16x16x32_bf16 v[36:39], v[88:91], v[164:167], v[36:39]
  buffer_load_dwordx4 v[128:131], v152, s[28:31], s51 offen sc1
  v_mfma_f32_16x16x32_bf16 v[40:43], v[88:91], v[168:171], v[40:43]
  buffer_load_dwordx4 v145, s[24:27], s50 offen offset:1024 lds
  v_mfma_f32_16x16x32_bf16 v[44:47], v[88:91], v[172:175], v[44:47]
  buffer_load_dwordx4 v[132:135], v153, s[28:31], s51 offen sc1
  v_mfma_f32_16x16x32_bf16 v[48:51], v[92:95], v[160:163], v[48:51]
  buffer_load_dwordx4 v146, s[24:27], s50 offen offset:2048 lds
  v_mfma_f32_16x16x32_bf16 v[52:55], v[92:95], v[164:167], v[52:55]
  buffer_load_dwordx4 v[136:139], v154, s[28:31], s51 offen sc1
  v_mfma_f32_16x16x32_bf16 v[56:59], v[92:95], v[168:171], v[56:59]
  buffer_load_dwordx4 v147, s[24:27], s50 offen offset:3072 lds
  v_mfma_f32_16x16x32_bf16 v[60:63], v[92:95], v[172:175], v[60:63]
  buffer_load_dwordx4 v[140:143], v155, s[28:31], s51 offen sc1
  s_waitcnt vmcnt(36) lgkmcnt(0)
  v_mfma_f32_16x16x32_bf16 v[0:3], v[64:67], v[176:179], v[0:3]
  ds_read_b64_tr_b16 v[80:81], v148 offset:20480
  s_add_u32 m0, s71, 12288
  s_add_u32 s73, s48, 3
  s_and_b32 s73, s73, 3
  s_add_u32 s51, s49, s73
  s_mul_i32 s50, s51, 28672
  s_lshl_b32 s51, s51, 10
  v_mfma_f32_16x16x32_bf16 v[4:7], v[64:67], v[180:183], v[4:7]
  ds_read_b64_tr_b16 v[82:83], v148 offset:22528
  v_mfma_f32_16x16x32_bf16 v[8:11], v[64:67], v[184:187], v[8:11]
  ds_read_b64_tr_b16 v[84:85], v149 offset:20480
  v_mfma_f32_16x16x32_bf16 v[12:15], v[64:67], v[188:191], v[12:15]
  ds_read_b64_tr_b16 v[86:87], v149 offset:22528
  v_mfma_f32_16x16x32_bf16 v[16:19], v[68:71], v[176:179], v[16:19]
  ds_read_b64_tr_b16 v[88:89], v150 offset:20480
  v_mfma_f32_16x16x32_bf16 v[20:23], v[68:71], v[180:183], v[20:23]
  ds_read_b64_tr_b16 v[90:91], v150 offset:22528
  v_mfma_f32_16x16x32_bf16 v[24:27], v[68:71], v[184:187], v[24:27]
  ds_read_b64_tr_b16 v[92:93], v151 offset:20480
  v_mfma_f32_16x16x32_bf16 v[28:31], v[68:71], v[188:191], v[28:31]
  ds_read_b64_tr_b16 v[94:95], v151 offset:22528
  v_mfma_f32_16x16x32_bf16 v[32:35], v[72:75], v[176:179], v[32:35]
  buffer_load_dwordx4 v144, s[24:27], s50 offen offset:0 lds
  v_mfma_f32_16x16x32_bf16 v[36:39], v[72:75], v[180:183], v[36:39]
  buffer_load_dwordx4 v[160:163], v152, s[28:31], s51 offen sc1
  v_mfma_f32_16x16x32_bf16 v[40:43], v[72:75], v[184:187], v[40:43]
  buffer_load_dwordx4 v145, s[24:27], s50 offen offset:1024 lds
  v_mfma_f32_16x16x32_bf16 v[44:47], v[72:75], v[188:191], v[44:47]
  buffer_load_dwordx4 v[164:167], v153, s[28:31], s51 offen sc1
  v_mfma_f32_16x16x32_bf16 v[48:51], v[76:79], v[176:179], v[48:51]
  buffer_load_dwordx4 v146, s[24:27], s50 offen offset:2048 lds
  v_mfma_f32_16x16x32_bf16 v[52:55], v[76:79], v[180:183], v[52:55]
  buffer_load_dwordx4 v[168:171], v154, s[28:31], s51 offen sc1
  v_mfma_f32_16x16x32_bf16 v[56:59], v[76:79], v[184:187], v[56:59]
  buffer_load_dwordx4 v147, s[24:27], s50 offen offset:3072 lds
  v_mfma_f32_16x16x32_bf16 v[60:63], v[76:79], v[188:191], v[60:63]
  buffer_load_dwordx4 v[172:175], v155, s[28:31], s51 offen sc1
  s_waitcnt vmcnt(40) lgkmcnt(0)
  v_mfma_f32_16x16x32_bf16 v[0:3], v[80:83], v[192:195], v[0:3]
  ds_read_b64_tr_b16 v[64:65], v148 offset:24576
  s_add_u32 s49, s49, 16
  s_and_b32 s49, s49, 127
  s_lshr_b32 s73, s49, 3
  s_lshl_b32 s43, 1, s73
  s_mov_b32 s74, 0x8000
K2_d3_l:
  s_and_b32 s73, s72, s43
  s_cbranch_scc1 K2_d3_g
  buffer_load_dword v159, v158, s[32:35], 0 offen sc1
  s_waitcnt vmcnt(0)
  v_cmp_eq_u32 vcc, s75, v159
  s_nop 1
  s_lshr_b32 s73, vcc_lo, 1
  s_and_b32 s73, s73, vcc_lo
  s_and_b32 s72, s73, 0x5555
  s_and_b32 s73, s72, s43
  s_cbranch_scc1 K2_d3_g
  s_sleep 4
  s_sub_u32 s74, s74, 1
  s_cmp_lg_u32 s74, 0
  s_cbranch_scc1 K2_d3_l
  s_mov_b32 s72, 0x5555
  s_branch K2_d3_l
K2_d3_g:
  s_add_u32 m0, s71, 16384
  s_add_u32 s73, s48, 0
  s_and_b32 s73, s73, 3
  s_add_u32 s51, s49, s73
  s_mul_i32 s50, s51, 28672
  s_lshl_b32 s51, s51, 10
  v_mfma_f32_16x16x32_bf16 v[4:7], v[80:83], v[196:199], v[4:7]
  ds_read_b64_tr_b16 v[66:67], v148 offset:26624
  v_mfma_f32_16x16x32_bf16 v[8:11], v[80:83], v[200:203], v[8:11]
  ds_read_b64_tr_b16 v[68:69], v149 offset:24576
  v_mfma_f32_16x16x32_bf16 v[12:15], v[80:83], v[204:207], v[12:15]
  ds_read_b64_tr_b16 v[70:71], v149 offset:26624
  v_mfma_f32_16x16x32_bf16 v[16:19], v[84:87], v[192:195], v[16:19]
  ds_read_b64_tr_b16 v[72:73], v150 offset:24576
  v_mfma_f32_16x16x32_bf16 v[20:23], v[84:87], v[196:199], v[20:23]
  ds_read_b64_tr_b16 v[74:75], v150 offset:26624
  v_mfma_f32_16x16x32_bf16 v[24:27], v[84:87], v[200:203], v[24:27]
  ds_read_b64_tr_b16 v[76:77], v151 offset:24576
  v_mfma_f32_16x16x32_bf16 v[28:31], v[84:87], v[204:207], v[28:31]
  ds_read_b64_tr_b16 v[78:79], v151 offset:26624
  v_mfma_f32_16x16x32_bf16 v[32:35], v[88:91], v[192:195], v[32:35]
  buffer_load_dwordx4 v144, s[24:27], s50 offen offset:0 lds
  v_mfma_f32_16x16x32_bf16 v[36:39], v[88:91], v[196:199], v[36:39]
  buffer_load_dwordx4 v[176:179], v152, s[28:31], s51 offen sc1
  v_mfma_f32_16x16x32_bf16 v[40:43], v[88:91], v[200:203], v[40:43]
  buffer_load_dwordx4 v145, s[24:27], s50 offen offset:1024 lds
  v_mfma_f32_16x16x32_bf16 v[44:47], v[88:91], v[204:207], v[44:47]
  buffer_load_dwordx4 v[180:183], v153, s[28:31], s51 offen sc1
  v_mfma_f32_16x16x32_bf16 v[48:51], v[92:95], v[192:195], v[48:51]
  buffer_load_dwordx4 v146, s[24:27], s50 offen offset:2048 lds
  v_mfma_f32_16x16x32_bf16 v[52:55], v[92:95], v[196:199], v[52:55]
  buffer_load_dwordx4 v[184:187], v154, s[28:31], s51 offen sc1
  v_mfma_f32_16x16x32_bf16 v[56:59], v[92:95], v[200:203], v[56:59]
  buffer_load_dwordx4 v147, s[24:27], s50 offen offset:3072 lds
  v_mfma_f32_16x16x32_bf16 v[60:63], v[92:95], v[204:207], v[60:63]
  buffer_load_dwordx4 v[188:191], v155, s[28:31], s51 offen sc1
  s_waitcnt vmcnt(40) lgkmcnt(0)
  v_mfma_f32_16x16x32_bf16 v[0:3], v[64:67], v[208:211], v[0:3]
  ds_read_b64_tr_b16 v[80:81], v148 offset:28672
  s_add_u32 m0, s71, 20480
  s_add_u32 s73, s48, 1
  s_and_b32 s73, s73, 3
  s_add_u32 s51, s49, s73
  s_mul_i32 s50, s51, 28672
  s_lshl_b32 s51, s51, 10
  v_mfma_f32_16x16x32_bf16 v[4:7], v[64:67], v[212:215], v[4:7]
  ds_read_b64_tr_b16 v[82:83], v148 offset:30720
  v_mfma_f32_16x16x32_bf16 v[8:11], v[64:67], v[216:219], v[8:11]
  ds_read_b64_tr_b16 v[84:85], v149 offset:28672
  v_mfma_f32_16x16x32_bf16 v[12:15], v[64:67], v[220:223], v[12:15]
  ds_read_b64_tr_b16 v[86:87], v149 offset:30720
  v_mfma_f32_16x16x32_bf16 v[16:19], v[68:71], v[208:211], v[16:19]
  ds_read_b64_tr_b16 v[88:89], v150 offset:28672
  v_mfma_f32_16x16x32_bf16 v[20:23], v[68:71], v[212:215], v[20:23]
  ds_read_b64_tr_b16 v[90:91], v150 offset:30720
  v_mfma_f32_16x16x32_bf16 v[24:27], v[68:71], v[216:219], v[24:27]
  ds_read_b64_tr_b16 v[92:93], v151 offset:28672
  v_mfma_f32_16x16x32_bf16 v[28:31], v[68:71], v[220:223], v[28:31]
  ds_read_b64_tr_b16 v[94:95], v151 offset:30720
  v_mfma_f32_16x16x32_bf16 v[32:35], v[72:75], v[208:211], v[32:35]
  buffer_load_dwordx4 v144, s[24:27], s50 offen offset:0 lds
  v_mfma_f32_16x16x32_bf16 v[36:39], v[72:75], v[212:215], v[36:39]
  buffer_load_dwordx4 v[192:195], v152, s[28:31], s51 offen sc1
  v_mfma_f32_16x16x32_bf16 v[40:43], v[72:75], v[216:219], v[40:43]
  buffer_load_dwordx4 v145, s[24:27], s50 offen offset:1024 lds
  v_mfma_f32_16x16x32_bf16 v[44:47], v[72:75], v[220:223], v[44:47]
  buffer_load_dwordx4 v[196:199], v153, s[28:31], s51 offen sc1
  v_mfma_f32_16x16x32_bf16 v[48:51], v[76:79], v[208:211], v[48:51]
  buffer_load_dwordx4 v146, s[24:27], s50 offen offset:2048 lds
  v_mfma_f32_16x16x32_bf16 v[52:55], v[76:79], v[212:215], v[52:55]
  buffer_load_dwordx4 v[200:203], v154, s[28:31], s51 offen sc1
  v_mfma_f32_16x16x32_bf16 v[56:59], v[76:79], v[216:219], v[56:59]
  buffer_load_dwordx4 v147, s[24:27], s50 offen offset:3072 lds
  v_mfma_f32_16x16x32_bf16 v[60:63], v[76:79], v[220:223], v[60:63]
  buffer_load_dwordx4 v[204:207], v155, s[28:31], s51 offen sc1
  s_waitcnt vmcnt(40) lgkmcnt(0)
  v_mfma_f32_16x16x32_bf16 v[0:3], v[80:83], v[224:227], v[0:3]
  ds_read_b64_tr_b16 v[64:65], v148 offset:0
  s_add_u32 m0, s71, 24576
  s_add_u32 s73, s48, 2
  s_and_b32 s73, s73, 3
  s_add_u32 s51, s49, s73
  s_mul_i32 s50, s51, 28672
  s_lshl_b32 s51, s51, 10
  v_mfma_f32_16x16x32_bf16 v[4:7], v[80:83], v[228:231], v[4:7]
  ds_read_b64_tr_b16 v[66:67], v148 offset:2048
  v_mfma_f32_16x16x32_bf16 v[8:11], v[80:83], v[232:235], v[8:11]
  ds_read_b64_tr_b16 v[68:69], v149 offset:0
  v_mfma_f32_16x16x32_bf16 v[12:15], v[80:83], v[236:239], v[12:15]
  ds_read_b64_tr_b16 v[70:71], v149 offset:2048
  v_mfma_f32_16x16x32_bf16 v[16:19], v[84:87], v[224:227], v[16:19]
  ds_read_b64_tr_b16 v[72:73], v150 offset:0
  v_mfma_f32_16x16x32_bf16 v[20:23], v[84:87], v[228:231], v[20:23]
  ds_read_b64_tr_b16 v[74:75], v150 offset:2048
  v_mfma_f32_16x16x32_bf16 v[24:27], v[84:87], v[232:235], v[24:27]
  ds_read_b64_tr_b16 v[76:77], v151 offset:0
  v_mfma_f32_16x16x32_bf16 v[28:31], v[84:87], v[236:239], v[28:31]
  ds_read_b64_tr_b16 v[78:79], v151 offset:2048
  v_mfma_f32_16x16x32_bf16 v[32:35], v[88:91], v[224:227], v[32:35]
  buffer_load_dwordx4 v144, s[24:27], s50 offen offset:0 lds
  v_mfma_f32_16x16x32_bf16 v[36:39], v[88:91], v[228:231], v[36:39]
  buffer_load_dwordx4 v[208:211], v152, s[28:31], s51 offen sc1
  v_mfma_f32_16x16x32_bf16 v[40:43], v[88:91], v[232:235], v[40:43]
  buffer_load_dwordx4 v145, s[24:27], s50 offen offset:1024 lds
  v_mfma_f32_16x16x32_bf16 v[44:47], v[88:91], v[236:239], v[44:47]
  buffer_load_dwordx4 v[212:215], v153, s[28:31], s51 offen sc1
  v_mfma_f32_16x16x32_bf16 v[48:51], v[92:95], v[224:227], v[48:51]
  buffer_load_dwordx4 v146, s[24:27], s50 offen offset:2048 lds
  v_mfma_f32_16x16x32_bf16 v[52:55], v[92:95], v[228:231], v[52:55]
  buffer_load_dwordx4 v[216:219], v154, s[28:31], s51 offen sc1
  v_mfma_f32_16x16x32_bf16 v[56:59], v[92:95], v[232:235], v[56:59]
  buffer_load_dwordx4 v147, s[24:27], s50 offen offset:3072 lds
  v_mfma_f32_16x16x32_bf16 v[60:63], v[92:95], v[236:239], v[60:63]
  buffer_load_dwordx4 v[220:223], v155, s[28:31], s51 offen sc1
  s_waitcnt vmcnt(40) lgkmcnt(0)
  v_mfma_f32_16x16x32_bf16 v[0:3], v[64:67], v[96:99], v[0:3]
  ds_read_b64_tr_b16 v[80:81], v148 offset:4096
  s_add_u32 m0, s71, 28672
  s_add_u32 s73, s48, 3
  s_and_b32 s73, s73, 3
  s_add_u32 s51, s49, s73
  s_mul_i32 s50, s51, 28672
  s_lshl_b32 s51, s51, 10
  v_mfma_f32_16x16x32_bf16 v[4:7], v[64:67], v[100:103], v[4:7]
  ds_read_b64_tr_b16 v[82:83], v148 offset:6144
  v_mfma_f32_16x16x32_bf16 v[8:11], v[64:67], v[104:107], v[8:11]
  ds_read_b64_tr_b16 v[84:85], v149 offset:4096
  v_mfma_f32_16x16x32_bf16 v[12:15], v[64:67], v[108:111], v[12:15]
  ds_read_b64_tr_b16 v[86:87], v149 offset:6144
  v_mfma_f32_16x16x32_bf16 v[16:19], v[68:71], v[96:99], v[16:19]
  ds_read_b64_tr_b16 v[88:89], v150 offset:4096
  v_mfma_f32_16x16x32_bf16 v[20:23], v[68:71], v[100:103], v[20:23]
  ds_read_b64_tr_b16 v[90:91], v150 offset:6144
  v_mfma_f32_16x16x32_bf16 v[24:27], v[68:71], v[104:107], v[24:27]
  ds_read_b64_tr_b16 v[92:93], v151 offset:4096
  v_mfma_f32_16x16x32_bf16 v[28:31], v[68:71], v[108:111], v[28:31]
  ds_read_b64_tr_b16 v[94:95], v151 offset:6144
  v_mfma_f32_16x16x32_bf16 v[32:35], v[72:75], v[96:99], v[32:35]
  buffer_load_dwordx4 v144, s[24:27], s50 offen offset:0 lds
  v_mfma_f32_16x16x32_bf16 v[36:39], v[72:75], v[100:103], v[36:39]
  buffer_load_dwordx4 v[224:227], v152, s[28:31], s51 offen sc1
  v_mfma_f32_16x16x32_bf16 v[40:43], v[72:75], v[104:107], v[40:43]
  buffer_load_dwordx4 v145, s[24:27], s50 offen offset:1024 lds
  v_mfma_f32_16x16x32_bf16 v[44:47], v[72:75], v[108:111], v[44:47]
  buffer_load_dwordx4 v[228:231], v153, s[28:31], s51 offen sc1
  v_mfma_f32_16x16x32_bf16 v[48:51], v[76:79], v[96:99], v[48:51]
  buffer_load_dwordx4 v146, s[24:27], s50 offen offset:2048 lds
  v_mfma_f32_16x16x32_bf16 v[52:55], v[76:79], v[100:103], v[52:55]
  buffer_load_dwordx4 v[232:235], v154, s[28:31], s51 offen sc1
  v_mfma_f32_16x16x32_bf16 v[56:59], v[76:79], v[104:107], v[56:59]
  buffer_load_dwordx4 v147, s[24:27], s50 offen offset:3072 lds
  v_mfma_f32_16x16x32_bf16 v[60:63], v[76:79], v[108:111], v[60:63]
  buffer_load_dwordx4 v[236:239], v155, s[28:31], s51 offen sc1
  s_waitcnt vmcnt(40) lgkmcnt(0)
  v_mfma_f32_16x16x32_bf16 v[0:3], v[80:83], v[112:115], v[0:3]
  ds_read_b64_tr_b16 v[64:65], v148 offset:8192
  s_add_u32 s49, s49, 16
  s_and_b32 s49, s49, 127
  s_lshr_b32 s73, s49, 3
  s_lshl_b32 s43, 1, s73
  s_mov_b32 s74, 0x8000
K2_d4_l:
  s_and_b32 s73, s72, s43
  s_cbranch_scc1 K2_d4_g
  buffer_load_dword v159, v158, s[32:35], 0 offen sc1
  s_waitcnt vmcnt(0)
  v_cmp_eq_u32 vcc, s75, v159
  s_nop 1
  s_lshr_b32 s73, vcc_lo, 1
  s_and_b32 s73, s73, vcc_lo
  s_and_b32 s72, s73, 0x5555
  s_and_b32 s73, s72, s43
  s_cbranch_scc1 K2_d4_g
  s_sleep 4
  s_sub_u32 s74, s74, 1
  s_cmp_lg_u32 s74, 0
  s_cbranch_scc1 K2_d4_l
  s_mov_b32 s72, 0x5555
  s_branch K2_d4_l
K2_d4_g:
  s_add_u32 m0, s71, 0
  s_add_u32 s73, s48, 0
  s_and_b32 s73, s73, 3
  s_add_u32 s51, s49, s73
  s_mul_i32 s50, s51, 28672
  s_lshl_b32 s51, s51, 10
  v_mfma_f32_16x16x32_bf16 v[4:7], v[80:83], v[116:119], v[4:7]
  ds_read_b64_tr_b16 v[66:67], v148 offset:10240
  v_mfma_f32_16x16x32_bf16 v[8:11], v[80:83], v[120:123], v[8:11]
  ds_read_b64_tr_b16 v[68:69], v149 offset:8192
  v_mfma_f32_16x16x32_bf16 v[12:15], v[80:83], v[124:127], v[12:15]
  ds_read_b64_tr_b16 v[70:71], v149 offset:10240
  v_mfma_f32_16x16x32_bf16 v[16:19], v[84:87], v[112:115], v[16:19]
  ds_read_b64_tr_b16 v[72:73], v150 offset:8192
  v_mfma_f32_16x16x32_bf16 v[20:23], v[84:87], v[116:119], v[20:23]
  ds_read_b64_tr_b16 v[74:75], v150 offset:10240
  v_mfma_f32_16x16x32_bf16 v[24:27], v[84:87], v[120:123], v[24:27]
  ds_read_b64_tr_b16 v[76:77], v151 offset:8192
  v_mfma_f32_16x16x32_bf16 v[28:31], v[84:87], v[124:127], v[28:31]
  ds_read_b64_tr_b16 v[78:79], v151 offset:10240
  v_mfma_f32_16x16x32_bf16 v[32:35], v[88:91], v[112:115], v[32:35]
  buffer_load_dwordx4 v144, s[24:27], s50 offen offset:0 lds
  v_mfma_f32_16x16x32_bf16 v[36:39], v[88:91], v[116:119], v[36:39]
  buffer_load_dwordx4 v[96:99], v152, s[28:31], s51 offen sc1
  v_mfma_f32_16x16x32_bf16 v[40:43], v[88:91], v[120:123], v[40:43]
  buffer_load_dwordx4 v145, s[24:27], s50 offen offset:1024 lds
  v_mfma_f32_16x16x32_bf16 v[44:47], v[88:91], v[124:127], v[44:47]
  buffer_load_dwordx4 v[100:103], v153, s[28:31], s51 offen sc1
  v_mfma_f32_16x16x32_bf16 v[48:51], v[92:95], v[112:115], v[48:51]
  buffer_load_dwordx4 v146, s[24:27], s50 offen offset:2048 lds
  v_mfma_f32_16x16x32_bf16 v[52:55], v[92:95], v[116:119], v[52:55]
  buffer_load_dwordx4 v[104:107], v154, s[28:31], s51 offen sc1
  v_mfma_f32_16x16x32_bf16 v[56:59], v[92:95], v[120:123], v[56:59]
  buffer_load_dwordx4 v147, s[24:27], s50 offen offset:3072 lds
  v_mfma_f32_16x16x32_bf16 v[60:63], v[92:95], v[124:127], v[60:63]
  buffer_load_dwordx4 v[108:111], v155, s[28:31], s51 offen sc1
  s_waitcnt vmcnt(40) lgkmcnt(0)
  v_mfma_f32_16x16x32_bf16 v[0:3], v[64:67], v[128:131], v[0:3]
  ds_read_b64_tr_b16 v[80:81], v148 offset:12288
  s_add_u32 m0, s71, 4096
  s_add_u32 s73, s48, 1
  s_and_b32 s73, s73, 3
  s_add_u32 s51, s49, s73
  s_mul_i32 s50, s51, 28672
  s_lshl_b32 s51, s51, 10
  v_mfma_f32_16x16x32_bf16 v[4:7], v[64:67], v[132:135], v[4:7]
  ds_read_b64_tr_b16 v[82:83], v148 offset:14336
  v_mfma_f32_16x16x32_bf16 v[8:11], v[64:67], v[136:139], v[8:11]
  ds_read_b64_tr_b16 v[84:85], v149 offset:12288
  v_mfma_f32_16x16x32_bf16 v[12:15], v[64:67], v[140:143], v[12:15]
  ds_read_b64_tr_b16 v[86:87], v149 offset:14336
  v_mfma_f32_16x16x32_bf16 v[16:19], v[68:71], v[128:131], v[16:19]
  ds_read_b64_tr_b16 v[88:89], v150 offset:12288
  v_mfma_f32_16x16x32_bf16 v[20:23], v[68:71], v[132:135], v[20:23]
  ds_read_b64_tr_b16 v[90:91], v150 offset:14336
  v_mfma_f32_16x16x32_bf16 v[24:27], v[68:71], v[136:139], v[24:27]
  ds_read_b64_tr_b16 v[92:93], v151 offset:12288
  v_mfma_f32_16x16x32_bf16 v[28:31], v[68:71], v[140:143], v[28:31]
  ds_read_b64_tr_b16 v[94:95], v151 offset:14336
  v_mfma_f32_16x16x32_bf16 v[32:35], v[72:75], v[128:131], v[32:35]
  buffer_load_dwordx4 v144, s[24:27], s50 offen offset:0 lds
  v_mfma_f32_16x16x32_bf16 v[36:39], v[72:75], v[132:135], v[36:39]
  buffer_load_dwordx4 v[112:115], v152, s[28:31], s51 offen sc1
  v_mfma_f32_16x16x32_bf16 v[40:43], v[72:75], v[136:139], v[40:43]
  buffer_load_dwordx4 v145, s[24:27], s50 offen offset:1024 lds
  v_mfma_f32_16x16x32_bf16 v[44:47], v[72:75], v[140:143], v[44:47]
  buffer_load_dwordx4 v[116:119], v153, s[28:31], s51 offen sc1
  v_mfma_f32_16x16x32_bf16 v[48:51], v[76:79], v[128:131], v[48:51]
  buffer_load_dwordx4 v146, s[24:27], s50 offen offset:2048 lds
  v_mfma_f32_16x16x32_bf16 v[52:55], v[76:79], v[132:135], v[52:55]
  buffer_load_dwordx4 v[120:123], v154, s[28:31], s51 offen sc1
  v_mfma_f32_16x16x32_bf16 v[56:59], v[76:79], v[136:139], v[56:59]
  buffer_load_dwordx4 v147, s[24:27], s50 offen offset:3072 lds
  v_mfma_f32_16x16x32_bf16 v[60:63], v[76:79], v[140:143], v[60:63]
  buffer_load_dwordx4 v[124:127], v155, s[28:31], s51 offen sc1
  s_waitcnt vmcnt(40) lgkmcnt(0)
  v_mfma_f32_16x16x32_bf16 v[0:3], v[80:83], v[160:163], v[0:3]
  ds_read_b64_tr_b16 v[64:65], v148 offset:16384
  s_add_u32 m0, s71, 8192
  s_add_u32 s73, s48, 2
  s_and_b32 s73, s73, 3
  s_add_u32 s51, s49, s73
  s_mul_i32 s50, s51, 28672
  s_lshl_b32 s51, s51, 10
  v_mfma_f32_16x16x32_bf16 v[4:7], v[80:83], v[164:167], v[4:7]
  ds_read_b64_tr_b16 v[66:67], v148 offset:18432
  v_mfma_f32_16x16x32_bf16 v[8:11], v[80:83], v[168:171], v[8:11]
  ds_read_b64_tr_b16 v[68:69], v149 offset:16384
  v_mfma_f32_16x16x32_bf16 v[12:15], v[80:83], v[172:175], v[12:15]
  ds_read_b64_tr_b16 v[70:71], v149 offset:18432
  v_mfma_f32_16x16x32_bf16 v[16:19], v[84:87], v[160:163], v[16:19]
  ds_read_b64_tr_b16 v[72:73], v150 offset:16384
  v_mfma_f32_16x16x32_bf16 v[20:23], v[84:87], v[164:167], v[20:23]
  ds_read_b64_tr_b16 v[74:75], v150 offset:18432
  v_mfma_f32_16x16x32_bf16 v[24:27], v[84:87], v[168:171], v[24:27]
  ds_read_b64_tr_b16 v[76:77], v151 offset:16384
  v_mfma_f32_16x16x32_bf16 v[28:31], v[84:87], v[172:175], v[28:31]
  ds_read_b64_tr_b16 v[78:79], v151 offset:18432
  v_mfma_f32_16x16x32_bf16 v[32:35], v[88:91], v[160:163], v[32:35]
  buffer_load_dwordx4 v144, s[24:27], s50 offen offset:0 lds
  v_mfma_f32_16x16x32_bf16 v[36:39], v[88:91], v[164:167], v[36:39]
  buffer_load_dwordx4 v[128:131], v152, s[28:31], s51 offen sc1
  v_mfma_f32_16x16x32_bf16 v[40:43], v[88:91], v[168:171], v[40:43]
  buffer_load_dwordx4 v145, s[24:27], s50 offen offset:1024 lds
  v_mfma_f32_16x16x32_bf16 v[44:47], v[88:91], v[172:175], v[44:47]
  buffer_load_dwordx4 v[132:135], v153, s[28:31], s51 offen sc1
  v_mfma_f32_16x16x32_bf16 v[48:51], v[92:95], v[160:163], v[48:51]
  buffer_load_dwordx4 v146, s[24:27], s50 offen offset:2048 lds
  v_mfma_f32_16x16x32_bf16 v[52:55], v[92:95], v[164:167], v[52:55]
  buffer_load_dwordx4 v[136:139], v154, s[28:31], s51 offen sc1
  v_mfma_f32_16x16x32_bf16 v[56:59], v[92:95], v[168:171], v[56:59]
  buffer_load_dwordx4 v147, s[24:27], s50 offen offset:3072 lds
  v_mfma_f32_16x16x32_bf16 v[60:63], v[92:95], v[172:175], v[60:63]
  buffer_load_dwordx4 v[140:143], v155, s[28:31], s51 offen sc1
  s_waitcnt vmcnt(40) lgkmcnt(0)
  v_mfma_f32_16x16x32_bf16 v[0:3], v[64:67], v[176:179], v[0:3]
  ds_read_b64_tr_b16 v[80:81], v148 offset:20480
  s_add_u32 m0, s71, 12288
  s_add_u32 s73, s48, 3
  s_and_b32 s73, s73, 3
  s_add_u32 s51, s49, s73
  s_mul_i32 s50, s51, 28672
  s_lshl_b32 s51, s51, 10
  v_mfma_f32_16x16x32_bf16 v[4:7], v[64:67], v[180:183], v[4:7]
  ds_read_b64_tr_b16 v[82:83], v148 offset:22528
  v_mfma_f32_16x16x32_bf16 v[8:11], v[64:67], v[184:187], v[8:11]
  ds_read_b64_tr_b16 v[84:85], v149 offset:20480
  v_mfma_f32_16x16x32_bf16 v[12:15], v[64:67], v[188:191], v[12:15]
  ds_read_b64_tr_b16 v[86:87], v149 offset:22528
  v_mfma_f32_16x16x32_bf16 v[16:19], v[68:71], v[176:179], v[16:19]
  ds_read_b64_tr_b16 v[88:89], v150 offset:20480
  v_mfma_f32_16x16x32_bf16 v[20:23], v[68:71], v[180:183], v[20:23]
  ds_read_b64_tr_b16 v[90:91], v150 offset:22528
  v_mfma_f32_16x16x32_bf16 v[24:27], v[68:71], v[184:187], v[24:27]
  ds_read_b64_tr_b16 v[92:93], v151 offset:20480
  v_mfma_f32_16x16x32_bf16 v[28:31], v[68:71], v[188:191], v[28:31]
  ds_read_b64_tr_b16 v[94:95], v151 offset:22528
  v_mfma_f32_16x16x32_bf16 v[32:35], v[72:75], v[176:179], v[32:35]
  buffer_load_dwordx4 v144, s[24:27], s50 offen offset:0 lds
  v_mfma_f32_16x16x32_bf16 v[36:39], v[72:75], v[180:183], v[36:39]
  buffer_load_dwordx4 v[160:163], v152, s[28:31], s51 offen sc1
  v_mfma_f32_16x16x32_bf16 v[40:43], v[72:75], v[184:187], v[40:43]
  buffer_load_dwordx4 v145, s[24:27], s50 offen offset:1024 lds
  v_mfma_f32_16x16x32_bf16 v[44:47], v[72:75], v[188:191], v[44:47]
  buffer_load_dwordx4 v[164:167], v153, s[28:31], s51 offen sc1
  v_mfma_f32_16x16x32_bf16 v[48:51], v[76:79], v[176:179], v[48:51]
  buffer_load_dwordx4 v146, s[24:27], s50 offen offset:2048 lds
  v_mfma_f32_16x16x32_bf16 v[52:55], v[76:79], v[180:183], v[52:55]
  buffer_load_dwordx4 v[168:171], v154, s[28:31], s51 offen sc1
  v_mfma_f32_16x16x32_bf16 v[56:59], v[76:79], v[184:187], v[56:59]
  buffer_load_dwordx4 v147, s[24:27], s50 offen offset:3072 lds
  v_mfma_f32_16x16x32_bf16 v[60:63], v[76:79], v[188:191], v[60:63]
  buffer_load_dwordx4 v[172:175], v155, s[28:31], s51 offen sc1
  s_waitcnt vmcnt(40) lgkmcnt(0)
  v_mfma_f32_16x16x32_bf16 v[0:3], v[80:83], v[192:195], v[0:3]
  ds_read_b64_tr_b16 v[64:65], v148 offset:24576
  s_add_u32 s49, s49, 16
  s_and_b32 s49, s49, 127
  s_lshr_b32 s73, s49, 3
  s_lshl_b32 s43, 1, s73
  s_mov_b32 s74, 0x8000
K2_d5_l:
  s_and_b32 s73, s72, s43
  s_cbranch_scc1 K2_d5_g
  buffer_load_dword v159, v158, s[32:35], 0 offen sc1
  s_waitcnt vmcnt(0)
  v_cmp_eq_u32 vcc, s75, v159
  s_nop 1
  s_lshr_b32 s73, vcc_lo, 1
  s_and_b32 s73, s73, vcc_lo
  s_and_b32 s72, s73, 0x5555
  s_and_b32 s73, s72, s43
  s_cbranch_scc1 K2_d5_g
  s_sleep 4
  s_sub_u32 s74, s74, 1
  s_cmp_lg_u32 s74, 0
  s_cbranch_scc1 K2_d5_l
  s_mov_b32 s72, 0x5555
  s_branch K2_d5_l
K2_d5_g:
  s_add_u32 m0, s71, 16384
  s_add_u32 s73, s48, 0
  s_and_b32 s73, s73, 3
  s_add_u32 s51, s49, s73
  s_mul_i32 s50, s51, 28672
  s_lshl_b32 s51, s51, 10
  v_mfma_f32_16x16x32_bf16 v[4:7], v[80:83], v[196:199], v[4:7]
  ds_read_b64_tr_b16 v[66:67], v148 offset:26624
  v_mfma_f32_16x16x32_bf16 v[8:11], v[80:83], v[200:203], v[8:11]
  ds_read_b64_tr_b16 v[68:69], v149 offset:24576
  v_mfma_f32_16x16x32_bf16 v[12:15], v[80:83], v[204:207], v[12:15]
  ds_read_b64_tr_b16 v[70:71], v149 offset:26624
  v_mfma_f32_16x16x32_bf16 v[16:19], v[84:87], v[192:195], v[16:19]
  ds_read_b64_tr_b16 v[72:73], v150 offset:24576
  v_mfma_f32_16x16x32_bf16 v[20:23], v[84:87], v[196:199], v[20:23]
  ds_read_b64_tr_b16 v[74:75], v150 offset:26624
  v_mfma_f32_16x16x32_bf16 v[24:27], v[84:87], v[200:203], v[24:27]
  ds_read_b64_tr_b16 v[76:77], v151 offset:24576
  v_mfma_f32_16x16x32_bf16 v[28:31], v[84:87], v[204:207], v[28:31]
  ds_read_b64_tr_b16 v[78:79], v151 offset:26624
  v_mfma_f32_16x16x32_bf16 v[32:35], v[88:91], v[192:195], v[32:35]
  buffer_load_dwordx4 v144, s[24:27], s50 offen offset:0 lds
  v_mfma_f32_16x16x32_bf16 v[36:39], v[88:91], v[196:199], v[36:39]
  buffer_load_dwordx4 v[176:179], v152, s[28:31], s51 offen sc1
  v_mfma_f32_16x16x32_bf16 v[40:43], v[88:91], v[200:203], v[40:43]
  buffer_load_dwordx4 v145, s[24:27], s50 offen offset:1024 lds
  v_mfma_f32_16x16x32_bf16 v[44:47], v[88:91], v[204:207], v[44:47]
  buffer_load_dwordx4 v[180:183], v153, s[28:31], s51 offen sc1
  v_mfma_f32_16x16x32_bf16 v[48:51], v[92:95], v[192:195], v[48:51]
  buffer_load_dwordx4 v146, s[24:27], s50 offen offset:2048 lds
  v_mfma_f32_16x16x32_bf16 v[52:55], v[92:95], v[196:199], v[52:55]
  buffer_load_dwordx4 v[184:187], v154, s[28:31], s51 offen sc1
  v_mfma_f32_16x16x32_bf16 v[56:59], v[92:95], v[200:203], v[56:59]
  buffer_load_dwordx4 v147, s[24:27], s50 offen offset:3072 lds
  v_mfma_f32_16x16x32_bf16 v[60:63], v[92:95], v[204:207], v[60:63]
  buffer_load_dwordx4 v[188:191], v155, s[28:31], s51 offen sc1
  s_waitcnt vmcnt(40) lgkmcnt(0)
  v_mfma_f32_16x16x32_bf16 v[0:3], v[64:67], v[208:211], v[0:3]
  ds_read_b64_tr_b16 v[80:81], v148 offset:28672
  s_add_u32 m0, s71, 20480
  s_add_u32 s73, s48, 1
  s_and_b32 s73, s73, 3
  s_add_u32 s51, s49, s73
  s_mul_i32 s50, s51, 28672
  s_lshl_b32 s51, s51, 10
  v_mfma_f32_16x16x32_bf16 v[4:7], v[64:67], v[212:215], v[4:7]
  ds_read_b64_tr_b16 v[82:83], v148 offset:30720
  v_mfma_f32_16x16x32_bf16 v[8:11], v[64:67], v[216:219], v[8:11]
  ds_read_b64_tr_b16 v[84:85], v149 offset:28672
  v_mfma_f32_16x16x32_bf16 v[12:15], v[64:67], v[220:223], v[12:15]
  ds_read_b64_tr_b16 v[86:87], v149 offset:30720
  v_mfma_f32_16x16x32_bf16 v[16:19], v[68:71], v[208:211], v[16:19]
  ds_read_b64_tr_b16 v[88:89], v150 offset:28672
  v_mfma_f32_16x16x32_bf16 v[20:23], v[68:71], v[212:215], v[20:23]
  ds_read_b64_tr_b16 v[90:91], v150 offset:30720
  v_mfma_f32_16x16x32_bf16 v[24:27], v[68:71], v[216:219], v[24:27]
  ds_read_b64_tr_b16 v[92:93], v151 offset:28672
  v_mfma_f32_16x16x32_bf16 v[28:31], v[68:71], v[220:223], v[28:31]
  ds_read_b64_tr_b16 v[94:95], v151 offset:30720
  v_mfma_f32_16x16x32_bf16 v[32:35], v[72:75], v[208:211], v[32:35]
  buffer_load_dwordx4 v144, s[24:27], s50 offen offset:0 lds
  v_mfma_f32_16x16x32_bf16 v[36:39], v[72:75], v[212:215], v[36:39]
  buffer_load_dwordx4 v[192:195], v152, s[28:31], s51 offen sc1
  v_mfma_f32_16x16x32_bf16 v[40:43], v[72:75], v[216:219], v[40:43]
  buffer_load_dwordx4 v145, s[24:27], s50 offen offset:1024 lds
  v_mfma_f32_16x16x32_bf16 v[44:47], v[72:75], v[220:223], v[44:47]
  buffer_load_dwordx4 v[196:199], v153, s[28:31], s51 offen sc1
  v_mfma_f32_16x16x32_bf16 v[48:51], v[76:79], v[208:211], v[48:51]
  buffer_load_dwordx4 v146, s[24:27], s50 offen offset:2048 lds
  v_mfma_f32_16x16x32_bf16 v[52:55], v[76:79], v[212:215], v[52:55]
  buffer_load_dwordx4 v[200:203], v154, s[28:31], s51 offen sc1
  v_mfma_f32_16x16x32_bf16 v[56:59], v[76:79], v[216:219], v[56:59]
  buffer_load_dwordx4 v147, s[24:27], s50 offen offset:3072 lds
  v_mfma_f32_16x16x32_bf16 v[60:63], v[76:79], v[220:223], v[60:63]
  buffer_load_dwordx4 v[204:207], v155, s[28:31], s51 offen sc1
  s_waitcnt vmcnt(40) lgkmcnt(0)
  v_mfma_f32_16x16x32_bf16 v[0:3], v[80:83], v[224:227], v[0:3]
  ds_read_b64_tr_b16 v[64:65], v148 offset:0
  s_add_u32 m0, s71, 24576
  s_add_u32 s73, s48, 2
  s_and_b32 s73, s73, 3
  s_add_u32 s51, s49, s73
  s_mul_i32 s50, s51, 28672
  s_lshl_b32 s51, s51, 10
  v_mfma_f32_16x16x32_bf16 v[4:7], v[80:83], v[228:231], v[4:7]
  ds_read_b64_tr_b16 v[66:67], v148 offset:2048
  v_mfma_f32_16x16x32_bf16 v[8:11], v[80:83], v[232:235], v[8:11]
  ds_read_b64_tr_b16 v[68:69], v149 offset:0
  v_mfma_f32_16x16x32_bf16 v[12:15], v[80:83], v[236:239], v[12:15]
  ds_read_b64_tr_b16 v[70:71], v149 offset:2048
  v_mfma_f32_16x16x32_bf16 v[16:19], v[84:87], v[224:227], v[16:19]
  ds_read_b64_tr_b16 v[72:73], v150 offset:0
  v_mfma_f32_16x16x32_bf16 v[20:23], v[84:87], v[228:231], v[20:23]
  ds_read_b64_tr_b16 v[74:75], v150 offset:2048
  v_mfma_f32_16x16x32_bf16 v[24:27], v[84:87], v[232:235], v[24:27]
  ds_read_b64_tr_b16 v[76:77], v151 offset:0
  v_mfma_f32_16x16x32_bf16 v[28:31], v[84:87], v[236:239], v[28:31]
  ds_read_b64_tr_b16 v[78:79], v151 offset:2048
  v_mfma_f32_16x16x32_bf16 v[32:35], v[88:91], v[224:227], v[32:35]
  buffer_load_dwordx4 v144, s[24:27], s50 offen offset:0 lds
  v_mfma_f32_16x16x32_bf16 v[36:39], v[88:91], v[228:231], v[36:39]
  buffer_load_dwordx4 v[208:211], v152, s[28:31], s51 offen sc1
  v_mfma_f32_16x16x32_bf16 v[40:43], v[88:91], v[232:235], v[40:43]
  buffer_load_dwordx4 v145, s[24:27], s50 offen offset:1024 lds
  v_mfma_f32_16x16x32_bf16 v[44:47], v[88:91], v[236:239], v[44:47]
  buffer_load_dwordx4 v[212:215], v153, s[28:31], s51 offen sc1
  v_mfma_f32_16x16x32_bf16 v[48:51], v[92:95], v[224:227], v[48:51]
  buffer_load_dwordx4 v146, s[24:27], s50 offen offset:2048 lds
  v_mfma_f32_16x16x32_bf16 v[52:55], v[92:95], v[228:231], v[52:55]
  buffer_load_dwordx4 v[216:219], v154, s[28:31], s51 offen sc1
  v_mfma_f32_16x16x32_bf16 v[56:59], v[92:95], v[232:235], v[56:59]
  buffer_load_dwordx4 v147, s[24:27], s50 offen offset:3072 lds
  v_mfma_f32_16x16x32_bf16 v[60:63], v[92:95], v[236:239], v[60:63]
  buffer_load_dwordx4 v[220:223], v155, s[28:31], s51 offen sc1
  s_waitcnt vmcnt(40) lgkmcnt(0)
  v_mfma_f32_16x16x32_bf16 v[0:3], v[64:67], v[96:99], v[0:3]
  ds_read_b64_tr_b16 v[80:81], v148 offset:4096
  s_add_u32 m0, s71, 28672
  s_add_u32 s73, s48, 3
  s_and_b32 s73, s73, 3
  s_add_u32 s51, s49, s73
  s_mul_i32 s50, s51, 28672
  s_lshl_b32 s51, s51, 10
  v_mfma_f32_16x16x32_bf16 v[4:7], v[64:67], v[100:103], v[4:7]
  ds_read_b64_tr_b16 v[82:83], v148 offset:6144
  v_mfma_f32_16x16x32_bf16 v[8:11], v[64:67], v[104:107], v[8:11]
  ds_read_b64_tr_b16 v[84:85], v149 offset:4096
  v_mfma_f32_16x16x32_bf16 v[12:15], v[64:67], v[108:111], v[12:15]
  ds_read_b64_tr_b16 v[86:87], v149 offset:6144
  v_mfma_f32_16x16x32_bf16 v[16:19], v[68:71], v[96:99], v[16:19]
  ds_read_b64_tr_b16 v[88:89], v150 offset:4096
  v_mfma_f32_16x16x32_bf16 v[20:23], v[68:71], v[100:103], v[20:23]
  ds_read_b64_tr_b16 v[90:91], v150 offset:6144
  v_mfma_f32_16x16x32_bf16 v[24:27], v[68:71], v[104:107], v[24:27]
  ds_read_b64_tr_b16 v[92:93], v151 offset:4096
  v_mfma_f32_16x16x32_bf16 v[28:31], v[68:71], v[108:111], v[28:31]
  ds_read_b64_tr_b16 v[94:95], v151 offset:6144
  v_mfma_f32_16x16x32_bf16 v[32:35], v[72:75], v[96:99], v[32:35]
  buffer_load_dwordx4 v144, s[24:27], s50 offen offset:0 lds
  v_mfma_f32_16x16x32_bf16 v[36:39], v[72:75], v[100:103], v[36:39]
  buffer_load_dwordx4 v[224:227], v152, s[28:31], s51 offen sc1
  v_mfma_f32_16x16x32_bf16 v[40:43], v[72:75], v[104:107], v[40:43]
  buffer_load_dwordx4 v145, s[24:27], s50 offen offset:1024 lds
  v_mfma_f32_16x16x32_bf16 v[44:47], v[72:75], v[108:111], v[44:47]
  buffer_load_dwordx4 v[228:231], v153, s[28:31], s51 offen sc1
  v_mfma_f32_16x16x32_bf16 v[48:51], v[76:79], v[96:99], v[48:51]
  buffer_load_dwordx4 v146, s[24:27], s50 offen offset:2048 lds
  v_mfma_f32_16x16x32_bf16 v[52:55], v[76:79], v[100:103], v[52:55]
  buffer_load_dwordx4 v[232:235], v154, s[28:31], s51 offen sc1
  v_mfma_f32_16x16x32_bf16 v[56:59], v[76:79], v[104:107], v[56:59]
  buffer_load_dwordx4 v147, s[24:27], s50 offen offset:3072 lds
  v_mfma_f32_16x16x32_bf16 v[60:63], v[76:79], v[108:111], v[60:63]
  buffer_load_dwordx4 v[236:239], v155, s[28:31], s51 offen sc1
  s_waitcnt vmcnt(40) lgkmcnt(0)
  v_mfma_f32_16x16x32_bf16 v[0:3], v[80:83], v[112:115], v[0:3]
  ds_read_b64_tr_b16 v[64:65], v148 offset:8192
  s_add_u32 s49, s49, 16
  s_and_b32 s49, s49, 127
  s_lshr_b32 s73, s49, 3
  s_lshl_b32 s43, 1, s73
  s_mov_b32 s74, 0x8000
K2_d6_l:
  s_and_b32 s73, s72, s43
  s_cbranch_scc1 K2_d6_g
  buffer_load_dword v159, v158, s[32:35], 0 offen sc1
  s_waitcnt vmcnt(0)
  v_cmp_eq_u32 vcc, s75, v159
  s_nop 1
  s_lshr_b32 s73, vcc_lo, 1
  s_and_b32 s73, s73, vcc_lo
  s_and_b32 s72, s73, 0x5555
  s_and_b32 s73, s72, s43
  s_cbranch_scc1 K2_d6_g
  s_sleep 4
  s_sub_u32 s74, s74, 1
  s_cmp_lg_u32 s74, 0
  s_cbranch_scc1 K2_d6_l
  s_mov_b32 s72, 0x5555
  s_branch K2_d6_l
K2_d6_g:
  s_add_u32 m0, s71, 0
  s_add_u32 s73, s48, 0
  s_and_b32 s73, s73, 3
  s_add_u32 s51, s49, s73
  s_mul_i32 s50, s51, 28672
  s_lshl_b32 s51, s51, 10
  v_mfma_f32_16x16x32_bf16 v[4:7], v[80:83], v[116:119], v[4:7]
  ds_read_b64_tr_b16 v[66:67], v148 offset:10240
  v_mfma_f32_16x16x32_bf16 v[8:11], v[80:83], v[120:123], v[8:11]
  ds_read_b64_tr_b16 v[68:69], v149 offset:8192
  v_mfma_f32_16x16x32_bf16 v[12:15], v[80:83], v[124:127], v[12:15]
  ds_read_b64_tr_b16 v[70:71], v149 offset:10240
  v_mfma_f32_16x16x32_bf16 v[16:19], v[84:87], v[112:115], v[16:19]
  ds_read_b64_tr_b16 v[72:73], v150 offset:8192
  v_mfma_f32_16x16x32_bf16 v[20:23], v[84:87], v[116:119], v[20:23]
  ds_read_b64_tr_b16 v[74:75], v150 offset:10240
  v_mfma_f32_16x16x32_bf16 v[24:27], v[84:87], v[120:123], v[24:27]
  ds_read_b64_tr_b16 v[76:77], v151 offset:8192
  v_mfma_f32_16x16x32_bf16 v[28:31], v[84:87], v[124:127], v[28:31]
  ds_read_b64_tr_b16 v[78:79], v151 offset:10240
  v_mfma_f32_16x16x32_bf16 v[32:35], v[88:91], v[112:115], v[32:35]
  buffer_load_dwordx4 v144, s[24:27], s50 offen offset:0 lds
  v_mfma_f32_16x16x32_bf16 v[36:39], v[88:91], v[116:119], v[36:39]
  buffer_load_dwordx4 v[96:99], v152, s[28:31], s51 offen sc1
  v_mfma_f32_16x16x32_bf16 v[40:43], v[88:91], v[120:123], v[40:43]
  buffer_load_dwordx4 v145, s[24:27], s50 offen offset:1024 lds
  v_mfma_f32_16x16x32_bf16 v[44:47], v[88:91], v[124:127], v[44:47]
  buffer_load_dwordx4 v[100:103], v153, s[28:31], s51 offen sc1
  v_mfma_f32_16x16x32_bf16 v[48:51], v[92:95], v[112:115], v[48:51]
  buffer_load_dwordx4 v146, s[24:27], s50 offen offset:2048 lds
  v_mfma_f32_16x16x32_bf16 v[52:55], v[92:95], v[116:119], v[52:55]
  buffer_load_dwordx4 v[104:107], v154, s[28:31], s51 offen sc1
  v_mfma_f32_16x16x32_bf16 v[56:59], v[92:95], v[120:123], v[56:59]
  buffer_load_dwordx4 v147, s[24:27], s50 offen offset:3072 lds
  v_mfma_f32_16x16x32_bf16 v[60:63], v[92:95], v[124:127], v[60:63]
  buffer_load_dwordx4 v[108:111], v155, s[28:31], s51 offen sc1
  s_waitcnt vmcnt(40) lgkmcnt(0)
  v_mfma_f32_16x16x32_bf16 v[0:3], v[64:67], v[128:131], v[0:3]
  ds_read_b64_tr_b16 v[80:81], v148 offset:12288
  s_add_u32 m0, s71, 4096
  s_add_u32 s73, s48, 1
  s_and_b32 s73, s73, 3
  s_add_u32 s51, s49, s73
  s_mul_i32 s50, s51, 28672
  s_lshl_b32 s51, s51, 10
  v_mfma_f32_16x16x32_bf16 v[4:7], v[64:67], v[132:135], v[4:7]
  ds_read_b64_tr_b16 v[82:83], v148 offset:14336
  v_mfma_f32_16x16x32_bf16 v[8:11], v[64:67], v[136:139], v[8:11]
  ds_read_b64_tr_b16 v[84:85], v149 offset:12288
  v_mfma_f32_16x16x32_bf16 v[12:15], v[64:67], v[140:143], v[12:15]
  ds_read_b64_tr_b16 v[86:87], v149 offset:14336
  v_mfma_f32_16x16x32_bf16 v[16:19], v[68:71], v[128:131], v[16:19]
  ds_read_b64_tr_b16 v[88:89], v150 offset:12288
  v_mfma_f32_16x16x32_bf16 v[20:23], v[68:71], v[132:135], v[20:23]
  ds_read_b64_tr_b16 v[90:91], v150 offset:14336
  v_mfma_f32_16x16x32_bf16 v[24:27], v[68:71], v[136:139], v[24:27]
  ds_read_b64_tr_b16 v[92:93], v151 offset:12288
  v_mfma_f32_16x16x32_bf16 v[28:31], v[68:71], v[140:143], v[28:31]
  ds_read_b64_tr_b16 v[94:95], v151 offset:14336
  v_mfma_f32_16x16x32_bf16 v[32:35], v[72:75], v[128:131], v[32:35]
  buffer_load_dwordx4 v144, s[24:27], s50 offen offset:0 lds
  v_mfma_f32_16x16x32_bf16 v[36:39], v[72:75], v[132:135], v[36:39]
  buffer_load_dwordx4 v[112:115], v152, s[28:31], s51 offen sc1
  v_mfma_f32_16x16x32_bf16 v[40:43], v[72:75], v[136:139], v[40:43]
  buffer_load_dwordx4 v145, s[24:27], s50 offen offset:1024 lds
  v_mfma_f32_16x16x32_bf16 v[44:47], v[72:75], v[140:143], v[44:47]
  buffer_load_dwordx4 v[116:119], v153, s[28:31], s51 offen sc1
  v_mfma_f32_16x16x32_bf16 v[48:51], v[76:79], v[128:131], v[48:51]
  buffer_load_dwordx4 v146, s[24:27], s50 offen offset:2048 lds
  v_mfma_f32_16x16x32_bf16 v[52:55], v[76:79], v[132:135], v[52:55]
  buffer_load_dwordx4 v[120:123], v154, s[28:31], s51 offen sc1
  v_mfma_f32_16x16x32_bf16 v[56:59], v[76:79], v[136:139], v[56:59]
  buffer_load_dwordx4 v147, s[24:27], s50 offen offset:3072 lds
  v_mfma_f32_16x16x32_bf16 v[60:63], v[76:79], v[140:143], v[60:63]
  buffer_load_dwordx4 v[124:127], v155, s[28:31], s51 offen sc1
  s_waitcnt vmcnt(40) lgkmcnt(0)
  v_mfma_f32_16x16x32_bf16 v[0:3], v[80:83], v[160:163], v[0:3]
  ds_read_b64_tr_b16 v[64:65], v148 offset:16384
  s_add_u32 m0, s71, 8192
  s_add_u32 s73, s48, 2
  s_and_b32 s73, s73, 3
  s_add_u32 s51, s49, s73
  s_mul_i32 s50, s51, 28672
  s_lshl_b32 s51, s51, 10
  v_mfma_f32_16x16x32_bf16 v[4:7], v[80:83], v[164:167], v[4:7]
  ds_read_b64_tr_b16 v[66:67], v148 offset:18432
  v_mfma_f32_16x16x32_bf16 v[8:11], v[80:83], v[168:171], v[8:11]
  ds_read_b64_tr_b16 v[68:69], v149 offset:16384
  v_mfma_f32_16x16x32_bf16 v[12:15], v[80:83], v[172:175], v[12:15]
  ds_read_b64_tr_b16 v[70:71], v149 offset:18432
  v_mfma_f32_16x16x32_bf16 v[16:19], v[84:87], v[160:163], v[16:19]
  ds_read_b64_tr_b16 v[72:73], v150 offset:16384
  v_mfma_f32_16x16x32_bf16 v[20:23], v[84:87], v[164:167], v[20:23]
  ds_read_b64_tr_b16 v[74:75], v150 offset:18432
  v_mfma_f32_16x16x32_bf16 v[24:27], v[84:87], v[168:171], v[24:27]
  ds_read_b64_tr_b16 v[76:77], v151 offset:16384
  v_mfma_f32_16x16x32_bf16 v[28:31], v[84:87], v[172:175], v[28:31]
  ds_read_b64_tr_b16 v[78:79], v151 offset:18432
  v_mfma_f32_16x16x32_bf16 v[32:35], v[88:91], v[160:163], v[32:35]
  buffer_load_dwordx4 v144, s[24:27], s50 offen offset:0 lds
  v_mfma_f32_16x16x32_bf16 v[36:39], v[88:91], v[164:167], v[36:39]
  buffer_load_dwordx4 v[128:131], v152, s[28:31], s51 offen sc1
  v_mfma_f32_16x16x32_bf16 v[40:43], v[88:91], v[168:171], v[40:43]
  buffer_load_dwordx4 v145, s[24:27], s50 offen offset:1024 lds
  v_mfma_f32_16x16x32_bf16 v[44:47], v[88:91], v[172:175], v[44:47]
  buffer_load_dwordx4 v[132:135], v153, s[28:31], s51 offen sc1
  v_mfma_f32_16x16x32_bf16 v[48:51], v[92:95], v[160:163], v[48:51]
  buffer_load_dwordx4 v146, s[24:27], s50 offen offset:2048 lds
  v_mfma_f32_16x16x32_bf16 v[52:55], v[92:95], v[164:167], v[52:55]
  buffer_load_dwordx4 v[136:139], v154, s[28:31], s51 offen sc1
  v_mfma_f32_16x16x32_bf16 v[56:59], v[92:95], v[168:171], v[56:59]
  buffer_load_dwordx4 v147, s[24:27], s50 offen offset:3072 lds
  v_mfma_f32_16x16x32_bf16 v[60:63], v[92:95], v[172:175], v[60:63]
  buffer_load_dwordx4 v[140:143], v155, s[28:31], s51 offen sc1
  s_waitcnt vmcnt(40) lgkmcnt(0)
  v_mfma_f32_16x16x32_bf16 v[0:3], v[64:67], v[176:179], v[0:3]
  ds_read_b64_tr_b16 v[80:81], v148 offset:20480
  s_add_u32 m0, s71, 12288
  s_add_u32 s73, s48, 3
  s_and_b32 s73, s73, 3
  s_add_u32 s51, s49, s73
  s_mul_i32 s50, s51, 28672
  s_lshl_b32 s51, s51, 10
  v_mfma_f32_16x16x32_bf16 v[4:7], v[64:67], v[180:183], v[4:7]
  ds_read_b64_tr_b16 v[82:83], v148 offset:22528
  v_mfma_f32_16x16x32_bf16 v[8:11], v[64:67], v[184:187], v[8:11]
  ds_read_b64_tr_b16 v[84:85], v149 offset:20480
  v_mfma_f32_16x16x32_bf16 v[12:15], v[64:67], v[188:191], v[12:15]
  ds_read_b64_tr_b16 v[86:87], v149 offset:22528
  v_mfma_f32_16x16x32_bf16 v[16:19], v[68:71], v[176:179], v[16:19]
  ds_read_b64_tr_b16 v[88:89], v150 offset:20480
  v_mfma_f32_16x16x32_bf16 v[20:23], v[68:71], v[180:183], v[20:23]
  ds_read_b64_tr_b16 v[90:91], v150 offset:22528
  v_mfma_f32_16x16x32_bf16 v[24:27], v[68:71], v[184:187], v[24:27]
  ds_read_b64_tr_b16 v[92:93], v151 offset:20480
  v_mfma_f32_16x16x32_bf16 v[28:31], v[68:71], v[188:191], v[28:31]
  ds_read_b64_tr_b16 v[94:95], v151 offset:22528
  v_mfma_f32_16x16x32_bf16 v[32:35], v[72:75], v[176:179], v[32:35]
  buffer_load_dwordx4 v144, s[24:27], s50 offen offset:0 lds
  v_mfma_f32_16x16x32_bf16 v[36:39], v[72:75], v[180:183], v[36:39]
  buffer_load_dwordx4 v[160:163], v152, s[28:31], s51 offen sc1
  v_mfma_f32_16x16x32_bf16 v[40:43], v[72:75], v[184:187], v[40:43]
  buffer_load_dwordx4 v145, s[24:27], s50 offen offset:1024 lds
  v_mfma_f32_16x16x32_bf16 v[44:47], v[72:75], v[188:191], v[44:47]
  buffer_load_dwordx4 v[164:167], v153, s[28:31], s51 offen sc1
  v_mfma_f32_16x16x32_bf16 v[48:51], v[76:79], v[176:179], v[48:51]
  buffer_load_dwordx4 v146, s[24:27], s50 offen offset:2048 lds
  v_mfma_f32_16x16x32_bf16 v[52:55], v[76:79], v[180:183], v[52:55]
  buffer_load_dwordx4 v[168:171], v154, s[28:31], s51 offen sc1
  v_mfma_f32_16x16x32_bf16 v[56:59], v[76:79], v[184:187], v[56:59]
  buffer_load_dwordx4 v147, s[24:27], s50 offen offset:3072 lds
  v_mfma_f32_16x16x32_bf16 v[60:63], v[76:79], v[188:191], v[60:63]
  buffer_load_dwordx4 v[172:175], v155, s[28:31], s51 offen sc1
  s_waitcnt vmcnt(40) lgkmcnt(0)
  v_mfma_f32_16x16x32_bf16 v[0:3], v[80:83], v[192:195], v[0:3]
  ds_read_b64_tr_b16 v[64:65], v148 offset:24576
  s_add_u32 s49, s49, 16
  s_and_b32 s49, s49, 127
  s_lshr_b32 s73, s49, 3
  s_lshl_b32 s43, 1, s73
  s_mov_b32 s74, 0x8000
K2_d7_l:
  s_and_b32 s73, s72, s43
  s_cbranch_scc1 K2_d7_g
  buffer_load_dword v159, v158, s[32:35], 0 offen sc1
  s_waitcnt vmcnt(0)
  v_cmp_eq_u32 vcc, s75, v159
  s_nop 1
  s_lshr_b32 s73, vcc_lo, 1
  s_and_b32 s73, s73, vcc_lo
  s_and_b32 s72, s73, 0x5555
  s_and_b32 s73, s72, s43
  s_cbranch_scc1 K2_d7_g
  s_sleep 4
  s_sub_u32 s74, s74, 1
  s_cmp_lg_u32 s74, 0
  s_cbranch_scc1 K2_d7_l
  s_mov_b32 s72, 0x5555
  s_branch K2_d7_l
K2_d7_g:
  s_add_u32 m0, s71, 16384
  s_add_u32 s73, s48, 0
  s_and_b32 s73, s73, 3
  s_add_u32 s51, s49, s73
  s_mul_i32 s50, s51, 28672
  s_lshl_b32 s51, s51, 10
  v_mfma_f32_16x16x32_bf16 v[4:7], v[80:83], v[196:199], v[4:7]
  ds_read_b64_tr_b16 v[66:67], v148 offset:26624
  v_mfma_f32_16x16x32_bf16 v[8:11], v[80:83], v[200:203], v[8:11]
  ds_read_b64_tr_b16 v[68:69], v149 offset:24576
  v_mfma_f32_16x16x32_bf16 v[12:15], v[80:83], v[204:207], v[12:15]
  ds_read_b64_tr_b16 v[70:71], v149 offset:26624
  v_mfma_f32_16x16x32_bf16 v[16:19], v[84:87], v[192:195], v[16:19]
  ds_read_b64_tr_b16 v[72:73], v150 offset:24576
  v_mfma_f32_16x16x32_bf16 v[20:23], v[84:87], v[196:199], v[20:23]
  ds_read_b64_tr_b16 v[74:75], v150 offset:26624
  v_mfma_f32_16x16x32_bf16 v[24:27], v[84:87], v[200:203], v[24:27]
  ds_read_b64_tr_b16 v[76:77], v151 offset:24576
  v_mfma_f32_16x16x32_bf16 v[28:31], v[84:87], v[204:207], v[28:31]
  ds_read_b64_tr_b16 v[78:79], v151 offset:26624
  v_mfma_f32_16x16x32_bf16 v[32:35], v[88:91], v[192:195], v[32:35]
  buffer_load_dwordx4 v144, s[24:27], s50 offen offset:0 lds
  v_mfma_f32_16x16x32_bf16 v[36:39], v[88:91], v[196:199], v[36:39]
  buffer_load_dwordx4 v[176:179], v152, s[28:31], s51 offen sc1
  v_mfma_f32_16x16x32_bf16 v[40:43], v[88:91], v[200:203], v[40:43]
  buffer_load_dwordx4 v145, s[24:27], s50 offen offset:1024 lds
  v_mfma_f32_16x16x32_bf16 v[44:47], v[88:91], v[204:207], v[44:47]
  buffer_load_dwordx4 v[180:183], v153, s[28:31], s51 offen sc1
  v_mfma_f32_16x16x32_bf16 v[48:51], v[92:95], v[192:195], v[48:51]
  buffer_load_dwordx4 v146, s[24:27], s50 offen offset:2048 lds
  v_mfma_f32_16x16x32_bf16 v[52:55], v[92:95], v[196:199], v[52:55]
  buffer_load_dwordx4 v[184:187], v154, s[28:31], s51 offen sc1
  v_mfma_f32_16x16x32_bf16 v[56:59], v[92:95], v[200:203], v[56:59]
  buffer_load_dwordx4 v147, s[24:27], s50 offen offset:3072 lds
  v_mfma_f32_16x16x32_bf16 v[60:63], v[92:95], v[204:207], v[60:63]
  buffer_load_dwordx4 v[188:191], v155, s[28:31], s51 offen sc1
  s_waitcnt vmcnt(40) lgkmcnt(0)
  v_mfma_f32_16x16x32_bf16 v[0:3], v[64:67], v[208:211], v[0:3]
  ds_read_b64_tr_b16 v[80:81], v148 offset:28672
  s_add_u32 m0, s71, 20480
  s_add_u32 s73, s48, 1
  s_and_b32 s73, s73, 3
  s_add_u32 s51, s49, s73
  s_mul_i32 s50, s51, 28672
  s_lshl_b32 s51, s51, 10
  v_mfma_f32_16x16x32_bf16 v[4:7], v[64:67], v[212:215], v[4:7]
  ds_read_b64_tr_b16 v[82:83], v148 offset:30720
  v_mfma_f32_16x16x32_bf16 v[8:11], v[64:67], v[216:219], v[8:11]
  ds_read_b64_tr_b16 v[84:85], v149 offset:28672
  v_mfma_f32_16x16x32_bf16 v[12:15], v[64:67], v[220:223], v[12:15]
  ds_read_b64_tr_b16 v[86:87], v149 offset:30720
  v_mfma_f32_16x16x32_bf16 v[16:19], v[68:71], v[208:211], v[16:19]
  ds_read_b64_tr_b16 v[88:89], v150 offset:28672
  v_mfma_f32_16x16x32_bf16 v[20:23], v[68:71], v[212:215], v[20:23]
  ds_read_b64_tr_b16 v[90:91], v150 offset:30720
  v_mfma_f32_16x16x32_bf16 v[24:27], v[68:71], v[216:219], v[24:27]
  ds_read_b64_tr_b16 v[92:93], v151 offset:28672
  v_mfma_f32_16x16x32_bf16 v[28:31], v[68:71], v[220:223], v[28:31]
  ds_read_b64_tr_b16 v[94:95], v151 offset:30720
  v_mfma_f32_16x16x32_bf16 v[32:35], v[72:75], v[208:211], v[32:35]
  buffer_load_dwordx4 v144, s[24:27], s50 offen offset:0 lds
  v_mfma_f32_16x16x32_bf16 v[36:39], v[72:75], v[212:215], v[36:39]
  buffer_load_dwordx4 v[192:195], v152, s[28:31], s51 offen sc1
  v_mfma_f32_16x16x32_bf16 v[40:43], v[72:75], v[216:219], v[40:43]
  buffer_load_dwordx4 v145, s[24:27], s50 offen offset:1024 lds
  v_mfma_f32_16x16x32_bf16 v[44:47], v[72:75], v[220:223], v[44:47]
  buffer_load_dwordx4 v[196:199], v153, s[28:31], s51 offen sc1
  v_mfma_f32_16x16x32_bf16 v[48:51], v[76:79], v[208:211], v[48:51]
  buffer_load_dwordx4 v146, s[24:27], s50 offen offset:2048 lds
  v_mfma_f32_16x16x32_bf16 v[52:55], v[76:79], v[212:215], v[52:55]
  buffer_load_dwordx4 v[200:203], v154, s[28:31], s51 offen sc1
  v_mfma_f32_16x16x32_bf16 v[56:59], v[76:79], v[216:219], v[56:59]
  buffer_load_dwordx4 v147, s[24:27], s50 offen offset:3072 lds
  v_mfma_f32_16x16x32_bf16 v[60:63], v[76:79], v[220:223], v[60:63]
  buffer_load_dwordx4 v[204:207], v155, s[28:31], s51 offen sc1
  s_waitcnt vmcnt(40) lgkmcnt(0)
  v_mfma_f32_16x16x32_bf16 v[0:3], v[80:83], v[224:227], v[0:3]
  ds_read_b64_tr_b16 v[64:65], v148 offset:0
  s_add_u32 m0, s71, 24576
  s_add_u32 s73, s48, 2
  s_and_b32 s73, s73, 3
  s_add_u32 s51, s49, s73
  s_mul_i32 s50, s51, 28672
  s_lshl_b32 s51, s51, 10
  v_mfma_f32_16x16x32_bf16 v[4:7], v[80:83], v[228:231], v[4:7]
  ds_read_b64_tr_b16 v[66:67], v148 offset:2048
  v_mfma_f32_16x16x32_bf16 v[8:11], v[80:83], v[232:235], v[8:11]
  ds_read_b64_tr_b16 v[68:69], v149 offset:0
  v_mfma_f32_16x16x32_bf16 v[12:15], v[80:83], v[236:239], v[12:15]
  ds_read_b64_tr_b16 v[70:71], v149 offset:2048
  v_mfma_f32_16x16x32_bf16 v[16:19], v[84:87], v[224:227], v[16:19]
  ds_read_b64_tr_b16 v[72:73], v150 offset:0
  v_mfma_f32_16x16x32_bf16 v[20:23], v[84:87], v[228:231], v[20:23]
  ds_read_b64_tr_b16 v[74:75], v150 offset:2048
  v_mfma_f32_16x16x32_bf16 v[24:27], v[84:87], v[232:235], v[24:27]
  ds_read_b64_tr_b16 v[76:77], v151 offset:0
  v_mfma_f32_16x16x32_bf16 v[28:31], v[84:87], v[236:239], v[28:31]
  ds_read_b64_tr_b16 v[78:79], v151 offset:2048
  v_mfma_f32_16x16x32_bf16 v[32:35], v[88:91], v[224:227], v[32:35]
  buffer_load_dwordx4 v144, s[24:27], s50 offen offset:0 lds
  v_mfma_f32_16x16x32_bf16 v[36:39], v[88:91], v[228:231], v[36:39]
  buffer_load_dwordx4 v[208:211], v152, s[28:31], s51 offen sc1
  v_mfma_f32_16x16x32_bf16 v[40:43], v[88:91], v[232:235], v[40:43]
  buffer_load_dwordx4 v145, s[24:27], s50 offen offset:1024 lds
  v_mfma_f32_16x16x32_bf16 v[44:47], v[88:91], v[236:239], v[44:47]
  buffer_load_dwordx4 v[212:215], v153, s[28:31], s51 offen sc1
  v_mfma_f32_16x16x32_bf16 v[48:51], v[92:95], v[224:227], v[48:51]
  buffer_load_dwordx4 v146, s[24:27], s50 offen offset:2048 lds
  v_mfma_f32_16x16x32_bf16 v[52:55], v[92:95], v[228:231], v[52:55]
  buffer_load_dwordx4 v[216:219], v154, s[28:31], s51 offen sc1
  v_mfma_f32_16x16x32_bf16 v[56:59], v[92:95], v[232:235], v[56:59]
  buffer_load_dwordx4 v147, s[24:27], s50 offen offset:3072 lds
  v_mfma_f32_16x16x32_bf16 v[60:63], v[92:95], v[236:239], v[60:63]
  buffer_load_dwordx4 v[220:223], v155, s[28:31], s51 offen sc1
  s_waitcnt vmcnt(40) lgkmcnt(0)
  v_mfma_f32_16x16x32_bf16 v[0:3], v[64:67], v[96:99], v[0:3]
  ds_read_b64_tr_b16 v[80:81], v148 offset:4096
  s_add_u32 m0, s71, 28672
  s_add_u32 s73, s48, 3
  s_and_b32 s73, s73, 3
  s_add_u32 s51, s49, s73
  s_mul_i32 s50, s51, 28672
  s_lshl_b32 s51, s51, 10
  v_mfma_f32_16x16x32_bf16 v[4:7], v[64:67], v[100:103], v[4:7]
  ds_read_b64_tr_b16 v[82:83], v148 offset:6144
  v_mfma_f32_16x16x32_bf16 v[8:11], v[64:67], v[104:107], v[8:11]
  ds_read_b64_tr_b16 v[84:85], v149 offset:4096
  v_mfma_f32_16x16x32_bf16 v[12:15], v[64:67], v[108:111], v[12:15]
  ds_read_b64_tr_b16 v[86:87], v149 offset:6144
  v_mfma_f32_16x16x32_bf16 v[16:19], v[68:71], v[96:99], v[16:19]
  ds_read_b64_tr_b16 v[88:89], v150 offset:4096
  v_mfma_f32_16x16x32_bf16 v[20:23], v[68:71], v[100:103], v[20:23]
  ds_read_b64_tr_b16 v[90:91], v150 offset:6144
  v_mfma_f32_16x16x32_bf16 v[24:27], v[68:71], v[104:107], v[24:27]
  ds_read_b64_tr_b16 v[92:93], v151 offset:4096
  v_mfma_f32_16x16x32_bf16 v[28:31], v[68:71], v[108:111], v[28:31]
  ds_read_b64_tr_b16 v[94:95], v151 offset:6144
  v_mfma_f32_16x16x32_bf16 v[32:35], v[72:75], v[96:99], v[32:35]
  buffer_load_dwordx4 v144, s[24:27], s50 offen offset:0 lds
  v_mfma_f32_16x16x32_bf16 v[36:39], v[72:75], v[100:103], v[36:39]
  buffer_load_dwordx4 v[224:227], v152, s[28:31], s51 offen sc1
  v_mfma_f32_16x16x32_bf16 v[40:43], v[72:75], v[104:107], v[40:43]
  buffer_load_dwordx4 v145, s[24:27], s50 offen offset:1024 lds
  v_mfma_f32_16x16x32_bf16 v[44:47], v[72:75], v[108:111], v[44:47]
  buffer_load_dwordx4 v[228:231], v153, s[28:31], s51 offen sc1
  v_mfma_f32_16x16x32_bf16 v[48:51], v[76:79], v[96:99], v[48:51]
  buffer_load_dwordx4 v146, s[24:27], s50 offen offset:2048 lds
  v_mfma_f32_16x16x32_bf16 v[52:55], v[76:79], v[100:103], v[52:55]
  buffer_load_dwordx4 v[232:235], v154, s[28:31], s51 offen sc1
  v_mfma_f32_16x16x32_bf16 v[56:59], v[76:79], v[104:107], v[56:59]
  buffer_load_dwordx4 v147, s[24:27], s50 offen offset:3072 lds
  v_mfma_f32_16x16x32_bf16 v[60:63], v[76:79], v[108:111], v[60:63]
  buffer_load_dwordx4 v[236:239], v155, s[28:31], s51 offen sc1
  s_waitcnt vmcnt(40) lgkmcnt(0)
  v_mfma_f32_16x16x32_bf16 v[0:3], v[80:83], v[112:115], v[0:3]
  ds_read_b64_tr_b16 v[64:65], v148 offset:8192
  v_mfma_f32_16x16x32_bf16 v[4:7], v[80:83], v[116:119], v[4:7]
  ds_read_b64_tr_b16 v[66:67], v148 offset:10240
  v_mfma_f32_16x16x32_bf16 v[8:11], v[80:83], v[120:123], v[8:11]
  ds_read_b64_tr_b16 v[68:69], v149 offset:8192
  v_mfma_f32_16x16x32_bf16 v[12:15], v[80:83], v[124:127], v[12:15]
  ds_read_b64_tr_b16 v[70:71], v149 offset:10240
  v_mfma_f32_16x16x32_bf16 v[16:19], v[84:87], v[112:115], v[16:19]
  ds_read_b64_tr_b16 v[72:73], v150 offset:8192
  v_mfma_f32_16x16x32_bf16 v[20:23], v[84:87], v[116:119], v[20:23]
  ds_read_b64_tr_b16 v[74:75], v150 offset:10240
  v_mfma_f32_16x16x32_bf16 v[24:27], v[84:87], v[120:123], v[24:27]
  ds_read_b64_tr_b16 v[76:77], v151 offset:8192
  v_mfma_f32_16x16x32_bf16 v[28:31], v[84:87], v[124:127], v[28:31]
  ds_read_b64_tr_b16 v[78:79], v151 offset:10240
  v_mfma_f32_16x16x32_bf16 v[32:35], v[88:91], v[112:115], v[32:35]
  v_mfma_f32_16x16x32_bf16 v[36:39], v[88:91], v[116:119], v[36:39]
  v_mfma_f32_16x16x32_bf16 v[40:43], v[88:91], v[120:123], v[40:43]
  v_mfma_f32_16x16x32_bf16 v[44:47], v[88:91], v[124:127], v[44:47]
  v_mfma_f32_16x16x32_bf16 v[48:51], v[92:95], v[112:115], v[48:51]
  v_mfma_f32_16x16x32_bf16 v[52:55], v[92:95], v[116:119], v[52:55]
  v_mfma_f32_16x16x32_bf16 v[56:59], v[92:95], v[120:123], v[56:59]
  v_mfma_f32_16x16x32_bf16 v[60:63], v[92:95], v[124:127], v[60:63]
  v_and_b32 v245, 15, v156
  s_lshl_b32 s52, s69, 6
  s_lshl_b32 s53, s14, 4
  s_add_u32 s52, s52, s53
  s_lshl_b32 s44, s70, 8
  s_mov_b32 s20, s10
  s_mov_b32 s21, s11
  s_and_b32 s21, s21, 0xffff
  s_mov_b32 s22, 0x2a00
  s_mov_b32 s23, 0x20000
  v_lshlrev_b32 v246, 4, v157
  s_add_u32 s47, s44, 3584
  buffer_load_dwordx4 v[96:99], v246, s[20:23], s47 offen offset:0 sc1
  buffer_load_dwordx4 v[100:103], v246, s[20:23], s47 offen offset:64 sc1
  buffer_load_dwordx4 v[104:107], v246, s[20:23], s47 offen offset:128 sc1
  buffer_load_dwordx4 v[108:111], v246, s[20:23], s47 offen offset:192 sc1
  s_waitcnt vmcnt(36) lgkmcnt(0)
  v_mfma_f32_16x16x32_bf16 v[0:3], v[64:67], v[128:131], v[0:3]
  ds_read_b64_tr_b16 v[80:81], v148 offset:12288
  v_mfma_f32_16x16x32_bf16 v[4:7], v[64:67], v[132:135], v[4:7]
  ds_read_b64_tr_b16 v[82:83], v148 offset:14336
  v_mfma_f32_16x16x32_bf16 v[8:11], v[64:67], v[136:139], v[8:11]
  ds_read_b64_tr_b16 v[84:85], v149 offset:12288
  v_mfma_f32_16x16x32_bf16 v[12:15], v[64:67], v[140:143], v[12:15]
  ds_read_b64_tr_b16 v[86:87], v149 offset:14336
  v_mfma_f32_16x16x32_bf16 v[16:19], v[68:71], v[128:131], v[16:19]
  ds_read_b64_tr_b16 v[88:89], v150 offset:12288
  v_mfma_f32_16x16x32_bf16 v[20:23], v[68:71], v[132:135], v[20:23]
  ds_read_b64_tr_b16 v[90:91], v150 offset:14336
  v_mfma_f32_16x16x32_bf16 v[24:27], v[68:71], v[136:139], v[24:27]
  ds_read_b64_tr_b16 v[92:93], v151 offset:12288
  v_mfma_f32_16x16x32_bf16 v[28:31], v[68:71], v[140:143], v[28:31]
  ds_read_b64_tr_b16 v[94:95], v151 offset:14336
  v_mfma_f32_16x16x32_bf16 v[32:35], v[72:75], v[128:131], v[32:35]
  v_mfma_f32_16x16x32_bf16 v[36:39], v[72:75], v[132:135], v[36:39]
  v_mfma_f32_16x16x32_bf16 v[40:43], v[72:75], v[136:139], v[40:43]
  v_mfma_f32_16x16x32_bf16 v[44:47], v[72:75], v[140:143], v[44:47]
  v_mfma_f32_16x16x32_bf16 v[48:51], v[76:79], v[128:131], v[48:51]
  v_mfma_f32_16x16x32_bf16 v[52:55], v[76:79], v[132:135], v[52:55]
  v_mfma_f32_16x16x32_bf16 v[56:59], v[76:79], v[136:139], v[56:59]
  v_mfma_f32_16x16x32_bf16 v[60:63], v[76:79], v[140:143], v[60:63]
  s_add_u32 s47, s44, 7168
  buffer_load_dwordx4 v[112:115], v246, s[20:23], s47 offen offset:0 sc1
  buffer_load_dwordx4 v[116:119], v246, s[20:23], s47 offen offset:64 sc1
  buffer_load_dwordx4 v[120:123], v246, s[20:23], s47 offen offset:128 sc1
  buffer_load_dwordx4 v[124:127], v246, s[20:23], s47 offen offset:192 sc1
  s_waitcnt vmcnt(32) lgkmcnt(0)
  v_mfma_f32_16x16x32_bf16 v[0:3], v[80:83], v[160:163], v[0:3]
  ds_read_b64_tr_b16 v[64:65], v148 offset:16384
  v_mfma_f32_16x16x32_bf16 v[4:7], v[80:83], v[164:167], v[4:7]
  ds_read_b64_tr_b16 v[66:67], v148 offset:18432
  v_mfma_f32_16x16x32_bf16 v[8:11], v[80:83], v[168:171], v[8:11]
  ds_read_b64_tr_b16 v[68:69], v149 offset:16384
  v_mfma_f32_16x16x32_bf16 v[12:15], v[80:83], v[172:175], v[12:15]
  ds_read_b64_tr_b16 v[70:71], v149 offset:18432
  v_mfma_f32_16x16x32_bf16 v[16:19], v[84:87], v[160:163], v[16:19]
  ds_read_b64_tr_b16 v[72:73], v150 offset:16384
  v_mfma_f32_16x16x32_bf16 v[20:23], v[84:87], v[164:167], v[20:23]
  ds_read_b64_tr_b16 v[74:75], v150 offset:18432
  v_mfma_f32_16x16x32_bf16 v[24:27], v[84:87], v[168:171], v[24:27]
  ds_read_b64_tr_b16 v[76:77], v151 offset:16384
  v_mfma_f32_16x16x32_bf16 v[28:31], v[84:87], v[172:175], v[28:31]
  ds_read_b64_tr_b16 v[78:79], v151 offset:18432
  v_mfma_f32_16x16x32_bf16 v[32:35], v[88:91], v[160:163], v[32:35]
  v_mfma_f32_16x16x32_bf16 v[36:39], v[88:91], v[164:167], v[36:39]
  v_mfma_f32_16x16x32_bf16 v[40:43], v[88:91], v[168:171], v[40:43]
  v_mfma_f32_16x16x32_bf16 v[44:47], v[88:91], v[172:175], v[44:47]
  v_mfma_f32_16x16x32_bf16 v[48:51], v[92:95], v[160:163], v[48:51]
  v_mfma_f32_16x16x32_bf16 v[52:55], v[92:95], v[164:167], v[52:55]
  v_mfma_f32_16x16x32_bf16 v[56:59], v[92:95], v[168:171], v[56:59]
  v_mfma_f32_16x16x32_bf16 v[60:63], v[92:95], v[172:175], v[60:63]
  s_lshr_b32 s56, s52, 4
  s_mul_i32 s56, s56, 14336
  s_lshl_b32 s57, s70, 11
  s_add_u32 s56, s56, s57
  s_mul_i32 s58, s52, 896
  s_lshl_b32 s57, s70, 7
  s_add_u32 s58, s58, s57
  v_mul_u32_u24 v247, 896, v245
  v_lshl_add_u32 v247, v157, 3, v247
  s_mov_b32 s16, s64
  s_mov_b32 s17, s65
  s_and_b32 s17, s17, 0xffff
  s_mov_b32 s18, 0x1c0000
  s_mov_b32 s19, 0x20000
  buffer_load_dwordx2 v[128:129], v247, s[16:19], s58 offen offset:0
  buffer_load_dwordx2 v[130:131], v247, s[16:19], s58 offen offset:32
  buffer_load_dwordx2 v[132:133], v247, s[16:19], s58 offen offset:64
  buffer_load_dwordx2 v[134:135], v247, s[16:19], s58 offen offset:96
  s_add_u32 s36, s10, 0x400000
  s_addc_u32 s37, s11, 0
  s_and_b32 s37, s37, 0xffff
  s_mov_b32 s38, 0x1c0000
  s_mov_b32 s39, 0x20000
  s_add_u32 s40, s10, 0x8000
  s_addc_u32 s41, s11, 0
  s_and_b32 s41, s41, 0xffff
  s_mov_b32 s42, 0x1c000
  s_mov_b32 s43, 0x20000
  s_waitcnt vmcnt(28) lgkmcnt(0)
  v_mfma_f32_16x16x32_bf16 v[0:3], v[64:67], v[176:179], v[0:3]
  ds_read_b64_tr_b16 v[80:81], v148 offset:20480
  v_mfma_f32_16x16x32_bf16 v[4:7], v[64:67], v[180:183], v[4:7]
  ds_read_b64_tr_b16 v[82:83], v148 offset:22528
  v_mfma_f32_16x16x32_bf16 v[8:11], v[64:67], v[184:187], v[8:11]
  ds_read_b64_tr_b16 v[84:85], v149 offset:20480
  v_mfma_f32_16x16x32_bf16 v[12:15], v[64:67], v[188:191], v[12:15]
  ds_read_b64_tr_b16 v[86:87], v149 offset:22528
  v_mfma_f32_16x16x32_bf16 v[16:19], v[68:71], v[176:179], v[16:19]
  ds_read_b64_tr_b16 v[88:89], v150 offset:20480
  v_mfma_f32_16x16x32_bf16 v[20:23], v[68:71], v[180:183], v[20:23]
  ds_read_b64_tr_b16 v[90:91], v150 offset:22528
  v_mfma_f32_16x16x32_bf16 v[24:27], v[68:71], v[184:187], v[24:27]
  ds_read_b64_tr_b16 v[92:93], v151 offset:20480
  v_mfma_f32_16x16x32_bf16 v[28:31], v[68:71], v[188:191], v[28:31]
  ds_read_b64_tr_b16 v[94:95], v151 offset:22528
  v_mfma_f32_16x16x32_bf16 v[32:35], v[72:75], v[176:179], v[32:35]
  v_mfma_f32_16x16x32_bf16 v[36:39], v[72:75], v[180:183], v[36:39]
  v_mfma_f32_16x16x32_bf16 v[40:43], v[72:75], v[184:187], v[40:43]
  v_mfma_f32_16x16x32_bf16 v[44:47], v[72:75], v[188:191], v[44:47]
  v_mfma_f32_16x16x32_bf16 v[48:51], v[76:79], v[176:179], v[48:51]
  v_mfma_f32_16x16x32_bf16 v[52:55], v[76:79], v[180:183], v[52:55]
  v_mfma_f32_16x16x32_bf16 v[56:59], v[76:79], v[184:187], v[56:59]
  v_mfma_f32_16x16x32_bf16 v[60:63], v[76:79], v[188:191], v[60:63]
  s_waitcnt vmcnt(20) lgkmcnt(0)
  v_mfma_f32_16x16x32_bf16 v[0:3], v[80:83], v[192:195], v[0:3]
  ds_read_b64_tr_b16 v[64:65], v148 offset:24576
  v_mfma_f32_16x16x32_bf16 v[4:7], v[80:83], v[196:199], v[4:7]
  ds_read_b64_tr_b16 v[66:67], v148 offset:26624
  v_mfma_f32_16x16x32_bf16 v[8:11], v[80:83], v[200:203], v[8:11]
  ds_read_b64_tr_b16 v[68:69], v149 offset:24576
  v_mfma_f32_16x16x32_bf16 v[12:15], v[80:83], v[204:207], v[12:15]
  ds_read_b64_tr_b16 v[70:71], v149 offset:26624
  v_mfma_f32_16x16x32_bf16 v[16:19], v[84:87], v[192:195], v[16:19]
  ds_read_b64_tr_b16 v[72:73], v150 offset:24576
  v_mfma_f32_16x16x32_bf16 v[20:23], v[84:87], v[196:199], v[20:23]
  ds_read_b64_tr_b16 v[74:75], v150 offset:26624
  v_mfma_f32_16x16x32_bf16 v[24:27], v[84:87], v[200:203], v[24:27]
  ds_read_b64_tr_b16 v[76:77], v151 offset:24576
  v_mfma_f32_16x16x32_bf16 v[28:31], v[84:87], v[204:207], v[28:31]
  ds_read_b64_tr_b16 v[78:79], v151 offset:26624
  v_mfma_f32_16x16x32_bf16 v[32:35], v[88:91], v[192:195], v[32:35]
  v_mfma_f32_16x16x32_bf16 v[36:39], v[88:91], v[196:199], v[36:39]
  v_mfma_f32_16x16x32_bf16 v[40:43], v[88:91], v[200:203], v[40:43]
  v_mfma_f32_16x16x32_bf16 v[44:47], v[88:91], v[204:207], v[44:47]
  v_mfma_f32_16x16x32_bf16 v[48:51], v[92:95], v[192:195], v[48:51]
  v_mfma_f32_16x16x32_bf16 v[52:55], v[92:95], v[196:199], v[52:55]
  v_mfma_f32_16x16x32_bf16 v[56:59], v[92:95], v[200:203], v[56:59]
  v_mfma_f32_16x16x32_bf16 v[60:63], v[92:95], v[204:207], v[60:63]
  s_waitcnt vmcnt(12) lgkmcnt(0)
  v_mfma_f32_16x16x32_bf16 v[0:3], v[64:67], v[208:211], v[0:3]
  ds_read_b64_tr_b16 v[80:81], v148 offset:28672
  v_mfma_f32_16x16x32_bf16 v[4:7], v[64:67], v[212:215], v[4:7]
  ds_read_b64_tr_b16 v[82:83], v148 offset:30720
  v_mfma_f32_16x16x32_bf16 v[8:11], v[64:67], v[216:219], v[8:11]
  ds_read_b64_tr_b16 v[84:85], v149 offset:28672
  v_mfma_f32_16x16x32_bf16 v[12:15], v[64:67], v[220:223], v[12:15]
  ds_read_b64_tr_b16 v[86:87], v149 offset:30720
  v_mfma_f32_16x16x32_bf16 v[16:19], v[68:71], v[208:211], v[16:19]
  ds_read_b64_tr_b16 v[88:89], v150 offset:28672
  v_mfma_f32_16x16x32_bf16 v[20:23], v[68:71], v[212:215], v[20:23]
  ds_read_b64_tr_b16 v[90:91], v150 offset:30720
  v_mfma_f32_16x16x32_bf16 v[24:27], v[68:71], v[216:219], v[24:27]
  ds_read_b64_tr_b16 v[92:93], v151 offset:28672
  v_mfma_f32_16x16x32_bf16 v[28:31], v[68:71], v[220:223], v[28:31]
  ds_read_b64_tr_b16 v[94:95], v151 offset:30720
  v_mfma_f32_16x16x32_bf16 v[32:35], v[72:75], v[208:211], v[32:35]
  v_mfma_f32_16x16x32_bf16 v[36:39], v[72:75], v[212:215], v[36:39]
  v_mfma_f32_16x16x32_bf16 v[40:43], v[72:75], v[216:219], v[40:43]
  v_mfma_f32_16x16x32_bf16 v[44:47], v[72:75], v[220:223], v[44:47]
  v_mfma_f32_16x16x32_bf16 v[48:51], v[76:79], v[208:211], v[48:51]
  v_mfma_f32_16x16x32_bf16 v[52:55], v[76:79], v[212:215], v[52:55]
  v_mfma_f32_16x16x32_bf16 v[56:59], v[76:79], v[216:219], v[56:59]
  v_mfma_f32_16x16x32_bf16 v[60:63], v[76:79], v[220:223], v[60:63]
  s_waitcnt lgkmcnt(0)
  v_mfma_f32_16x16x32_bf16 v[0:3], v[80:83], v[224:227], v[0:3]
  v_mfma_f32_16x16x32_bf16 v[4:7], v[80:83], v[228:231], v[4:7]
  v_mfma_f32_16x16x32_bf16 v[8:11], v[80:83], v[232:235], v[8:11]
  v_mfma_f32_16x16x32_bf16 v[12:15], v[80:83], v[236:239], v[12:15]
  v_mfma_f32_16x16x32_bf16 v[16:19], v[84:87], v[224:227], v[16:19]
  v_mfma_f32_16x16x32_bf16 v[20:23], v[84:87], v[228:231], v[20:23]
  v_mfma_f32_16x16x32_bf16 v[24:27], v[84:87], v[232:235], v[24:27]
  v_mfma_f32_16x16x32_bf16 v[28:31], v[84:87], v[236:239], v[28:31]
  v_mfma_f32_16x16x32_bf16 v[32:35], v[88:91], v[224:227], v[32:35]
  v_mfma_f32_16x16x32_bf16 v[36:39], v[88:91], v[228:231], v[36:39]
  v_mfma_f32_16x16x32_bf16 v[40:43], v[88:91], v[232:235], v[40:43]
  v_mfma_f32_16x16x32_bf16 v[44:47], v[88:91], v[236:239], v[44:47]
  v_mfma_f32_16x16x32_bf16 v[48:51], v[92:95], v[224:227], v[48:51]
  v_mfma_f32_16x16x32_bf16 v[52:55], v[92:95], v[228:231], v[52:55]
  v_mfma_f32_16x16x32_bf16 v[56:59], v[92:95], v[232:235], v[56:59]
  v_mfma_f32_16x16x32_bf16 v[60:63], v[92:95], v[236:239], v[60:63]
  v_add_u32 v248, s71, v243
  s_sub_u32 s59, s14, 1
  s_and_b32 s59, s59, 3
  s_lshl_b32 s73, s59, 15
  s_cmp_eq_u32 s59, 3
  s_cselect_b32 s73, 0x20000, s73
  v_add_u32 v249, s73, v243
  s_sub_u32 s59, s14, 2
  s_and_b32 s59, s59, 3
  s_lshl_b32 s73, s59, 15
  s_cmp_eq_u32 s59, 3
  s_cselect_b32 s73, 0x20000, s73
  v_add_u32 v250, s73, v243
  s_sub_u32 s59, s14, 3
  s_and_b32 s59, s59, 3
  s_lshl_b32 s73, s59, 15
  s_cmp_eq_u32 s59, 3
  s_cselect_b32 s73, 0x20000, s73
  v_add_u32 v251, s73, v243
  ds_write_b128 v248, v[4:7] offset:0
  ds_write_b128 v248, v[20:23] offset:1024
  ds_write_b128 v248, v[36:39] offset:2048
  ds_write_b128 v248, v[52:55] offset:3072
  ds_write_b128 v248, v[8:11] offset:4096
  ds_write_b128 v248, v[24:27] offset:5120
  ds_write_b128 v248, v[40:43] offset:6144
  ds_write_b128 v248, v[56:59] offset:7168
  ds_write_b128 v248, v[12:15] offset:8192
  ds_write_b128 v248, v[28:31] offset:9216
  ds_write_b128 v248, v[44:47] offset:10240
  ds_write_b128 v248, v[60:63] offset:11264
  s_waitcnt lgkmcnt(0)
  s_barrier
  ds_read_b128 v[4:7], v249 offset:0
  ds_read_b128 v[20:23], v249 offset:1024
  ds_read_b128 v[36:39], v249 offset:2048
  ds_read_b128 v[52:55], v249 offset:3072
  ds_read_b128 v[8:11], v250 offset:4096
  ds_read_b128 v[24:27], v250 offset:5120
  ds_read_b128 v[40:43], v250 offset:6144
  ds_read_b128 v[56:59], v250 offset:7168
  ds_read_b128 v[12:15], v251 offset:8192
  ds_read_b128 v[28:31], v251 offset:9216
  ds_read_b128 v[44:47], v251 offset:10240
  ds_read_b128 v[60:63], v251 offset:11264
  s_waitcnt lgkmcnt(8)
  v_add_f32 v64, v0, v4
  v_add_f32 v65, v1, v5
  v_add_f32 v66, v2, v6
  v_add_f32 v67, v3, v7
  v_add_f32 v68, v16, v20
  v_add_f32 v69, v17, v21
  v_add_f32 v70, v18, v22
  v_add_f32 v71, v19, v23
  v_add_f32 v72, v32, v36
  v_add_f32 v73, v33, v37
  v_add_f32 v74, v34, v38
  v_add_f32 v75, v35, v39
  v_add_f32 v76, v48, v52
  v_add_f32 v77, v49, v53
  v_add_f32 v78, v50, v54
  v_add_f32 v79, v51, v55
  s_waitcnt lgkmcnt(0)
  s_barrier
  v_add_f32 v8, v8, v12
  v_add_f32 v9, v9, v13
  v_add_f32 v10, v10, v14
  v_add_f32 v11, v11, v15
  v_add_f32 v24, v24, v28
  v_add_f32 v25, v25, v29
  v_add_f32 v26, v26, v30
  v_add_f32 v27, v27, v31
  v_add_f32 v40, v40, v44
  v_add_f32 v41, v41, v45
  v_add_f32 v42, v42, v46
  v_add_f32 v43, v43, v47
  v_add_f32 v56, v56, v60
  v_add_f32 v57, v57, v61
  v_add_f32 v58, v58, v62
  v_add_f32 v59, v59, v63
  v_add_f32 v0, v64, v8
  v_add_f32 v1, v65, v9
  v_add_f32 v2, v66, v10
  v_add_f32 v3, v67, v11
  v_add_f32 v4, v68, v24
  v_add_f32 v5, v69, v25
  v_add_f32 v6, v70, v26
  v_add_f32 v7, v71, v27
  v_add_f32 v8, v72, v40
  v_add_f32 v9, v73, v41
  v_add_f32 v10, v74, v42
  v_add_f32 v11, v75, v43
  v_add_f32 v12, v76, v56
  v_add_f32 v13, v77, v57
  v_add_f32 v14, v78, v58
  v_add_f32 v15, v79, v59
  s_waitcnt vmcnt(0)
  v_cvt_pk_bf16_f32 v16, v0, v1
  v_cvt_pk_bf16_f32 v17, v2, v3
  v_cvt_pk_bf16_f32 v18, v4, v5
  v_cvt_pk_bf16_f32 v19, v6, v7
  v_cvt_pk_bf16_f32 v20, v8, v9
  v_cvt_pk_bf16_f32 v21, v10, v11
  v_cvt_pk_bf16_f32 v22, v12, v13
  v_cvt_pk_bf16_f32 v23, v14, v15
  v_lshlrev_b32 v0, 16, v16
  v_and_b32 v1, 0xffff0000, v16
  v_lshlrev_b32 v2, 16, v17
  v_and_b32 v3, 0xffff0000, v17
  v_lshlrev_b32 v4, 16, v18
  v_and_b32 v5, 0xffff0000, v18
  v_lshlrev_b32 v6, 16, v19
  v_and_b32 v7, 0xffff0000, v19
  v_lshlrev_b32 v8, 16, v20
  v_and_b32 v9, 0xffff0000, v20
  v_lshlrev_b32 v10, 16, v21
  v_and_b32 v11, 0xffff0000, v21
  v_lshlrev_b32 v12, 16, v22
  v_and_b32 v13, 0xffff0000, v22
  v_lshlrev_b32 v14, 16, v23
  v_and_b32 v15, 0xffff0000, v23
  v_mul_f32 v0, v0, v96
  v_mul_f32 v1, v1, v97
  v_mul_f32 v2, v2, v98
  v_mul_f32 v3, v3, v99
  v_mul_f32 v4, v4, v100
  v_mul_f32 v5, v5, v101
  v_mul_f32 v6, v6, v102
  v_mul_f32 v7, v7, v103
  v_mul_f32 v8, v8, v104
  v_mul_f32 v9, v9, v105
  v_mul_f32 v10, v10, v106
  v_mul_f32 v11, v11, v107
  v_mul_f32 v12, v12, v108
  v_mul_f32 v13, v13, v109
  v_mul_f32 v14, v14, v110
  v_mul_f32 v15, v15, v111
  v_cvt_pk_bf16_f32 v16, v0, v1
  v_cvt_pk_bf16_f32 v17, v2, v3
  v_cvt_pk_bf16_f32 v18, v4, v5
  v_cvt_pk_bf16_f32 v19, v6, v7
  v_cvt_pk_bf16_f32 v20, v8, v9
  v_cvt_pk_bf16_f32 v21, v10, v11
  v_cvt_pk_bf16_f32 v22, v12, v13
  v_cvt_pk_bf16_f32 v23, v14, v15
  v_lshlrev_b32 v0, 16, v16
  v_and_b32 v1, 0xffff0000, v16
  v_lshlrev_b32 v2, 16, v17
  v_and_b32 v3, 0xffff0000, v17
  v_lshlrev_b32 v4, 16, v18
  v_and_b32 v5, 0xffff0000, v18
  v_lshlrev_b32 v6, 16, v19
  v_and_b32 v7, 0xffff0000, v19
  v_lshlrev_b32 v8, 16, v20
  v_and_b32 v9, 0xffff0000, v20
  v_lshlrev_b32 v10, 16, v21
  v_and_b32 v11, 0xffff0000, v21
  v_lshlrev_b32 v12, 16, v22
  v_and_b32 v13, 0xffff0000, v22
  v_lshlrev_b32 v14, 16, v23
  v_and_b32 v15, 0xffff0000, v23
  v_lshlrev_b32 v32, 16, v128
  v_and_b32 v33, 0xffff0000, v128
  v_lshlrev_b32 v34, 16, v129
  v_and_b32 v35, 0xffff0000, v129
  v_lshlrev_b32 v36, 16, v130
  v_and_b32 v37, 0xffff0000, v130
  v_lshlrev_b32 v38, 16, v131
  v_and_b32 v39, 0xffff0000, v131
  v_lshlrev_b32 v40, 16, v132
  v_and_b32 v41, 0xffff0000, v132
  v_lshlrev_b32 v42, 16, v133
  v_and_b32 v43, 0xffff0000, v133
  v_lshlrev_b32 v44, 16, v134
  v_and_b32 v45, 0xffff0000, v134
  v_lshlrev_b32 v46, 16, v135
  v_and_b32 v47, 0xffff0000, v135
  v_add_f32 v0, v0, v32
  v_add_f32 v1, v1, v33
  v_add_f32 v2, v2, v34
  v_add_f32 v3, v3, v35
  v_add_f32 v4, v4, v36
  v_add_f32 v5, v5, v37
  v_add_f32 v6, v6, v38
  v_add_f32 v7, v7, v39
  v_add_f32 v8, v8, v40
  v_add_f32 v9, v9, v41
  v_add_f32 v10, v10, v42
  v_add_f32 v11, v11, v43
  v_add_f32 v12, v12, v44
  v_add_f32 v13, v13, v45
  v_add_f32 v14, v14, v46
  v_add_f32 v15, v15, v47
  v_cvt_pk_bf16_f32 v16, v0, v1
  v_cvt_pk_bf16_f32 v17, v2, v3
  v_cvt_pk_bf16_f32 v18, v4, v5
  v_cvt_pk_bf16_f32 v19, v6, v7
  v_cvt_pk_bf16_f32 v20, v8, v9
  v_cvt_pk_bf16_f32 v21, v10, v11
  v_cvt_pk_bf16_f32 v22, v12, v13
  v_cvt_pk_bf16_f32 v23, v14, v15
  v_lshlrev_b32 v0, 16, v16
  v_and_b32 v1, 0xffff0000, v16
  v_lshlrev_b32 v2, 16, v17
  v_and_b32 v3, 0xffff0000, v17
  v_lshlrev_b32 v4, 16, v18
  v_and_b32 v5, 0xffff0000, v18
  v_lshlrev_b32 v6, 16, v19
  v_and_b32 v7, 0xffff0000, v19
  v_lshlrev_b32 v8, 16, v20
  v_and_b32 v9, 0xffff0000, v20
  v_lshlrev_b32 v10, 16, v21
  v_and_b32 v11, 0xffff0000, v21
  v_lshlrev_b32 v12, 16, v22
  v_and_b32 v13, 0xffff0000, v22
  v_lshlrev_b32 v14, 16, v23
  v_and_b32 v15, 0xffff0000, v23
  v_mul_f32 v32, v0, v112
  v_mul_f32 v33, v1, v113
  v_mul_f32 v34, v2, v114
  v_mul_f32 v35, v3, v115
  v_mul_f32 v36, v4, v116
  v_mul_f32 v37, v5, v117
  v_mul_f32 v38, v6, v118
  v_mul_f32 v39, v7, v119
  v_mul_f32 v40, v8, v120
  v_mul_f32 v41, v9, v121
  v_mul_f32 v42, v10, v122
  v_mul_f32 v43, v11, v123
  v_mul_f32 v44, v12, v124
  v_mul_f32 v45, v13, v125
  v_mul_f32 v46, v14, v126
  v_mul_f32 v47, v15, v127
  v_cvt_pk_bf16_f32 v24, v32, v33
  v_cvt_pk_bf16_f32 v25, v34, v35
  v_cvt_pk_bf16_f32 v26, v36, v37
  v_cvt_pk_bf16_f32 v27, v38, v39
  v_cvt_pk_bf16_f32 v28, v40, v41
  v_cvt_pk_bf16_f32 v29, v42, v43
  v_cvt_pk_bf16_f32 v30, v44, v45
  v_cvt_pk_bf16_f32 v31, v46, v47
  buffer_store_dwordx4 v[24:27], v243, s[36:39], s56 offen offset:0 sc1
  buffer_store_dwordx4 v[28:31], v243, s[36:39], s56 offen offset:1024 sc1
  v_add_f32 v48, v0, v1
  v_mul_f32 v49, v0, v0
  v_add_f32 v50, v2, v3
  v_mul_f32 v51, v2, v2
  v_fmac_f32 v49, v1, v1
  v_fmac_f32 v51, v3, v3
  v_add_f32 v48, v48, v4
  v_fmac_f32 v49, v4, v4
  v_add_f32 v50, v50, v5
  v_fmac_f32 v51, v5, v5
  v_add_f32 v48, v48, v6
  v_fmac_f32 v49, v6, v6
  v_add_f32 v50, v50, v7
  v_fmac_f32 v51, v7, v7
  v_add_f32 v48, v48, v8
  v_fmac_f32 v49, v8, v8
  v_add_f32 v50, v50, v9
  v_fmac_f32 v51, v9, v9
  v_add_f32 v48, v48, v10
  v_fmac_f32 v49, v10, v10
  v_add_f32 v50, v50, v11
  v_fmac_f32 v51, v11, v11
  v_add_f32 v48, v48, v12
  v_fmac_f32 v49, v12, v12
  v_add_f32 v50, v50, v13
  v_fmac_f32 v51, v13, v13
  v_add_f32 v48, v48, v14
  v_fmac_f32 v49, v14, v14
  v_add_f32 v50, v50, v15
  v_fmac_f32 v51, v15, v15
  v_add_f32 v48, v48, v50
  v_add_f32 v49, v49, v51
  v_mov_b32 v50, v48
  v_mov_b32 v51, v49
  s_nop 0
  v_permlane32_swap_b32 v48, v50
  v_permlane32_swap_b32 v49, v51
  s_nop 0
  v_add_f32 v48, v48, v50
  v_add_f32 v49, v49, v51
  v_mov_b32 v50, v48
  v_mov_b32 v51, v49
  s_nop 0
  v_permlane16_swap_b32 v48, v50
  v_permlane16_swap_b32 v49, v51
  s_nop 0
  v_add_f32 v48, v48, v50
  v_add_f32 v49, v49, v51
  v_lshlrev_b32 v50, 3, v245
  s_lshl_b32 s57, s70, 14
  s_lshl_b32 s59, s52, 3
  s_add_u32 s57, s57, s59
  buffer_store_dwordx2 v[48:49], v50, s[40:43], s57 offen sc1
  v_accvgpr_write_b32 a120, v16
  v_accvgpr_write_b32 a121, v17
  v_accvgpr_write_b32 a122, v18
  v_accvgpr_write_b32 a123, v19
  v_accvgpr_write_b32 a124, v20
  v_accvgpr_write_b32 a125, v21
  v_accvgpr_write_b32 a126, v22
  v_accvgpr_write_b32 a127, v23
  s_cmp_ge_u32 s68, 14
  s_cselect_b32 s76, 1, 0
  s_mul_i32 s77, s76, 14
  s_sub_u32 s77, s68, s77
  s_and_b32 s44, s2, 7
  s_lshl_b32 s44, s44, 1
  s_add_u32 s76, s76, s44
  v_mbcnt_lo_u32_b32 v244, -1, 0
  v_mbcnt_hi_u32_b32 v244, -1, v244
  v_and_b32 v247, 15, v244
  s_mul_i32 s45, s14, 28672
  v_lshrrev_b32 v245, 4, v244
  v_lshlrev_b32 v246, 1, v245
  v_xor_b32 v246, v246, v247
  v_lshlrev_b32 v246, 4, v246
  v_mul_u32_u24 v245, 3584, v245
  v_add3_u32 v248, v245, v246, s45
  v_lshrrev_b32 v245, 4, v244
  v_add_u32 v245, 4, v245
  v_lshlrev_b32 v246, 1, v245
  v_xor_b32 v246, v246, v247
  v_lshlrev_b32 v246, 4, v246
  v_mul_u32_u24 v245, 3584, v245
  v_add3_u32 v249, v245, v246, s45
  v_subrev_u32 v249, 1024, v249
  s_lshl_b32 s46, s77, 8
  s_lshl_b32 s48, s14, 11
  s_mov_b32 s24, s62
  s_mov_b32 s25, s63
  s_add_u32 s24, s24, s46
  s_addc_u32 s25, s25, 0
  s_and_b32 s25, s25, 0xffff
  s_mov_b32 s26, 0x0
  s_mov_b32 s27, 0x20000
  s_sub_u32 s26, 1605632, s46
  s_add_u32 m0, s48, 0
  s_mov_b32 s50, 0
  buffer_load_dwordx4 v248, s[24:27], s50 offen offset:0 lds
  buffer_load_dwordx4 v249, s[24:27], s50 offen offset:1024 lds
  s_add_u32 m0, s48, 8192
  s_mov_b32 s50, 114688
  buffer_load_dwordx4 v248, s[24:27], s50 offen offset:0 lds
  buffer_load_dwordx4 v249, s[24:27], s50 offen offset:1024 lds
  s_add_u32 m0, s48, 16384
  s_mov_b32 s50, 229376
  buffer_load_dwordx4 v248, s[24:27], s50 offen offset:0 lds
  buffer_load_dwordx4 v249, s[24:27], s50 offen offset:1024 lds
  s_add_u32 m0, s48, 24576
  s_mov_b32 s50, 344064
  buffer_load_dwordx4 v248, s[24:27], s50 offen offset:0 lds
  buffer_load_dwordx4 v249, s[24:27], s50 offen offset:1024 lds
  s_waitcnt vmcnt(8)
  s_barrier
  s_lshr_b32 s44, s69, 1
  s_lshl_b32 s44, s44, 7
  s_and_b32 s45, s69, 1
  s_mul_i32 s45, s45, 7
  s_add_u32 s45, s45, s70
  s_lshl_b32 s45, s45, 2
  s_add_u32 s44, s44, s45
  s_add_u32 s44, s44, 2048
  s_cmp_lg_u32 s14, 0
  s_cbranch_scc1 K2_b_nf
  v_mov_b32 v8, 0
  v_mov_b32 v9, s75
  s_mov_b64 exec, 1
  buffer_store_dword v9, v8, s[32:35], s44 offen sc1
  s_mov_b64 exec, -1
K2_b_nf:
  s_add_u32 m0, s48, 32768
  s_mov_b32 s50, 458752
  buffer_load_dwordx4 v248, s[24:27], s50 offen offset:0 lds
  buffer_load_dwordx4 v249, s[24:27], s50 offen offset:1024 lds
  s_add_u32 m0, s48, 40960
  s_mov_b32 s50, 573440
  buffer_load_dwordx4 v248, s[24:27], s50 offen offset:0 lds
  buffer_load_dwordx4 v249, s[24:27], s50 offen offset:1024 lds
  s_add_u32 m0, s48, 49152
  s_mov_b32 s50, 688128
  buffer_load_dwordx4 v248, s[24:27], s50 offen offset:0 lds
  buffer_load_dwordx4 v249, s[24:27], s50 offen offset:1024 lds
  s_add_u32 m0, s48, 57344
  s_mov_b32 s50, 802816
  buffer_load_dwordx4 v248, s[24:27], s50 offen offset:0 lds
  buffer_load_dwordx4 v249, s[24:27], s50 offen offset:1024 lds
  s_add_u32 m0, s48, 65536
  s_mov_b32 s50, 917504
  buffer_load_dwordx4 v248, s[24:27], s50 offen offset:0 lds
  buffer_load_dwordx4 v249, s[24:27], s50 offen offset:1024 lds
  s_add_u32 m0, s48, 73728
  s_mov_b32 s50, 1032192
  buffer_load_dwordx4 v248, s[24:27], s50 offen offset:0 lds
  buffer_load_dwordx4 v249, s[24:27], s50 offen offset:1024 lds
  s_add_u32 m0, s48, 81920
  s_mov_b32 s50, 1146880
  buffer_load_dwordx4 v248, s[24:27], s50 offen offset:0 lds
  buffer_load_dwordx4 v249, s[24:27], s50 offen offset:1024 lds
  s_add_u32 m0, s48, 90112
  s_mov_b32 s50, 1261568
  buffer_load_dwordx4 v248, s[24:27], s50 offen offset:0 lds
  buffer_load_dwordx4 v249, s[24:27], s50 offen offset:1024 lds
  s_add_u32 m0, s48, 98304
  s_mov_b32 s50, 1376256
  buffer_load_dwordx4 v248, s[24:27], s50 offen offset:0 lds
  buffer_load_dwordx4 v249, s[24:27], s50 offen offset:1024 lds
  s_add_u32 m0, s48, 106496
  s_mov_b32 s50, 1490944
  buffer_load_dwordx4 v248, s[24:27], s50 offen offset:0 lds
  buffer_load_dwordx4 v249, s[24:27], s50 offen offset:1024 lds
  v_mbcnt_lo_u32_b32 v1, -1, 0
  v_mbcnt_hi_u32_b32 v1, -1, v1
  v_bfe_u32 v2, v1, 2, 4
  v_and_b32 v3, 7, v2
  v_lshlrev_b32 v2, 8, v2
  v_and_b32 v4, 3, v1
  v_lshl_add_u32 v2, v4, 3, v2
  v_xor_b32 v4, 0, v3
  v_lshl_add_u32 v240, v4, 5, v2
  v_xor_b32 v4, 1, v3
  v_lshl_add_u32 v241, v4, 5, v2
  v_xor_b32 v4, 2, v3
  v_lshl_add_u32 v242, v4, 5, v2
  v_xor_b32 v4, 3, v3
  v_lshl_add_u32 v243, v4, 5, v2
  v_xor_b32 v4, 4, v3
  v_lshl_add_u32 v244, v4, 5, v2
  v_xor_b32 v4, 5, v3
  v_lshl_add_u32 v245, v4, 5, v2
  v_xor_b32 v4, 6, v3
  v_lshl_add_u32 v246, v4, 5, v2
  v_xor_b32 v4, 7, v3
  v_lshl_add_u32 v247, v4, 5, v2
  s_mul_i32 s44, s14, 28672
  v_lshlrev_b32 v2, 4, v1
  v_add_u32 v250, s44, v2
  v_add_u32 v251, 14336, v250
  v_lshrrev_b32 v3, 4, v1
  v_lshlrev_b32 v252, 4, v3
  s_lshl_b32 s44, s14, 8
  v_and_b32 v4, 15, v1
  v_lshlrev_b32 v4, 3, v4
  v_add_u32 v253, s44, v4
  s_mul_i32 s44, s14, 114688
  v_add_u32 v254, s44, v2
  v_add_u32 v255, 57344, v254
  s_mul_i32 s45, s76, 114688
  s_add_u32 s28, s10, 0x400000
  s_addc_u32 s29, s11, 0
  s_add_u32 s28, s28, s45
  s_addc_u32 s29, s29, 0
  s_and_b32 s29, s29, 0xffff
  s_mov_b32 s30, 0x1c000
  s_mov_b32 s31, 0x20000
  s_add_u32 s16, s10, 0x4000
  s_addc_u32 s17, s11, 0
  s_and_b32 s17, s17, 0xffff
  s_mov_b32 s18, 0x4000
  s_mov_b32 s19, 0x20000
  s_add_u32 s20, s10, 0x8000
  s_addc_u32 s21, s11, 0
  s_and_b32 s21, s21, 0xffff
  s_mov_b32 s22, 0x20000
  s_mov_b32 s23, 0x20000
  s_mul_i32 s52, s76, 458752
  s_lshl_b32 s53, s77, 12
  s_add_u32 s52, s52, s53
  s_add_u32 s36, s10, 0x600000
  s_addc_u32 s37, s11, 0
  s_add_u32 s36, s36, s52
  s_addc_u32 s37, s37, 0
  s_and_b32 s37, s37, 0xffff
  s_mov_b32 s38, 0x0
  s_mov_b32 s39, 0x20000
  s_sub_u32 s38, 7340032, s52
  s_lshl_b32 s44, s77, 9
  s_add_u32 s45, s44, 0x2000
  s_lshl_b32 s56, s76, 10
  s_lshl_b32 s46, s76, 7
  s_add_u32 s46, s46, 2048
  s_lshl_b32 s47, s77, 3
  s_add_u32 s47, s47, 6088
  v_mov_b32 v2, s46
  v_mov_b32 v3, s47
  v_cmp_gt_u32 vcc, 14, v1
  s_nop 1
  v_cndmask_b32 v2, v3, v2, vcc
  v_lshl_add_u32 v2, v1, 2, v2
  s_mov_b32 s74, 0x8000
  s_cmp_lg_u32 s14, 0
  s_cbranch_scc1 K2_b_pd
K2_b_pl:
  buffer_load_dword v3, v2, s[32:35], 0 offen sc1
  s_waitcnt vmcnt(0)
  v_cmp_eq_u32 vcc, s75, v3
  s_nop 1
  s_and_b32 s73, vcc_lo, 0xffff
  s_cmp_eq_u32 s73, 0xffff
  s_cbranch_scc1 K2_b_pd
  s_sleep 2
  s_sub_u32 s74, s74, 1
  s_cmp_lg_u32 s74, 0
  s_cbranch_scc1 K2_b_pl
K2_b_pd:
  s_waitcnt vmcnt(0)
  s_barrier
  s_mov_b32 s51, 0
  buffer_load_dwordx4 v[64:67], v250, s[28:31], s51 offen sc1
  buffer_load_dwordx4 v[68:71], v251, s[28:31], s51 offen sc1
  s_mov_b32 s51, 1024
  buffer_load_dwordx4 v[72:75], v250, s[28:31], s51 offen sc1
  buffer_load_dwordx4 v[76:79], v251, s[28:31], s51 offen sc1
  s_mov_b32 s51, 2048
  buffer_load_dwordx4 v[80:83], v250, s[28:31], s51 offen sc1
  buffer_load_dwordx4 v[84:87], v251, s[28:31], s51 offen sc1
  s_mov_b32 s51, 3072
  buffer_load_dwordx4 v[88:91], v250, s[28:31], s51 offen sc1
  buffer_load_dwordx4 v[92:95], v251, s[28:31], s51 offen sc1
  s_mov_b32 s51, 4096
  buffer_load_dwordx4 v[96:99], v250, s[28:31], s51 offen sc1
  buffer_load_dwordx4 v[100:103], v251, s[28:31], s51 offen sc1
  ds_read_b64_tr_b16 a[0:1], v240 offset:0
  ds_read_b64_tr_b16 a[2:3], v240 offset:4096
  ds_read_b64_tr_b16 a[4:5], v241 offset:0
  ds_read_b64_tr_b16 a[6:7], v241 offset:4096
  ds_read_b64_tr_b16 a[8:9], v242 offset:0
  ds_read_b64_tr_b16 a[10:11], v242 offset:4096
  ds_read_b64_tr_b16 a[12:13], v243 offset:0
  ds_read_b64_tr_b16 a[14:15], v243 offset:4096
  ds_read_b64_tr_b16 a[16:17], v244 offset:0
  ds_read_b64_tr_b16 a[18:19], v244 offset:4096
  ds_read_b64_tr_b16 a[20:21], v245 offset:0
  ds_read_b64_tr_b16 a[22:23], v245 offset:4096
  ds_read_b64_tr_b16 a[24:25], v246 offset:0
  ds_read_b64_tr_b16 a[26:27], v246 offset:4096
  ds_read_b64_tr_b16 a[28:29], v247 offset:0
  ds_read_b64_tr_b16 a[30:31], v247 offset:4096
  s_waitcnt vmcnt(8) lgkmcnt(0)
  v_mfma_f32_16x16x32_bf16 v[0:3], a[0:3], v[64:67], 0
  v_mfma_f32_16x16x32_bf16 v[4:7], a[0:3], v[68:71], 0
  v_mfma_f32_16x16x32_bf16 v[8:11], a[4:7], v[64:67], 0
  ds_read_b64_tr_b16 a[0:1], v240 offset:8192
  v_mfma_f32_16x16x32_bf16 v[12:15], a[4:7], v[68:71], 0
  ds_read_b64_tr_b16 a[2:3], v240 offset:12288
  s_mov_b32 s51, 5120
  buffer_load_dwordx4 v[104:107], v250, s[28:31], s51 offen sc1
  v_mfma_f32_16x16x32_bf16 v[16:19], a[8:11], v[64:67], 0
  ds_read_b64_tr_b16 a[4:5], v241 offset:8192
  v_mfma_f32_16x16x32_bf16 v[20:23], a[8:11], v[68:71], 0
  s_waitcnt lgkmcnt(4)
  ds_read_b64_tr_b16 a[6:7], v241 offset:12288
  v_mfma_f32_16x16x32_bf16 v[24:27], a[12:15], v[64:67], 0
  ds_read_b64_tr_b16 a[8:9], v242 offset:8192
  v_mfma_f32_16x16x32_bf16 v[28:31], a[12:15], v[68:71], 0
  ds_read_b64_tr_b16 a[10:11], v242 offset:12288
  buffer_load_dwordx4 v[108:111], v251, s[28:31], s51 offen sc1
  v_mfma_f32_16x16x32_bf16 v[32:35], a[16:19], v[64:67], 0
  ds_read_b64_tr_b16 a[12:13], v243 offset:8192
  v_mfma_f32_16x16x32_bf16 v[36:39], a[16:19], v[68:71], 0
  ds_read_b64_tr_b16 a[14:15], v243 offset:12288
  v_mfma_f32_16x16x32_bf16 v[40:43], a[20:23], v[64:67], 0
  ds_read_b64_tr_b16 a[16:17], v244 offset:8192
  v_mfma_f32_16x16x32_bf16 v[44:47], a[20:23], v[68:71], 0
  ds_read_b64_tr_b16 a[18:19], v244 offset:12288
  s_add_u32 s57, s56, 0
  buffer_load_dwordx2 a[32:33], v253, s[20:23], s57 offen sc1
  v_mfma_f32_16x16x32_bf16 v[48:51], a[24:27], v[64:67], 0
  ds_read_b64_tr_b16 a[20:21], v245 offset:8192
  v_mfma_f32_16x16x32_bf16 v[52:55], a[24:27], v[68:71], 0
  s_waitcnt lgkmcnt(4)
  ds_read_b64_tr_b16 a[22:23], v245 offset:12288
  v_mfma_f32_16x16x32_bf16 v[56:59], a[28:31], v[64:67], 0
  ds_read_b64_tr_b16 a[24:25], v246 offset:8192
  s_add_u32 s57, s56, 128
  buffer_load_dwordx2 a[46:47], v253, s[20:23], s57 offen sc1
  v_mfma_f32_16x16x32_bf16 v[60:63], a[28:31], v[68:71], 0
  s_waitcnt vmcnt(10)
  ds_read_b64_tr_b16 a[26:27], v246 offset:12288
  v_mfma_f32_16x16x32_bf16 v[0:3], a[0:3], v[72:75], v[0:3]
  ds_read_b64_tr_b16 a[28:29], v247 offset:8192
  v_mfma_f32_16x16x32_bf16 v[4:7], a[0:3], v[76:79], v[4:7]
  ds_read_b64_tr_b16 a[30:31], v247 offset:12288
  v_mfma_f32_16x16x32_bf16 v[8:11], a[4:7], v[72:75], v[8:11]
  ds_read_b64_tr_b16 a[0:1], v240 offset:16384
  v_mfma_f32_16x16x32_bf16 v[12:15], a[4:7], v[76:79], v[12:15]
  ds_read_b64_tr_b16 a[2:3], v240 offset:20480
  s_mov_b32 s51, 6144
  buffer_load_dwordx4 v[112:115], v250, s[28:31], s51 offen sc1
  v_mfma_f32_16x16x32_bf16 v[16:19], a[8:11], v[72:75], v[16:19]
  ds_read_b64_tr_b16 a[4:5], v241 offset:16384
  v_mfma_f32_16x16x32_bf16 v[20:23], a[8:11], v[76:79], v[20:23]
  s_waitcnt lgkmcnt(4)
  ds_read_b64_tr_b16 a[6:7], v241 offset:20480
  v_mfma_f32_16x16x32_bf16 v[24:27], a[12:15], v[72:75], v[24:27]
  ds_read_b64_tr_b16 a[8:9], v242 offset:16384
  v_mfma_f32_16x16x32_bf16 v[28:31], a[12:15], v[76:79], v[28:31]
  ds_read_b64_tr_b16 a[10:11], v242 offset:20480
  buffer_load_dwordx4 v[116:119], v251, s[28:31], s51 offen sc1
  v_mfma_f32_16x16x32_bf16 v[32:35], a[16:19], v[72:75], v[32:35]
  ds_read_b64_tr_b16 a[12:13], v243 offset:16384
  v_mfma_f32_16x16x32_bf16 v[36:39], a[16:19], v[76:79], v[36:39]
  ds_read_b64_tr_b16 a[14:15], v243 offset:20480
  v_mfma_f32_16x16x32_bf16 v[40:43], a[20:23], v[72:75], v[40:43]
  ds_read_b64_tr_b16 a[16:17], v244 offset:16384
  v_mfma_f32_16x16x32_bf16 v[44:47], a[20:23], v[76:79], v[44:47]
  ds_read_b64_tr_b16 a[18:19], v244 offset:20480
  s_add_u32 s57, s56, 16384
  buffer_load_dwordx2 a[34:35], v253, s[20:23], s57 offen sc1
  v_mfma_f32_16x16x32_bf16 v[48:51], a[24:27], v[72:75], v[48:51]
  ds_read_b64_tr_b16 a[20:21], v245 offset:16384
  v_mfma_f32_16x16x32_bf16 v[52:55], a[24:27], v[76:79], v[52:55]
  s_waitcnt lgkmcnt(4)
  ds_read_b64_tr_b16 a[22:23], v245 offset:20480
  v_mfma_f32_16x16x32_bf16 v[56:59], a[28:31], v[72:75], v[56:59]
  ds_read_b64_tr_b16 a[24:25], v246 offset:16384
  s_add_u32 s57, s56, 16512
  buffer_load_dwordx2 a[48:49], v253, s[20:23], s57 offen sc1
  v_mfma_f32_16x16x32_bf16 v[60:63], a[28:31], v[76:79], v[60:63]
  s_waitcnt vmcnt(12)
  ds_read_b64_tr_b16 a[26:27], v246 offset:20480
  v_mfma_f32_16x16x32_bf16 v[0:3], a[0:3], v[80:83], v[0:3]
  ds_read_b64_tr_b16 a[28:29], v247 offset:16384
  v_mfma_f32_16x16x32_bf16 v[4:7], a[0:3], v[84:87], v[4:7]
  ds_read_b64_tr_b16 a[30:31], v247 offset:20480
  v_mfma_f32_16x16x32_bf16 v[8:11], a[4:7], v[80:83], v[8:11]
  ds_read_b64_tr_b16 a[0:1], v240 offset:24576
  v_mfma_f32_16x16x32_bf16 v[12:15], a[4:7], v[84:87], v[12:15]
  ds_read_b64_tr_b16 a[2:3], v240 offset:28672
  s_mov_b32 s51, 7168
  buffer_load_dwordx4 v[120:123], v250, s[28:31], s51 offen sc1
  v_mfma_f32_16x16x32_bf16 v[16:19], a[8:11], v[80:83], v[16:19]
  ds_read_b64_tr_b16 a[4:5], v241 offset:24576
  v_mfma_f32_16x16x32_bf16 v[20:23], a[8:11], v[84:87], v[20:23]
  s_waitcnt lgkmcnt(4)
  ds_read_b64_tr_b16 a[6:7], v241 offset:28672
  v_mfma_f32_16x16x32_bf16 v[24:27], a[12:15], v[80:83], v[24:27]
  ds_read_b64_tr_b16 a[8:9], v242 offset:24576
  v_mfma_f32_16x16x32_bf16 v[28:31], a[12:15], v[84:87], v[28:31]
  ds_read_b64_tr_b16 a[10:11], v242 offset:28672
  buffer_load_dwordx4 v[124:127], v251, s[28:31], s51 offen sc1
  v_mfma_f32_16x16x32_bf16 v[32:35], a[16:19], v[80:83], v[32:35]
  ds_read_b64_tr_b16 a[12:13], v243 offset:24576
  v_mfma_f32_16x16x32_bf16 v[36:39], a[16:19], v[84:87], v[36:39]
  ds_read_b64_tr_b16 a[14:15], v243 offset:28672
  v_mfma_f32_16x16x32_bf16 v[40:43], a[20:23], v[80:83], v[40:43]
  ds_read_b64_tr_b16 a[16:17], v244 offset:24576
  v_mfma_f32_16x16x32_bf16 v[44:47], a[20:23], v[84:87], v[44:47]
  ds_read_b64_tr_b16 a[18:19], v244 offset:28672
  s_add_u32 s57, s56, 32768
  buffer_load_dwordx2 a[36:37], v253, s[20:23], s57 offen sc1
  v_mfma_f32_16x16x32_bf16 v[48:51], a[24:27], v[80:83], v[48:51]
  ds_read_b64_tr_b16 a[20:21], v245 offset:24576
  v_mfma_f32_16x16x32_bf16 v[52:55], a[24:27], v[84:87], v[52:55]
  s_waitcnt lgkmcnt(4)
  ds_read_b64_tr_b16 a[22:23], v245 offset:28672
  v_mfma_f32_16x16x32_bf16 v[56:59], a[28:31], v[80:83], v[56:59]
  ds_read_b64_tr_b16 a[24:25], v246 offset:24576
  s_add_u32 s57, s56, 32896
  buffer_load_dwordx2 a[50:51], v253, s[20:23], s57 offen sc1
  v_mfma_f32_16x16x32_bf16 v[60:63], a[28:31], v[84:87], v[60:63]
  s_waitcnt vmcnt(14)
  ds_read_b64_tr_b16 a[26:27], v246 offset:28672
  v_mfma_f32_16x16x32_bf16 v[0:3], a[0:3], v[88:91], v[0:3]
  ds_read_b64_tr_b16 a[28:29], v247 offset:24576
  v_mfma_f32_16x16x32_bf16 v[4:7], a[0:3], v[92:95], v[4:7]
  ds_read_b64_tr_b16 a[30:31], v247 offset:28672
  v_mfma_f32_16x16x32_bf16 v[8:11], a[4:7], v[88:91], v[8:11]
  ds_read_b64_tr_b16 a[0:1], v240 offset:32768
  v_mfma_f32_16x16x32_bf16 v[12:15], a[4:7], v[92:95], v[12:15]
  ds_read_b64_tr_b16 a[2:3], v240 offset:36864
  s_mov_b32 s51, 8192
  buffer_load_dwordx4 v[128:131], v250, s[28:31], s51 offen sc1
  v_mfma_f32_16x16x32_bf16 v[16:19], a[8:11], v[88:91], v[16:19]
  ds_read_b64_tr_b16 a[4:5], v241 offset:32768
  v_mfma_f32_16x16x32_bf16 v[20:23], a[8:11], v[92:95], v[20:23]
  s_waitcnt lgkmcnt(4)
  ds_read_b64_tr_b16 a[6:7], v241 offset:36864
  v_mfma_f32_16x16x32_bf16 v[24:27], a[12:15], v[88:91], v[24:27]
  ds_read_b64_tr_b16 a[8:9], v242 offset:32768
  v_mfma_f32_16x16x32_bf16 v[28:31], a[12:15], v[92:95], v[28:31]
  ds_read_b64_tr_b16 a[10:11], v242 offset:36864
  buffer_load_dwordx4 v[132:135], v251, s[28:31], s51 offen sc1
  v_mfma_f32_16x16x32_bf16 v[32:35], a[16:19], v[88:91], v[32:35]
  ds_read_b64_tr_b16 a[12:13], v243 offset:32768
  v_mfma_f32_16x16x32_bf16 v[36:39], a[16:19], v[92:95], v[36:39]
  ds_read_b64_tr_b16 a[14:15], v243 offset:36864
  v_mfma_f32_16x16x32_bf16 v[40:43], a[20:23], v[88:91], v[40:43]
  ds_read_b64_tr_b16 a[16:17], v244 offset:32768
  v_mfma_f32_16x16x32_bf16 v[44:47], a[20:23], v[92:95], v[44:47]
  ds_read_b64_tr_b16 a[18:19], v244 offset:36864
  s_add_u32 s57, s56, 49152
  buffer_load_dwordx2 a[38:39], v253, s[20:23], s57 offen sc1
  v_mfma_f32_16x16x32_bf16 v[48:51], a[24:27], v[88:91], v[48:51]
  ds_read_b64_tr_b16 a[20:21], v245 offset:32768
  v_mfma_f32_16x16x32_bf16 v[52:55], a[24:27], v[92:95], v[52:55]
  s_waitcnt lgkmcnt(4)
  ds_read_b64_tr_b16 a[22:23], v245 offset:36864
  v_mfma_f32_16x16x32_bf16 v[56:59], a[28:31], v[88:91], v[56:59]
  ds_read_b64_tr_b16 a[24:25], v246 offset:32768
  s_add_u32 s57, s56, 49280
  buffer_load_dwordx2 a[52:53], v253, s[20:23], s57 offen sc1
  v_mfma_f32_16x16x32_bf16 v[60:63], a[28:31], v[92:95], v[60:63]
  s_waitcnt vmcnt(16)
  ds_read_b64_tr_b16 a[26:27], v246 offset:36864
  v_mfma_f32_16x16x32_bf16 v[0:3], a[0:3], v[96:99], v[0:3]
  ds_read_b64_tr_b16 a[28:29], v247 offset:32768
  v_mfma_f32_16x16x32_bf16 v[4:7], a[0:3], v[100:103], v[4:7]
  ds_read_b64_tr_b16 a[30:31], v247 offset:36864
  v_mfma_f32_16x16x32_bf16 v[8:11], a[4:7], v[96:99], v[8:11]
  ds_read_b64_tr_b16 a[0:1], v240 offset:40960
  v_mfma_f32_16x16x32_bf16 v[12:15], a[4:7], v[100:103], v[12:15]
  ds_read_b64_tr_b16 a[2:3], v240 offset:45056
  s_mov_b32 s51, 9216
  buffer_load_dwordx4 v[136:139], v250, s[28:31], s51 offen sc1
  v_mfma_f32_16x16x32_bf16 v[16:19], a[8:11], v[96:99], v[16:19]
  ds_read_b64_tr_b16 a[4:5], v241 offset:40960
  v_mfma_f32_16x16x32_bf16 v[20:23], a[8:11], v[100:103], v[20:23]
  s_waitcnt lgkmcnt(4)
  ds_read_b64_tr_b16 a[6:7], v241 offset:45056
  v_mfma_f32_16x16x32_bf16 v[24:27], a[12:15], v[96:99], v[24:27]
  ds_read_b64_tr_b16 a[8:9], v242 offset:40960
  v_mfma_f32_16x16x32_bf16 v[28:31], a[12:15], v[100:103], v[28:31]
  ds_read_b64_tr_b16 a[10:11], v242 offset:45056
  buffer_load_dwordx4 v[140:143], v251, s[28:31], s51 offen sc1
  v_mfma_f32_16x16x32_bf16 v[32:35], a[16:19], v[96:99], v[32:35]
  ds_read_b64_tr_b16 a[12:13], v243 offset:40960
  v_mfma_f32_16x16x32_bf16 v[36:39], a[16:19], v[100:103], v[36:39]
  ds_read_b64_tr_b16 a[14:15], v243 offset:45056
  v_mfma_f32_16x16x32_bf16 v[40:43], a[20:23], v[96:99], v[40:43]
  ds_read_b64_tr_b16 a[16:17], v244 offset:40960
  v_mfma_f32_16x16x32_bf16 v[44:47], a[20:23], v[100:103], v[44:47]
  ds_read_b64_tr_b16 a[18:19], v244 offset:45056
  s_add_u32 s57, s56, 65536
  buffer_load_dwordx2 a[40:41], v253, s[20:23], s57 offen sc1
  v_mfma_f32_16x16x32_bf16 v[48:51], a[24:27], v[96:99], v[48:51]
  ds_read_b64_tr_b16 a[20:21], v245 offset:40960
  v_mfma_f32_16x16x32_bf16 v[52:55], a[24:27], v[100:103], v[52:55]
  s_waitcnt lgkmcnt(4)
  ds_read_b64_tr_b16 a[22:23], v245 offset:45056
  v_mfma_f32_16x16x32_bf16 v[56:59], a[28:31], v[96:99], v[56:59]
  ds_read_b64_tr_b16 a[24:25], v246 offset:40960
  s_add_u32 s57, s56, 65664
  buffer_load_dwordx2 a[54:55], v253, s[20:23], s57 offen sc1
  v_mfma_f32_16x16x32_bf16 v[60:63], a[28:31], v[100:103], v[60:63]
  s_waitcnt vmcnt(18)
  ds_read_b64_tr_b16 a[26:27], v246 offset:45056
  v_mfma_f32_16x16x32_bf16 v[0:3], a[0:3], v[104:107], v[0:3]
  ds_read_b64_tr_b16 a[28:29], v247 offset:40960
  v_mfma_f32_16x16x32_bf16 v[4:7], a[0:3], v[108:111], v[4:7]
  ds_read_b64_tr_b16 a[30:31], v247 offset:45056
  v_mfma_f32_16x16x32_bf16 v[8:11], a[4:7], v[104:107], v[8:11]
  ds_read_b64_tr_b16 a[0:1], v240 offset:49152
  v_mfma_f32_16x16x32_bf16 v[12:15], a[4:7], v[108:111], v[12:15]
  ds_read_b64_tr_b16 a[2:3], v240 offset:53248
  s_mov_b32 s51, 10240
  buffer_load_dwordx4 v[144:147], v250, s[28:31], s51 offen sc1
  v_mfma_f32_16x16x32_bf16 v[16:19], a[8:11], v[104:107], v[16:19]
  ds_read_b64_tr_b16 a[4:5], v241 offset:49152
  v_mfma_f32_16x16x32_bf16 v[20:23], a[8:11], v[108:111], v[20:23]
  s_waitcnt lgkmcnt(4)
  ds_read_b64_tr_b16 a[6:7], v241 offset:53248
  v_mfma_f32_16x16x32_bf16 v[24:27], a[12:15], v[104:107], v[24:27]
  ds_read_b64_tr_b16 a[8:9], v242 offset:49152
  v_mfma_f32_16x16x32_bf16 v[28:31], a[12:15], v[108:111], v[28:31]
  ds_read_b64_tr_b16 a[10:11], v242 offset:53248
  buffer_load_dwordx4 v[148:151], v251, s[28:31], s51 offen sc1
  v_mfma_f32_16x16x32_bf16 v[32:35], a[16:19], v[104:107], v[32:35]
  ds_read_b64_tr_b16 a[12:13], v243 offset:49152
  v_mfma_f32_16x16x32_bf16 v[36:39], a[16:19], v[108:111], v[36:39]
  ds_read_b64_tr_b16 a[14:15], v243 offset:53248
  v_mfma_f32_16x16x32_bf16 v[40:43], a[20:23], v[104:107], v[40:43]
  ds_read_b64_tr_b16 a[16:17], v244 offset:49152
  v_mfma_f32_16x16x32_bf16 v[44:47], a[20:23], v[108:111], v[44:47]
  ds_read_b64_tr_b16 a[18:19], v244 offset:53248
  s_add_u32 s57, s56, 81920
  buffer_load_dwordx2 a[42:43], v253, s[20:23], s57 offen sc1
  v_mfma_f32_16x16x32_bf16 v[48:51], a[24:27], v[104:107], v[48:51]
  ds_read_b64_tr_b16 a[20:21], v245 offset:49152
  v_mfma_f32_16x16x32_bf16 v[52:55], a[24:27], v[108:111], v[52:55]
  s_waitcnt lgkmcnt(4)
  ds_read_b64_tr_b16 a[22:23], v245 offset:53248
  v_mfma_f32_16x16x32_bf16 v[56:59], a[28:31], v[104:107], v[56:59]
  ds_read_b64_tr_b16 a[24:25], v246 offset:49152
  s_add_u32 s57, s56, 82048
  buffer_load_dwordx2 a[56:57], v253, s[20:23], s57 offen sc1
  v_mfma_f32_16x16x32_bf16 v[60:63], a[28:31], v[108:111], v[60:63]
  s_waitcnt vmcnt(18)
  ds_read_b64_tr_b16 a[26:27], v246 offset:53248
  v_mfma_f32_16x16x32_bf16 v[0:3], a[0:3], v[112:115], v[0:3]
  ds_read_b64_tr_b16 a[28:29], v247 offset:49152
  v_mfma_f32_16x16x32_bf16 v[4:7], a[0:3], v[116:119], v[4:7]
  ds_read_b64_tr_b16 a[30:31], v247 offset:53248
  v_mfma_f32_16x16x32_bf16 v[8:11], a[4:7], v[112:115], v[8:11]
  ds_read_b64_tr_b16 a[0:1], v240 offset:57344
  v_mfma_f32_16x16x32_bf16 v[12:15], a[4:7], v[116:119], v[12:15]
  ds_read_b64_tr_b16 a[2:3], v240 offset:61440
  s_mov_b32 s51, 11264
  buffer_load_dwordx4 v[152:155], v250, s[28:31], s51 offen sc1
  v_mfma_f32_16x16x32_bf16 v[16:19], a[8:11], v[112:115], v[16:19]
  ds_read_b64_tr_b16 a[4:5], v241 offset:57344
  v_mfma_f32_16x16x32_bf16 v[20:23], a[8:11], v[116:119], v[20:23]
  s_waitcnt lgkmcnt(4)
  ds_read_b64_tr_b16 a[6:7], v241 offset:61440
  v_mfma_f32_16x16x32_bf16 v[24:27], a[12:15], v[112:115], v[24:27]
  ds_read_b64_tr_b16 a[8:9], v242 offset:57344
  v_mfma_f32_16x16x32_bf16 v[28:31], a[12:15], v[116:119], v[28:31]
  ds_read_b64_tr_b16 a[10:11], v242 offset:61440
  buffer_load_dwordx4 v[156:159], v251, s[28:31], s51 offen sc1
  v_mfma_f32_16x16x32_bf16 v[32:35], a[16:19], v[112:115], v[32:35]
  ds_read_b64_tr_b16 a[12:13], v243 offset:57344
  v_mfma_f32_16x16x32_bf16 v[36:39], a[16:19], v[116:119], v[36:39]
  ds_read_b64_tr_b16 a[14:15], v243 offset:61440
  v_mfma_f32_16x16x32_bf16 v[40:43], a[20:23], v[112:115], v[40:43]
  ds_read_b64_tr_b16 a[16:17], v244 offset:57344
  v_mfma_f32_16x16x32_bf16 v[44:47], a[20:23], v[116:119], v[44:47]
  ds_read_b64_tr_b16 a[18:19], v244 offset:61440
  s_add_u32 s57, s56, 98304
  buffer_load_dwordx2 a[44:45], v253, s[20:23], s57 offen sc1
  v_mfma_f32_16x16x32_bf16 v[48:51], a[24:27], v[112:115], v[48:51]
  ds_read_b64_tr_b16 a[20:21], v245 offset:57344
  v_mfma_f32_16x16x32_bf16 v[52:55], a[24:27], v[116:119], v[52:55]
  s_waitcnt lgkmcnt(4)
  ds_read_b64_tr_b16 a[22:23], v245 offset:61440
  v_mfma_f32_16x16x32_bf16 v[56:59], a[28:31], v[112:115], v[56:59]
  ds_read_b64_tr_b16 a[24:25], v246 offset:57344
  s_add_u32 s57, s56, 98432
  buffer_load_dwordx2 a[58:59], v253, s[20:23], s57 offen sc1
  v_mfma_f32_16x16x32_bf16 v[60:63], a[28:31], v[116:119], v[60:63]
  s_waitcnt vmcnt(18)
  ds_read_b64_tr_b16 a[26:27], v246 offset:61440
  v_mfma_f32_16x16x32_bf16 v[0:3], a[0:3], v[120:123], v[0:3]
  ds_read_b64_tr_b16 a[28:29], v247 offset:57344
  v_mfma_f32_16x16x32_bf16 v[4:7], a[0:3], v[124:127], v[4:7]
  ds_read_b64_tr_b16 a[30:31], v247 offset:61440
  v_add_u32 v240, 65536, v240
  v_add_u32 v241, 65536, v241
  v_add_u32 v242, 65536, v242
  v_add_u32 v243, 65536, v243
  v_add_u32 v244, 65536, v244
  v_add_u32 v245, 65536, v245
  v_add_u32 v246, 65536, v246
  v_mfma_f32_16x16x32_bf16 v[8:11], a[4:7], v[120:123], v[8:11]
  ds_read_b64_tr_b16 a[0:1], v240 offset:0
  v_mfma_f32_16x16x32_bf16 v[12:15], a[4:7], v[124:127], v[12:15]
  ds_read_b64_tr_b16 a[2:3], v240 offset:4096
  s_mov_b32 s51, 12288
  buffer_load_dwordx4 v[160:163], v250, s[28:31], s51 offen sc1
  v_mfma_f32_16x16x32_bf16 v[16:19], a[8:11], v[120:123], v[16:19]
  ds_read_b64_tr_b16 a[4:5], v241 offset:0
  v_mfma_f32_16x16x32_bf16 v[20:23], a[8:11], v[124:127], v[20:23]
  s_waitcnt lgkmcnt(4)
  ds_read_b64_tr_b16 a[6:7], v241 offset:4096
  v_mfma_f32_16x16x32_bf16 v[24:27], a[12:15], v[120:123], v[24:27]
  ds_read_b64_tr_b16 a[8:9], v242 offset:0
  v_mfma_f32_16x16x32_bf16 v[28:31], a[12:15], v[124:127], v[28:31]
  ds_read_b64_tr_b16 a[10:11], v242 offset:4096
  buffer_load_dwordx4 v[164:167], v251, s[28:31], s51 offen sc1
  v_mfma_f32_16x16x32_bf16 v[32:35], a[16:19], v[120:123], v[32:35]
  ds_read_b64_tr_b16 a[12:13], v243 offset:0
  v_mfma_f32_16x16x32_bf16 v[36:39], a[16:19], v[124:127], v[36:39]
  ds_read_b64_tr_b16 a[14:15], v243 offset:4096
  v_mfma_f32_16x16x32_bf16 v[40:43], a[20:23], v[120:123], v[40:43]
  ds_read_b64_tr_b16 a[16:17], v244 offset:0
  v_mfma_f32_16x16x32_bf16 v[44:47], a[20:23], v[124:127], v[44:47]
  ds_read_b64_tr_b16 a[18:19], v244 offset:4096
  buffer_load_dwordx4 v[176:179], v252, s[16:19], s44 offen offset:0 sc1
  v_mfma_f32_16x16x32_bf16 v[48:51], a[24:27], v[120:123], v[48:51]
  ds_read_b64_tr_b16 a[20:21], v245 offset:0
  v_mfma_f32_16x16x32_bf16 v[52:55], a[24:27], v[124:127], v[52:55]
  s_waitcnt lgkmcnt(4)
  ds_read_b64_tr_b16 a[22:23], v245 offset:4096
  v_mfma_f32_16x16x32_bf16 v[56:59], a[28:31], v[120:123], v[56:59]
  ds_read_b64_tr_b16 a[24:25], v246 offset:0
  buffer_load_dwordx4 v[208:211], v252, s[16:19], s45 offen offset:0 sc1
  v_mfma_f32_16x16x32_bf16 v[60:63], a[28:31], v[124:127], v[60:63]
  s_waitcnt vmcnt(18)
  ds_read_b64_tr_b16 a[26:27], v246 offset:4096
  v_add_u32 v247, 65536, v247
  v_mfma_f32_16x16x32_bf16 v[0:3], a[0:3], v[128:131], v[0:3]
  ds_read_b64_tr_b16 a[28:29], v247 offset:0
  v_mfma_f32_16x16x32_bf16 v[4:7], a[0:3], v[132:135], v[4:7]
  ds_read_b64_tr_b16 a[30:31], v247 offset:4096
  v_mfma_f32_16x16x32_bf16 v[8:11], a[4:7], v[128:131], v[8:11]
  ds_read_b64_tr_b16 a[0:1], v240 offset:8192
  v_mfma_f32_16x16x32_bf16 v[12:15], a[4:7], v[132:135], v[12:15]
  ds_read_b64_tr_b16 a[2:3], v240 offset:12288
  s_mov_b32 s51, 13312
  buffer_load_dwordx4 v[168:171], v250, s[28:31], s51 offen sc1
  v_mfma_f32_16x16x32_bf16 v[16:19], a[8:11], v[128:131], v[16:19]
  ds_read_b64_tr_b16 a[4:5], v241 offset:8192
  v_mfma_f32_16x16x32_bf16 v[20:23], a[8:11], v[132:135], v[20:23]
  s_waitcnt lgkmcnt(4)
  ds_read_b64_tr_b16 a[6:7], v241 offset:12288
  v_mfma_f32_16x16x32_bf16 v[24:27], a[12:15], v[128:131], v[24:27]
  ds_read_b64_tr_b16 a[8:9], v242 offset:8192
  v_mfma_f32_16x16x32_bf16 v[28:31], a[12:15], v[132:135], v[28:31]
  ds_read_b64_tr_b16 a[10:11], v242 offset:12288
  buffer_load_dwordx4 v[172:175], v251, s[28:31], s51 offen sc1
  v_mfma_f32_16x16x32_bf16 v[32:35], a[16:19], v[128:131], v[32:35]
  ds_read_b64_tr_b16 a[12:13], v243 offset:8192
  v_mfma_f32_16x16x32_bf16 v[36:39], a[16:19], v[132:135], v[36:39]
  ds_read_b64_tr_b16 a[14:15], v243 offset:12288
  v_mfma_f32_16x16x32_bf16 v[40:43], a[20:23], v[128:131], v[40:43]
  ds_read_b64_tr_b16 a[16:17], v244 offset:8192
  v_mfma_f32_16x16x32_bf16 v[44:47], a[20:23], v[132:135], v[44:47]
  ds_read_b64_tr_b16 a[18:19], v244 offset:12288
  buffer_load_dwordx4 v[180:183], v252, s[16:19], s44 offen offset:64 sc1
  v_mfma_f32_16x16x32_bf16 v[48:51], a[24:27], v[128:131], v[48:51]
  ds_read_b64_tr_b16 a[20:21], v245 offset:8192
  v_mfma_f32_16x16x32_bf16 v[52:55], a[24:27], v[132:135], v[52:55]
  s_waitcnt lgkmcnt(4)
  ds_read_b64_tr_b16 a[22:23], v245 offset:12288
  v_mfma_f32_16x16x32_bf16 v[56:59], a[28:31], v[128:131], v[56:59]
  ds_read_b64_tr_b16 a[24:25], v246 offset:8192
  buffer_load_dwordx4 v[212:215], v252, s[16:19], s45 offen offset:64 sc1
  v_mfma_f32_16x16x32_bf16 v[60:63], a[28:31], v[132:135], v[60:63]
  s_waitcnt vmcnt(18)
  ds_read_b64_tr_b16 a[26:27], v246 offset:12288
  v_mfma_f32_16x16x32_bf16 v[0:3], a[0:3], v[136:139], v[0:3]
  ds_read_b64_tr_b16 a[28:29], v247 offset:8192
  v_mfma_f32_16x16x32_bf16 v[4:7], a[0:3], v[140:143], v[4:7]
  ds_read_b64_tr_b16 a[30:31], v247 offset:12288
  v_mfma_f32_16x16x32_bf16 v[8:11], a[4:7], v[136:139], v[8:11]
  ds_read_b64_tr_b16 a[0:1], v240 offset:16384
  v_mfma_f32_16x16x32_bf16 v[12:15], a[4:7], v[140:143], v[12:15]
  ds_read_b64_tr_b16 a[2:3], v240 offset:20480
  buffer_load_dwordx4 v[184:187], v252, s[16:19], s44 offen offset:128 sc1
  v_mfma_f32_16x16x32_bf16 v[16:19], a[8:11], v[136:139], v[16:19]
  ds_read_b64_tr_b16 a[4:5], v241 offset:16384
  v_mfma_f32_16x16x32_bf16 v[20:23], a[8:11], v[140:143], v[20:23]
  s_waitcnt lgkmcnt(4)
  ds_read_b64_tr_b16 a[6:7], v241 offset:20480
  v_mfma_f32_16x16x32_bf16 v[24:27], a[12:15], v[136:139], v[24:27]
  ds_read_b64_tr_b16 a[8:9], v242 offset:16384
  v_mfma_f32_16x16x32_bf16 v[28:31], a[12:15], v[140:143], v[28:31]
  ds_read_b64_tr_b16 a[10:11], v242 offset:20480
  buffer_load_dwordx4 v[216:219], v252, s[16:19], s45 offen offset:128 sc1
  v_mfma_f32_16x16x32_bf16 v[32:35], a[16:19], v[136:139], v[32:35]
  ds_read_b64_tr_b16 a[12:13], v243 offset:16384
  v_mfma_f32_16x16x32_bf16 v[36:39], a[16:19], v[140:143], v[36:39]
  ds_read_b64_tr_b16 a[14:15], v243 offset:20480
  v_mfma_f32_16x16x32_bf16 v[40:43], a[20:23], v[136:139], v[40:43]
  ds_read_b64_tr_b16 a[16:17], v244 offset:16384
  v_mfma_f32_16x16x32_bf16 v[44:47], a[20:23], v[140:143], v[44:47]
  ds_read_b64_tr_b16 a[18:19], v244 offset:20480
  buffer_load_dwordx4 v[188:191], v252, s[16:19], s44 offen offset:192 sc1
  v_mfma_f32_16x16x32_bf16 v[48:51], a[24:27], v[136:139], v[48:51]
  ds_read_b64_tr_b16 a[20:21], v245 offset:16384
  v_mfma_f32_16x16x32_bf16 v[52:55], a[24:27], v[140:143], v[52:55]
  s_waitcnt lgkmcnt(4)
  ds_read_b64_tr_b16 a[22:23], v245 offset:20480
  v_mfma_f32_16x16x32_bf16 v[56:59], a[28:31], v[136:139], v[56:59]
  ds_read_b64_tr_b16 a[24:25], v246 offset:16384
  buffer_load_dwordx4 v[220:223], v252, s[16:19], s45 offen offset:192 sc1
  v_mfma_f32_16x16x32_bf16 v[60:63], a[28:31], v[140:143], v[60:63]
  s_waitcnt vmcnt(18)
  ds_read_b64_tr_b16 a[26:27], v246 offset:20480
  v_mfma_f32_16x16x32_bf16 v[0:3], a[0:3], v[144:147], v[0:3]
  ds_read_b64_tr_b16 a[28:29], v247 offset:16384
  v_mfma_f32_16x16x32_bf16 v[4:7], a[0:3], v[148:151], v[4:7]
  ds_read_b64_tr_b16 a[30:31], v247 offset:20480
  v_mfma_f32_16x16x32_bf16 v[8:11], a[4:7], v[144:147], v[8:11]
  ds_read_b64_tr_b16 a[0:1], v240 offset:24576
  v_mfma_f32_16x16x32_bf16 v[12:15], a[4:7], v[148:151], v[12:15]
  ds_read_b64_tr_b16 a[2:3], v240 offset:28672
  buffer_load_dwordx4 v[192:195], v252, s[16:19], s44 offen offset:256 sc1
  v_mfma_f32_16x16x32_bf16 v[16:19], a[8:11], v[144:147], v[16:19]
  ds_read_b64_tr_b16 a[4:5], v241 offset:24576
  v_mfma_f32_16x16x32_bf16 v[20:23], a[8:11], v[148:151], v[20:23]
  s_waitcnt lgkmcnt(4)
  ds_read_b64_tr_b16 a[6:7], v241 offset:28672
  v_mfma_f32_16x16x32_bf16 v[24:27], a[12:15], v[144:147], v[24:27]
  ds_read_b64_tr_b16 a[8:9], v242 offset:24576
  v_mfma_f32_16x16x32_bf16 v[28:31], a[12:15], v[148:151], v[28:31]
  ds_read_b64_tr_b16 a[10:11], v242 offset:28672
  buffer_load_dwordx4 v[224:227], v252, s[16:19], s45 offen offset:256 sc1
  v_mfma_f32_16x16x32_bf16 v[32:35], a[16:19], v[144:147], v[32:35]
  ds_read_b64_tr_b16 a[12:13], v243 offset:24576
  v_mfma_f32_16x16x32_bf16 v[36:39], a[16:19], v[148:151], v[36:39]
  ds_read_b64_tr_b16 a[14:15], v243 offset:28672
  v_mfma_f32_16x16x32_bf16 v[40:43], a[20:23], v[144:147], v[40:43]
  ds_read_b64_tr_b16 a[16:17], v244 offset:24576
  v_mfma_f32_16x16x32_bf16 v[44:47], a[20:23], v[148:151], v[44:47]
  ds_read_b64_tr_b16 a[18:19], v244 offset:28672
  buffer_load_dwordx4 v[196:199], v252, s[16:19], s44 offen offset:320 sc1
  v_mfma_f32_16x16x32_bf16 v[48:51], a[24:27], v[144:147], v[48:51]
  ds_read_b64_tr_b16 a[20:21], v245 offset:24576
  v_mfma_f32_16x16x32_bf16 v[52:55], a[24:27], v[148:151], v[52:55]
  s_waitcnt lgkmcnt(4)
  ds_read_b64_tr_b16 a[22:23], v245 offset:28672
  v_mfma_f32_16x16x32_bf16 v[56:59], a[28:31], v[144:147], v[56:59]
  ds_read_b64_tr_b16 a[24:25], v246 offset:24576
  buffer_load_dwordx4 v[228:231], v252, s[16:19], s45 offen offset:320 sc1
  v_mfma_f32_16x16x32_bf16 v[60:63], a[28:31], v[148:151], v[60:63]
  s_waitcnt vmcnt(18)
  ds_read_b64_tr_b16 a[26:27], v246 offset:28672
  v_mfma_f32_16x16x32_bf16 v[0:3], a[0:3], v[152:155], v[0:3]
  ds_read_b64_tr_b16 a[28:29], v247 offset:24576
  v_mfma_f32_16x16x32_bf16 v[4:7], a[0:3], v[156:159], v[4:7]
  ds_read_b64_tr_b16 a[30:31], v247 offset:28672
  v_mfma_f32_16x16x32_bf16 v[8:11], a[4:7], v[152:155], v[8:11]
  ds_read_b64_tr_b16 a[0:1], v240 offset:32768
  v_mfma_f32_16x16x32_bf16 v[12:15], a[4:7], v[156:159], v[12:15]
  ds_read_b64_tr_b16 a[2:3], v240 offset:36864
  buffer_load_dwordx4 v[200:203], v252, s[16:19], s44 offen offset:384 sc1
  v_mfma_f32_16x16x32_bf16 v[16:19], a[8:11], v[152:155], v[16:19]
  ds_read_b64_tr_b16 a[4:5], v241 offset:32768
  v_mfma_f32_16x16x32_bf16 v[20:23], a[8:11], v[156:159], v[20:23]
  s_waitcnt lgkmcnt(4)
  ds_read_b64_tr_b16 a[6:7], v241 offset:36864
  v_mfma_f32_16x16x32_bf16 v[24:27], a[12:15], v[152:155], v[24:27]
  ds_read_b64_tr_b16 a[8:9], v242 offset:32768
  v_mfma_f32_16x16x32_bf16 v[28:31], a[12:15], v[156:159], v[28:31]
  ds_read_b64_tr_b16 a[10:11], v242 offset:36864
  buffer_load_dwordx4 v[232:235], v252, s[16:19], s45 offen offset:384 sc1
  v_mfma_f32_16x16x32_bf16 v[32:35], a[16:19], v[152:155], v[32:35]
  ds_read_b64_tr_b16 a[12:13], v243 offset:32768
  v_mfma_f32_16x16x32_bf16 v[36:39], a[16:19], v[156:159], v[36:39]
  ds_read_b64_tr_b16 a[14:15], v243 offset:36864
  v_mfma_f32_16x16x32_bf16 v[40:43], a[20:23], v[152:155], v[40:43]
  ds_read_b64_tr_b16 a[16:17], v244 offset:32768
  v_mfma_f32_16x16x32_bf16 v[44:47], a[20:23], v[156:159], v[44:47]
  ds_read_b64_tr_b16 a[18:19], v244 offset:36864
  buffer_load_dwordx4 v[204:207], v252, s[16:19], s44 offen offset:448 sc1
  v_mfma_f32_16x16x32_bf16 v[48:51], a[24:27], v[152:155], v[48:51]
  ds_read_b64_tr_b16 a[20:21], v245 offset:32768
  v_mfma_f32_16x16x32_bf16 v[52:55], a[24:27], v[156:159], v[52:55]
  s_waitcnt lgkmcnt(4)
  ds_read_b64_tr_b16 a[22:23], v245 offset:36864
  v_mfma_f32_16x16x32_bf16 v[56:59], a[28:31], v[152:155], v[56:59]
  ds_read_b64_tr_b16 a[24:25], v246 offset:32768
  buffer_load_dwordx4 v[236:239], v252, s[16:19], s45 offen offset:448 sc1
  v_mfma_f32_16x16x32_bf16 v[60:63], a[28:31], v[156:159], v[60:63]
  s_waitcnt vmcnt(18)
  ds_read_b64_tr_b16 a[26:27], v246 offset:36864
  v_mfma_f32_16x16x32_bf16 v[0:3], a[0:3], v[160:163], v[0:3]
  ds_read_b64_tr_b16 a[28:29], v247 offset:32768
  v_mfma_f32_16x16x32_bf16 v[4:7], a[0:3], v[164:167], v[4:7]
  ds_read_b64_tr_b16 a[30:31], v247 offset:36864
  v_mfma_f32_16x16x32_bf16 v[8:11], a[4:7], v[160:163], v[8:11]
  ds_read_b64_tr_b16 a[0:1], v240 offset:40960
  v_mfma_f32_16x16x32_bf16 v[12:15], a[4:7], v[164:167], v[12:15]
  ds_read_b64_tr_b16 a[2:3], v240 offset:45056
  v_mfma_f32_16x16x32_bf16 v[16:19], a[8:11], v[160:163], v[16:19]
  ds_read_b64_tr_b16 a[4:5], v241 offset:40960
  v_mfma_f32_16x16x32_bf16 v[20:23], a[8:11], v[164:167], v[20:23]
  s_waitcnt lgkmcnt(4)
  ds_read_b64_tr_b16 a[6:7], v241 offset:45056
  v_mfma_f32_16x16x32_bf16 v[24:27], a[12:15], v[160:163], v[24:27]
  ds_read_b64_tr_b16 a[8:9], v242 offset:40960
  v_mfma_f32_16x16x32_bf16 v[28:31], a[12:15], v[164:167], v[28:31]
  ds_read_b64_tr_b16 a[10:11], v242 offset:45056
  v_mfma_f32_16x16x32_bf16 v[32:35], a[16:19], v[160:163], v[32:35]
  ds_read_b64_tr_b16 a[12:13], v243 offset:40960
  v_mfma_f32_16x16x32_bf16 v[36:39], a[16:19], v[164:167], v[36:39]
  ds_read_b64_tr_b16 a[14:15], v243 offset:45056
  v_mfma_f32_16x16x32_bf16 v[40:43], a[20:23], v[160:163], v[40:43]
  ds_read_b64_tr_b16 a[16:17], v244 offset:40960
  v_mfma_f32_16x16x32_bf16 v[44:47], a[20:23], v[164:167], v[44:47]
  ds_read_b64_tr_b16 a[18:19], v244 offset:45056
  v_mfma_f32_16x16x32_bf16 v[48:51], a[24:27], v[160:163], v[48:51]
  ds_read_b64_tr_b16 a[20:21], v245 offset:40960
  v_mfma_f32_16x16x32_bf16 v[52:55], a[24:27], v[164:167], v[52:55]
  s_waitcnt lgkmcnt(4)
  ds_read_b64_tr_b16 a[22:23], v245 offset:45056
  v_mfma_f32_16x16x32_bf16 v[56:59], a[28:31], v[160:163], v[56:59]
  ds_read_b64_tr_b16 a[24:25], v246 offset:40960
  v_mfma_f32_16x16x32_bf16 v[60:63], a[28:31], v[164:167], v[60:63]
  s_waitcnt vmcnt(14)
  ds_read_b64_tr_b16 a[26:27], v246 offset:45056
  v_mfma_f32_16x16x32_bf16 v[0:3], a[0:3], v[168:171], v[0:3]
  ds_read_b64_tr_b16 a[28:29], v247 offset:40960
  v_mfma_f32_16x16x32_bf16 v[4:7], a[0:3], v[172:175], v[4:7]
  ds_read_b64_tr_b16 a[30:31], v247 offset:45056
  v_mfma_f32_16x16x32_bf16 v[8:11], a[4:7], v[168:171], v[8:11]
  v_mfma_f32_16x16x32_bf16 v[12:15], a[4:7], v[172:175], v[12:15]
  v_mfma_f32_16x16x32_bf16 v[16:19], a[8:11], v[168:171], v[16:19]
  v_mfma_f32_16x16x32_bf16 v[20:23], a[8:11], v[172:175], v[20:23]
  s_waitcnt lgkmcnt(4)
  v_mfma_f32_16x16x32_bf16 v[24:27], a[12:15], v[168:171], v[24:27]
  v_mfma_f32_16x16x32_bf16 v[28:31], a[12:15], v[172:175], v[28:31]
  v_mfma_f32_16x16x32_bf16 v[32:35], a[16:19], v[168:171], v[32:35]
  v_mfma_f32_16x16x32_bf16 v[36:39], a[16:19], v[172:175], v[36:39]
  v_mfma_f32_16x16x32_bf16 v[40:43], a[20:23], v[168:171], v[40:43]
  v_mfma_f32_16x16x32_bf16 v[44:47], a[20:23], v[172:175], v[44:47]
  v_mfma_f32_16x16x32_bf16 v[48:51], a[24:27], v[168:171], v[48:51]
  v_mfma_f32_16x16x32_bf16 v[52:55], a[24:27], v[172:175], v[52:55]
  s_waitcnt lgkmcnt(4)
  v_mfma_f32_16x16x32_bf16 v[56:59], a[28:31], v[168:171], v[56:59]
  v_mfma_f32_16x16x32_bf16 v[60:63], a[28:31], v[172:175], v[60:63]
  s_waitcnt vmcnt(0)
  s_barrier
  v_mbcnt_lo_u32_b32 v148, -1, 0
  v_mbcnt_hi_u32_b32 v148, -1, v148
  v_bfe_u32 v149, v148, 4, 2
  v_lshlrev_b32 v149, 1, v149
  v_and_b32 v150, 7, v148
  v_xor_b32 v149, v149, v150
  v_lshlrev_b32 v149, 4, v149
  v_lshrrev_b32 v150, 3, v148
  v_mul_u32_u24 v150, 896, v150
  v_add_u32 v144, v149, v150
  v_add_u32 v145, 6144, v144
  v_add_u32 v146, 12288, v144
  v_add_u32 v147, 18432, v144
  s_mul_i32 s73, s14, 401408
  s_lshl_b32 s74, s70, 7
  s_add_u32 s73, s73, s74
  s_mov_b32 s24, s54
  s_mov_b32 s25, s55
  s_add_u32 s24, s24, s73
  s_addc_u32 s25, s25, 0
  s_and_b32 s25, s25, 0xffff
  s_mov_b32 s26, 0x0
  s_mov_b32 s27, 0x20000
  s_sub_u32 s26, 1605632, s73
  s_mul_i32 s71, s14, 40960
  s_and_b32 s72, s2, 7
  s_mul_i32 s72, s72, 14
  s_lshr_b32 s72, s72, 3
  s_mov_b32 s49, s72
  v_accvgpr_read_b32 v64, a32
  v_accvgpr_read_b32 v65, a33
  v_accvgpr_read_b32 v66, a34
  v_accvgpr_read_b32 v67, a35
  v_accvgpr_read_b32 v68, a36
  v_accvgpr_read_b32 v69, a37
  v_accvgpr_read_b32 v70, a38
  v_accvgpr_read_b32 v71, a39
  v_accvgpr_read_b32 v72, a40
  v_accvgpr_read_b32 v73, a41
  v_accvgpr_read_b32 v74, a42
  v_accvgpr_read_b32 v75, a43
  v_accvgpr_read_b32 v76, a44
  v_accvgpr_read_b32 v77, a45
  v_accvgpr_read_b32 v80, a46
  v_accvgpr_read_b32 v81, a47
  v_accvgpr_read_b32 v82, a48
  v_accvgpr_read_b32 v83, a49
  v_accvgpr_read_b32 v84, a50
  v_accvgpr_read_b32 v85, a51
  v_accvgpr_read_b32 v86, a52
  v_accvgpr_read_b32 v87, a53
  v_accvgpr_read_b32 v88, a54
  v_accvgpr_read_b32 v89, a55
  v_accvgpr_read_b32 v90, a56
  v_accvgpr_read_b32 v91, a57
  v_accvgpr_read_b32 v92, a58
  v_accvgpr_read_b32 v93, a59
  s_add_u32 m0, s71, 0
  s_mul_i32 s50, s49, 28672
  buffer_load_dwordx4 v144, s[24:27], s50 offen offset:0 lds
  v_add_f32 v64, v64, v66
  v_add_f32 v65, v65, v67
  v_add_f32 v64, v64, v68
  v_add_f32 v65, v65, v69
  v_add_f32 v64, v64, v70
  v_add_f32 v65, v65, v71
  v_add_f32 v64, v64, v72
  v_add_f32 v65, v65, v73
  v_add_f32 v64, v64, v74
  v_add_f32 v65, v65, v75
  v_add_f32 v64, v64, v76
  v_add_f32 v65, v65, v77
  v_add_f32 v80, v80, v82
  v_add_f32 v81, v81, v83
  v_add_f32 v80, v80, v84
  v_add_f32 v81, v81, v85
  v_add_f32 v80, v80, v86
  v_add_f32 v81, v81, v87
  v_add_f32 v80, v80, v88
  v_add_f32 v81, v81, v89
  v_add_f32 v80, v80, v90
  v_add_f32 v81, v81, v91
  v_add_f32 v80, v80, v92
  v_add_f32 v81, v81, v93
  buffer_load_dwordx4 v145, s[24:27], s50 offen offset:1024 lds
  v_mul_f32 v64, 0x3b124925, v64
  v_mul_f32 v65, 0x3b124925, v65
  v_fma_f32 v65, -v64, v64, v65
  v_max_f32 v65, 0, v65
  v_cvt_pk_bf16_f32 v65, v65, v65
  v_and_b32 v65, 0xffff0000, v65
  v_add_f32 v65, 0x3727c5ac, v65
  v_cvt_pk_bf16_f32 v65, v65, v65
  v_and_b32 v65, 0xffff0000, v65
  v_sqrt_f32 v65, v65
  v_cvt_pk_bf16_f32 v96, v64, v64
  v_and_b32 v96, 0xffff0000, v96
  v_cvt_pk_bf16_f32 v65, v65, v65
  v_and_b32 v65, 0xffff0000, v65
  v_rcp_f32 v98, v65
  v_sub_f32 v96, 0, v96
  buffer_load_dwordx4 v146, s[24:27], s50 offen offset:2048 lds
  v_mul_f32 v80, 0x3b124925, v80
  v_mul_f32 v81, 0x3b124925, v81
  v_fma_f32 v81, -v80, v80, v81
  v_max_f32 v81, 0, v81
  v_cvt_pk_bf16_f32 v81, v81, v81
  v_and_b32 v81, 0xffff0000, v81
  v_add_f32 v81, 0x3727c5ac, v81
  v_cvt_pk_bf16_f32 v81, v81, v81
  v_and_b32 v81, 0xffff0000, v81
  v_sqrt_f32 v81, v81
  v_cvt_pk_bf16_f32 v97, v80, v80
  v_and_b32 v97, 0xffff0000, v97
  v_cvt_pk_bf16_f32 v81, v81, v81
  v_and_b32 v81, 0xffff0000, v81
  v_rcp_f32 v99, v81
  v_sub_f32 v97, 0, v97
  buffer_load_dwordx4 v147, s[24:27], s50 offen offset:3072 lds
  v_mov_b32 v102, 0x3fb8aa3b
  v_mul_f32 v98, 0x3fb8aa3b, v98
  v_mul_f32 v99, 0x3fb8aa3b, v99
  v_fma_f32 v0, v96, v176, v0
  v_fma_f32 v1, v96, v177, v1
  v_fma_f32 v2, v96, v178, v2
  v_fma_f32 v3, v96, v179, v3
  v_fma_f32 v8, v96, v180, v8
  v_fma_f32 v9, v96, v181, v9
  v_fma_f32 v10, v96, v182, v10
  v_fma_f32 v11, v96, v183, v11
  s_add_u32 s49, s49, 1
  s_cmp_eq_u32 s49, 14
  s_cselect_b32 s49, 0, s49
  s_add_u32 m0, s71, 4096
  s_mul_i32 s50, s49, 28672
  v_fma_f32 v0, v98, v0, v208
  v_fma_f32 v1, v98, v1, v209
  v_fma_f32 v2, v98, v2, v210
  v_fma_f32 v3, v98, v3, v211
  v_fma_f32 v8, v98, v8, v212
  v_fma_f32 v9, v98, v9, v213
  v_fma_f32 v10, v98, v10, v214
  v_fma_f32 v11, v98, v11, v215
  v_exp_f32 v104, -v0
  v_exp_f32 v105, -v1
  v_exp_f32 v106, -v2
  v_exp_f32 v107, -v3
  v_exp_f32 v108, -v8
  v_exp_f32 v109, -v9
  v_exp_f32 v110, -v10
  v_exp_f32 v111, -v11
  buffer_load_dwordx4 v144, s[24:27], s50 offen offset:0 lds
  v_fma_f32 v104, v104, v102, v102
  v_fma_f32 v105, v105, v102, v102
  v_fma_f32 v106, v106, v102, v102
  v_fma_f32 v107, v107, v102, v102
  v_fma_f32 v108, v108, v102, v102
  v_fma_f32 v109, v109, v102, v102
  v_fma_f32 v110, v110, v102, v102
  v_fma_f32 v111, v111, v102, v102
  v_rcp_f32 v104, v104
  v_rcp_f32 v105, v105
  v_rcp_f32 v106, v106
  v_rcp_f32 v107, v107
  v_rcp_f32 v108, v108
  v_rcp_f32 v109, v109
  v_rcp_f32 v110, v110
  v_rcp_f32 v111, v111
  buffer_load_dwordx4 v145, s[24:27], s50 offen offset:1024 lds
  v_mul_f32 v0, v0, v104
  v_mul_f32 v1, v1, v105
  v_mul_f32 v2, v2, v106
  v_mul_f32 v3, v3, v107
  v_mul_f32 v8, v8, v108
  v_mul_f32 v9, v9, v109
  v_mul_f32 v10, v10, v110
  v_mul_f32 v11, v11, v111
  v_cvt_pk_bf16_f32 v0, v0, v1
  v_cvt_pk_bf16_f32 v1, v2, v3
  v_cvt_pk_bf16_f32 v2, v8, v9
  v_cvt_pk_bf16_f32 v3, v10, v11
  buffer_store_dwordx4 v[0:3], v254, s[36:39], 0 offen offset:0 sc1
  v_fma_f32 v4, v97, v176, v4
  v_fma_f32 v5, v97, v177, v5
  v_fma_f32 v6, v97, v178, v6
  v_fma_f32 v7, v97, v179, v7
  v_fma_f32 v12, v97, v180, v12
  v_fma_f32 v13, v97, v181, v13
  v_fma_f32 v14, v97, v182, v14
  v_fma_f32 v15, v97, v183, v15
  buffer_load_dwordx4 v146, s[24:27], s50 offen offset:2048 lds
  v_fma_f32 v4, v99, v4, v208
  v_fma_f32 v5, v99, v5, v209
  v_fma_f32 v6, v99, v6, v210
  v_fma_f32 v7, v99, v7, v211
  v_fma_f32 v12, v99, v12, v212
  v_fma_f32 v13, v99, v13, v213
  v_fma_f32 v14, v99, v14, v214
  v_fma_f32 v15, v99, v15, v215
  v_exp_f32 v112, -v4
  v_exp_f32 v113, -v5
  v_exp_f32 v114, -v6
  v_exp_f32 v115, -v7
  v_exp_f32 v116, -v12
  v_exp_f32 v117, -v13
  v_exp_f32 v118, -v14
  v_exp_f32 v119, -v15
  buffer_load_dwordx4 v147, s[24:27], s50 offen offset:3072 lds
  v_fma_f32 v112, v112, v102, v102
  v_fma_f32 v113, v113, v102, v102
  v_fma_f32 v114, v114, v102, v102
  v_fma_f32 v115, v115, v102, v102
  v_fma_f32 v116, v116, v102, v102
  v_fma_f32 v117, v117, v102, v102
  v_fma_f32 v118, v118, v102, v102
  v_fma_f32 v119, v119, v102, v102
  v_rcp_f32 v112, v112
  v_rcp_f32 v113, v113
  v_rcp_f32 v114, v114
  v_rcp_f32 v115, v115
  v_rcp_f32 v116, v116
  v_rcp_f32 v117, v117
  v_rcp_f32 v118, v118
  v_rcp_f32 v119, v119
  s_add_u32 s49, s49, 1
  s_cmp_eq_u32 s49, 14
  s_cselect_b32 s49, 0, s49
  s_add_u32 m0, s71, 8192
  s_mul_i32 s50, s49, 28672
  v_mul_f32 v4, v4, v112
  v_mul_f32 v5, v5, v113
  v_mul_f32 v6, v6, v114
  v_mul_f32 v7, v7, v115
  v_mul_f32 v12, v12, v116
  v_mul_f32 v13, v13, v117
  v_mul_f32 v14, v14, v118
  v_mul_f32 v15, v15, v119
  v_cvt_pk_bf16_f32 v4, v4, v5
  v_cvt_pk_bf16_f32 v5, v6, v7
  v_cvt_pk_bf16_f32 v6, v12, v13
  v_cvt_pk_bf16_f32 v7, v14, v15
  buffer_store_dwordx4 v[4:7], v255, s[36:39], 0 offen offset:0 sc1
  v_fma_f32 v16, v96, v184, v16
  v_fma_f32 v17, v96, v185, v17
  v_fma_f32 v18, v96, v186, v18
  v_fma_f32 v19, v96, v187, v19
  v_fma_f32 v24, v96, v188, v24
  v_fma_f32 v25, v96, v189, v25
  v_fma_f32 v26, v96, v190, v26
  v_fma_f32 v27, v96, v191, v27
  buffer_load_dwordx4 v144, s[24:27], s50 offen offset:0 lds
  v_fma_f32 v16, v98, v16, v216
  v_fma_f32 v17, v98, v17, v217
  v_fma_f32 v18, v98, v18, v218
  v_fma_f32 v19, v98, v19, v219
  v_fma_f32 v24, v98, v24, v220
  v_fma_f32 v25, v98, v25, v221
  v_fma_f32 v26, v98, v26, v222
  v_fma_f32 v27, v98, v27, v223
  v_exp_f32 v104, -v16
  v_exp_f32 v105, -v17
  v_exp_f32 v106, -v18
  v_exp_f32 v107, -v19
  v_exp_f32 v108, -v24
  v_exp_f32 v109, -v25
  v_exp_f32 v110, -v26
  v_exp_f32 v111, -v27
  buffer_load_dwordx4 v145, s[24:27], s50 offen offset:1024 lds
  v_fma_f32 v104, v104, v102, v102
  v_fma_f32 v105, v105, v102, v102
  v_fma_f32 v106, v106, v102, v102
  v_fma_f32 v107, v107, v102, v102
  v_fma_f32 v108, v108, v102, v102
  v_fma_f32 v109, v109, v102, v102
  v_fma_f32 v110, v110, v102, v102
  v_fma_f32 v111, v111, v102, v102
  v_rcp_f32 v104, v104
  v_rcp_f32 v105, v105
  v_rcp_f32 v106, v106
  v_rcp_f32 v107, v107
  v_rcp_f32 v108, v108
  v_rcp_f32 v109, v109
  v_rcp_f32 v110, v110
  v_rcp_f32 v111, v111
  buffer_load_dwordx4 v146, s[24:27], s50 offen offset:2048 lds
  v_mul_f32 v16, v16, v104
  v_mul_f32 v17, v17, v105
  v_mul_f32 v18, v18, v106
  v_mul_f32 v19, v19, v107
  v_mul_f32 v24, v24, v108
  v_mul_f32 v25, v25, v109
  v_mul_f32 v26, v26, v110
  v_mul_f32 v27, v27, v111
  v_cvt_pk_bf16_f32 v16, v16, v17
  v_cvt_pk_bf16_f32 v17, v18, v19
  v_cvt_pk_bf16_f32 v18, v24, v25
  v_cvt_pk_bf16_f32 v19, v26, v27
  buffer_store_dwordx4 v[16:19], v254, s[36:39], 0 offen offset:1024 sc1
  v_fma_f32 v20, v97, v184, v20
  v_fma_f32 v21, v97, v185, v21
  v_fma_f32 v22, v97, v186, v22
  v_fma_f32 v23, v97, v187, v23
  v_fma_f32 v28, v97, v188, v28
  v_fma_f32 v29, v97, v189, v29
  v_fma_f32 v30, v97, v190, v30
  v_fma_f32 v31, v97, v191, v31
  buffer_load_dwordx4 v147, s[24:27], s50 offen offset:3072 lds
  v_fma_f32 v20, v99, v20, v216
  v_fma_f32 v21, v99, v21, v217
  v_fma_f32 v22, v99, v22, v218
  v_fma_f32 v23, v99, v23, v219
  v_fma_f32 v28, v99, v28, v220
  v_fma_f32 v29, v99, v29, v221
  v_fma_f32 v30, v99, v30, v222
  v_fma_f32 v31, v99, v31, v223
  v_exp_f32 v112, -v20
  v_exp_f32 v113, -v21
  v_exp_f32 v114, -v22
  v_exp_f32 v115, -v23
  v_exp_f32 v116, -v28
  v_exp_f32 v117, -v29
  v_exp_f32 v118, -v30
  v_exp_f32 v119, -v31
  s_add_u32 s49, s49, 1
  s_cmp_eq_u32 s49, 14
  s_cselect_b32 s49, 0, s49
  s_add_u32 m0, s71, 12288
  s_mul_i32 s50, s49, 28672
  v_fma_f32 v112, v112, v102, v102
  v_fma_f32 v113, v113, v102, v102
  v_fma_f32 v114, v114, v102, v102
  v_fma_f32 v115, v115, v102, v102
  v_fma_f32 v116, v116, v102, v102
  v_fma_f32 v117, v117, v102, v102
  v_fma_f32 v118, v118, v102, v102
  v_fma_f32 v119, v119, v102, v102
  v_rcp_f32 v112, v112
  v_rcp_f32 v113, v113
  v_rcp_f32 v114, v114
  v_rcp_f32 v115, v115
  v_rcp_f32 v116, v116
  v_rcp_f32 v117, v117
  v_rcp_f32 v118, v118
  v_rcp_f32 v119, v119
  buffer_load_dwordx4 v144, s[24:27], s50 offen offset:0 lds
  v_mul_f32 v20, v20, v112
  v_mul_f32 v21, v21, v113
  v_mul_f32 v22, v22, v114
  v_mul_f32 v23, v23, v115
  v_mul_f32 v28, v28, v116
  v_mul_f32 v29, v29, v117
  v_mul_f32 v30, v30, v118
  v_mul_f32 v31, v31, v119
  v_cvt_pk_bf16_f32 v20, v20, v21
  v_cvt_pk_bf16_f32 v21, v22, v23
  v_cvt_pk_bf16_f32 v22, v28, v29
  v_cvt_pk_bf16_f32 v23, v30, v31
  buffer_store_dwordx4 v[20:23], v255, s[36:39], 0 offen offset:1024 sc1
  v_fma_f32 v32, v96, v192, v32
  v_fma_f32 v33, v96, v193, v33
  v_fma_f32 v34, v96, v194, v34
  v_fma_f32 v35, v96, v195, v35
  v_fma_f32 v40, v96, v196, v40
  v_fma_f32 v41, v96, v197, v41
  v_fma_f32 v42, v96, v198, v42
  v_fma_f32 v43, v96, v199, v43
  buffer_load_dwordx4 v145, s[24:27], s50 offen offset:1024 lds
  v_fma_f32 v32, v98, v32, v224
  v_fma_f32 v33, v98, v33, v225
  v_fma_f32 v34, v98, v34, v226
  v_fma_f32 v35, v98, v35, v227
  v_fma_f32 v40, v98, v40, v228
  v_fma_f32 v41, v98, v41, v229
  v_fma_f32 v42, v98, v42, v230
  v_fma_f32 v43, v98, v43, v231
  v_exp_f32 v104, -v32
  v_exp_f32 v105, -v33
  v_exp_f32 v106, -v34
  v_exp_f32 v107, -v35
  v_exp_f32 v108, -v40
  v_exp_f32 v109, -v41
  v_exp_f32 v110, -v42
  v_exp_f32 v111, -v43
  buffer_load_dwordx4 v146, s[24:27], s50 offen offset:2048 lds
  v_fma_f32 v104, v104, v102, v102
  v_fma_f32 v105, v105, v102, v102
  v_fma_f32 v106, v106, v102, v102
  v_fma_f32 v107, v107, v102, v102
  v_fma_f32 v108, v108, v102, v102
  v_fma_f32 v109, v109, v102, v102
  v_fma_f32 v110, v110, v102, v102
  v_fma_f32 v111, v111, v102, v102
  v_rcp_f32 v104, v104
  v_rcp_f32 v105, v105
  v_rcp_f32 v106, v106
  v_rcp_f32 v107, v107
  v_rcp_f32 v108, v108
  v_rcp_f32 v109, v109
  v_rcp_f32 v110, v110
  v_rcp_f32 v111, v111
  buffer_load_dwordx4 v147, s[24:27], s50 offen offset:3072 lds
  v_mul_f32 v32, v32, v104
  v_mul_f32 v33, v33, v105
  v_mul_f32 v34, v34, v106
  v_mul_f32 v35, v35, v107
  v_mul_f32 v40, v40, v108
  v_mul_f32 v41, v41, v109
  v_mul_f32 v42, v42, v110
  v_mul_f32 v43, v43, v111
  v_cvt_pk_bf16_f32 v32, v32, v33
  v_cvt_pk_bf16_f32 v33, v34, v35
  v_cvt_pk_bf16_f32 v34, v40, v41
  v_cvt_pk_bf16_f32 v35, v42, v43
  buffer_store_dwordx4 v[32:35], v254, s[36:39], 0 offen offset:2048 sc1
  v_fma_f32 v36, v97, v192, v36
  v_fma_f32 v37, v97, v193, v37
  v_fma_f32 v38, v97, v194, v38
  v_fma_f32 v39, v97, v195, v39
  v_fma_f32 v44, v97, v196, v44
  v_fma_f32 v45, v97, v197, v45
  v_fma_f32 v46, v97, v198, v46
  v_fma_f32 v47, v97, v199, v47
  s_add_u32 s49, s49, 1
  s_cmp_eq_u32 s49, 14
  s_cselect_b32 s49, 0, s49
  s_add_u32 m0, s71, 16384
  s_mul_i32 s50, s49, 28672
  v_fma_f32 v36, v99, v36, v224
  v_fma_f32 v37, v99, v37, v225
  v_fma_f32 v38, v99, v38, v226
  v_fma_f32 v39, v99, v39, v227
  v_fma_f32 v44, v99, v44, v228
  v_fma_f32 v45, v99, v45, v229
  v_fma_f32 v46, v99, v46, v230
  v_fma_f32 v47, v99, v47, v231
  v_exp_f32 v112, -v36
  v_exp_f32 v113, -v37
  v_exp_f32 v114, -v38
  v_exp_f32 v115, -v39
  v_exp_f32 v116, -v44
  v_exp_f32 v117, -v45
  v_exp_f32 v118, -v46
  v_exp_f32 v119, -v47
  buffer_load_dwordx4 v144, s[24:27], s50 offen offset:0 lds
  v_fma_f32 v112, v112, v102, v102
  v_fma_f32 v113, v113, v102, v102
  v_fma_f32 v114, v114, v102, v102
  v_fma_f32 v115, v115, v102, v102
  v_fma_f32 v116, v116, v102, v102
  v_fma_f32 v117, v117, v102, v102
  v_fma_f32 v118, v118, v102, v102
  v_fma_f32 v119, v119, v102, v102
  v_rcp_f32 v112, v112
  v_rcp_f32 v113, v113
  v_rcp_f32 v114, v114
  v_rcp_f32 v115, v115
  v_rcp_f32 v116, v116
  v_rcp_f32 v117, v117
  v_rcp_f32 v118, v118
  v_rcp_f32 v119, v119
  buffer_load_dwordx4 v145, s[24:27], s50 offen offset:1024 lds
  v_mul_f32 v36, v36, v112
  v_mul_f32 v37, v37, v113
  v_mul_f32 v38, v38, v114
  v_mul_f32 v39, v39, v115
  v_mul_f32 v44, v44, v116
  v_mul_f32 v45, v45, v117
  v_mul_f32 v46, v46, v118
  v_mul_f32 v47, v47, v119
  v_cvt_pk_bf16_f32 v36, v36, v37
  v_cvt_pk_bf16_f32 v37, v38, v39
  v_cvt_pk_bf16_f32 v38, v44, v45
  v_cvt_pk_bf16_f32 v39, v46, v47
  buffer_store_dwordx4 v[36:39], v255, s[36:39], 0 offen offset:2048 sc1
  v_fma_f32 v48, v96, v200, v48
  v_fma_f32 v49, v96, v201, v49
  v_fma_f32 v50, v96, v202, v50
  v_fma_f32 v51, v96, v203, v51
  v_fma_f32 v56, v96, v204, v56
  v_fma_f32 v57, v96, v205, v57
  v_fma_f32 v58, v96, v206, v58
  v_fma_f32 v59, v96, v207, v59
  buffer_load_dwordx4 v146, s[24:27], s50 offen offset:2048 lds
  v_fma_f32 v48, v98, v48, v232
  v_fma_f32 v49, v98, v49, v233
  v_fma_f32 v50, v98, v50, v234
  v_fma_f32 v51, v98, v51, v235
  v_fma_f32 v56, v98, v56, v236
  v_fma_f32 v57, v98, v57, v237
  v_fma_f32 v58, v98, v58, v238
  v_fma_f32 v59, v98, v59, v239
  v_exp_f32 v104, -v48
  v_exp_f32 v105, -v49
  v_exp_f32 v106, -v50
  v_exp_f32 v107, -v51
  v_exp_f32 v108, -v56
  v_exp_f32 v109, -v57
  v_exp_f32 v110, -v58
  v_exp_f32 v111, -v59
  buffer_load_dwordx4 v147, s[24:27], s50 offen offset:3072 lds
  v_fma_f32 v104, v104, v102, v102
  v_fma_f32 v105, v105, v102, v102
  v_fma_f32 v106, v106, v102, v102
  v_fma_f32 v107, v107, v102, v102
  v_fma_f32 v108, v108, v102, v102
  v_fma_f32 v109, v109, v102, v102
  v_fma_f32 v110, v110, v102, v102
  v_fma_f32 v111, v111, v102, v102
  v_rcp_f32 v104, v104
  v_rcp_f32 v105, v105
  v_rcp_f32 v106, v106
  v_rcp_f32 v107, v107
  v_rcp_f32 v108, v108
  v_rcp_f32 v109, v109
  v_rcp_f32 v110, v110
  v_rcp_f32 v111, v111
  s_add_u32 s49, s49, 1
  s_cmp_eq_u32 s49, 14
  s_cselect_b32 s49, 0, s49
  s_add_u32 m0, s71, 20480
  s_mul_i32 s50, s49, 28672
  v_mul_f32 v48, v48, v104
  v_mul_f32 v49, v49, v105
  v_mul_f32 v50, v50, v106
  v_mul_f32 v51, v51, v107
  v_mul_f32 v56, v56, v108
  v_mul_f32 v57, v57, v109
  v_mul_f32 v58, v58, v110
  v_mul_f32 v59, v59, v111
  v_cvt_pk_bf16_f32 v48, v48, v49
  v_cvt_pk_bf16_f32 v49, v50, v51
  v_cvt_pk_bf16_f32 v50, v56, v57
  v_cvt_pk_bf16_f32 v51, v58, v59
  buffer_store_dwordx4 v[48:51], v254, s[36:39], 0 offen offset:3072 sc1
  v_fma_f32 v52, v97, v200, v52
  v_fma_f32 v53, v97, v201, v53
  v_fma_f32 v54, v97, v202, v54
  v_fma_f32 v55, v97, v203, v55
  v_fma_f32 v60, v97, v204, v60
  v_fma_f32 v61, v97, v205, v61
  v_fma_f32 v62, v97, v206, v62
  v_fma_f32 v63, v97, v207, v63
  buffer_load_dwordx4 v144, s[24:27], s50 offen offset:0 lds
  v_fma_f32 v52, v99, v52, v232
  v_fma_f32 v53, v99, v53, v233
  v_fma_f32 v54, v99, v54, v234
  v_fma_f32 v55, v99, v55, v235
  v_fma_f32 v60, v99, v60, v236
  v_fma_f32 v61, v99, v61, v237
  v_fma_f32 v62, v99, v62, v238
  v_fma_f32 v63, v99, v63, v239
  v_exp_f32 v112, -v52
  v_exp_f32 v113, -v53
  v_exp_f32 v114, -v54
  v_exp_f32 v115, -v55
  v_exp_f32 v116, -v60
  v_exp_f32 v117, -v61
  v_exp_f32 v118, -v62
  v_exp_f32 v119, -v63
  buffer_load_dwordx4 v145, s[24:27], s50 offen offset:1024 lds
  v_fma_f32 v112, v112, v102, v102
  v_fma_f32 v113, v113, v102, v102
  v_fma_f32 v114, v114, v102, v102
  v_fma_f32 v115, v115, v102, v102
  v_fma_f32 v116, v116, v102, v102
  v_fma_f32 v117, v117, v102, v102
  v_fma_f32 v118, v118, v102, v102
  v_fma_f32 v119, v119, v102, v102
  v_rcp_f32 v112, v112
  v_rcp_f32 v113, v113
  v_rcp_f32 v114, v114
  v_rcp_f32 v115, v115
  v_rcp_f32 v116, v116
  v_rcp_f32 v117, v117
  v_rcp_f32 v118, v118
  v_rcp_f32 v119, v119
  buffer_load_dwordx4 v146, s[24:27], s50 offen offset:2048 lds
  v_mul_f32 v52, v52, v112
  v_mul_f32 v53, v53, v113
  v_mul_f32 v54, v54, v114
  v_mul_f32 v55, v55, v115
  v_mul_f32 v60, v60, v116
  v_mul_f32 v61, v61, v117
  v_mul_f32 v62, v62, v118
  v_mul_f32 v63, v63, v119
  v_cvt_pk_bf16_f32 v52, v52, v53
  v_cvt_pk_bf16_f32 v53, v54, v55
  v_cvt_pk_bf16_f32 v54, v60, v61
  v_cvt_pk_bf16_f32 v55, v62, v63
  buffer_store_dwordx4 v[52:55], v255, s[36:39], 0 offen offset:3072 sc1
  s_waitcnt vmcnt(0)
  s_barrier
  s_lshl_b32 s44, s76, 7
  s_lshl_b32 s45, s77, 2
  s_add_u32 s44, s44, s45
  s_add_u32 s44, s44, 4096
  s_cmp_lg_u32 s14, 0
  s_cbranch_scc1 K2_c_nf
  v_mov_b32 v8, 0
  v_mov_b32 v9, s75
  s_mov_b64 exec, 1
  buffer_store_dword v9, v8, s[32:35], s44 offen sc1
  s_mov_b64 exec, -1
K2_c_nf:
  buffer_load_dwordx4 v147, s[24:27], s50 offen offset:3072 lds
  s_add_u32 s49, s49, 1
  s_cmp_eq_u32 s49, 14
  s_cselect_b32 s49, 0, s49
  s_add_u32 m0, s71, 24576
  s_mul_i32 s50, s49, 28672
  buffer_load_dwordx4 v144, s[24:27], s50 offen offset:0 lds
  buffer_load_dwordx4 v145, s[24:27], s50 offen offset:1024 lds
  buffer_load_dwordx4 v146, s[24:27], s50 offen offset:2048 lds
  buffer_load_dwordx4 v147, s[24:27], s50 offen offset:3072 lds
  s_add_u32 s49, s49, 1
  s_cmp_eq_u32 s49, 14
  s_cselect_b32 s49, 0, s49
  s_add_u32 m0, s71, 28672
  s_mul_i32 s50, s49, 28672
  buffer_load_dwordx4 v144, s[24:27], s50 offen offset:0 lds
  buffer_load_dwordx4 v145, s[24:27], s50 offen offset:1024 lds
  buffer_load_dwordx4 v146, s[24:27], s50 offen offset:2048 lds
  buffer_load_dwordx4 v147, s[24:27], s50 offen offset:3072 lds
  s_add_u32 s49, s49, 1
  s_cmp_eq_u32 s49, 14
  s_cselect_b32 s49, 0, s49
  s_add_u32 m0, s71, 32768
  s_mul_i32 s50, s49, 28672
  buffer_load_dwordx4 v144, s[24:27], s50 offen offset:0 lds
  buffer_load_dwordx4 v145, s[24:27], s50 offen offset:1024 lds
  buffer_load_dwordx4 v146, s[24:27], s50 offen offset:2048 lds
  buffer_load_dwordx4 v147, s[24:27], s50 offen offset:3072 lds
  s_add_u32 s49, s49, 1
  s_cmp_eq_u32 s49, 14
  s_cselect_b32 s49, 0, s49
  s_add_u32 m0, s71, 36864
  s_mul_i32 s50, s49, 28672
  buffer_load_dwordx4 v144, s[24:27], s50 offen offset:0 lds
  buffer_load_dwordx4 v145, s[24:27], s50 offen offset:1024 lds
  buffer_load_dwordx4 v146, s[24:27], s50 offen offset:2048 lds
  buffer_load_dwordx4 v147, s[24:27], s50 offen offset:3072 lds
  v_mbcnt_lo_u32_b32 v156, -1, 0
  v_mbcnt_hi_u32_b32 v156, -1, v156
  v_bfe_u32 v157, v156, 4, 2
  v_lshlrev_b32 v152, 4, v156
  v_mov_b32 v243, v152
  s_add_u32 s73, s14, 0
  s_and_b32 s73, s73, 3
  s_mul_i32 s73, s73, 57344
  v_add_u32 v152, s73, v243
  s_add_u32 s73, s14, 1
  s_and_b32 s73, s73, 3
  s_mul_i32 s73, s73, 57344
  v_add_u32 v153, s73, v243
  s_add_u32 s73, s14, 2
  s_and_b32 s73, s73, 3
  s_mul_i32 s73, s73, 57344
  v_add_u32 v154, s73, v243
  s_add_u32 s73, s14, 3
  s_and_b32 s73, s73, 3
  s_mul_i32 s73, s73, 57344
  v_add_u32 v155, s73, v243
  s_mul_i32 s73, s69, 229376
  s_mul_i32 s74, s14, 14336
  s_add_u32 s73, s73, s74
  s_add_u32 s28, s10, 0x600000
  s_addc_u32 s29, s11, 0
  s_add_u32 s28, s28, s73
  s_addc_u32 s29, s29, 0
  s_and_b32 s29, s29, 0xffff
  s_mov_b32 s30, 0x0
  s_mov_b32 s31, 0x20000
  s_sub_u32 s30, 7340032, s73
  v_bfe_u32 v158, v156, 2, 4
  v_bfe_u32 v159, v158, 1, 2
  v_lshlrev_b32 v158, 7, v158
  v_and_b32 v136, 3, v156
  v_lshl_add_u32 v158, v136, 3, v158
  v_add_u32 v158, s71, v158
  v_xor_b32 v136, 0, v159
  v_lshl_add_u32 v148, v136, 5, v158
  v_xor_b32 v136, 1, v159
  v_lshl_add_u32 v149, v136, 5, v158
  v_xor_b32 v136, 2, v159
  v_lshl_add_u32 v150, v136, 5, v158
  v_xor_b32 v136, 3, v159
  v_lshl_add_u32 v151, v136, 5, v158
  s_mov_b32 s48, s72
  s_lshr_b32 s44, s69, 1
  s_lshl_b32 s44, s44, 7
  s_add_u32 s44, s44, 4096
  v_lshlrev_b32 v158, 2, v156
  v_add_u32 v158, s44, v158
  s_mov_b32 s74, 0x8000
  s_cmp_lg_u32 s14, 0
  s_cbranch_scc1 K2_c_pd
K2_c_pl:
  buffer_load_dword v159, v158, s[32:35], 0 offen sc1
  s_waitcnt vmcnt(0)
  v_cmp_eq_u32 vcc, s75, v159
  s_nop 1
  s_and_b32 s73, vcc_lo, 0x3fff
  s_cmp_eq_u32 s73, 0x3fff
  s_cbranch_scc1 K2_c_pd
  s_sleep 2
  s_sub_u32 s74, s74, 1
  s_cmp_lg_u32 s74, 0
  s_cbranch_scc1 K2_c_pl
K2_c_pd:
  s_waitcnt vmcnt(0)
  s_barrier
  s_lshl_b32 s51, s48, 10
  buffer_load_dwordx4 v[96:99], v152, s[28:31], s51 offen sc1
  buffer_load_dwordx4 v[100:103], v153, s[28:31], s51 offen sc1
  buffer_load_dwordx4 v[104:107], v154, s[28:31], s51 offen sc1
  buffer_load_dwordx4 v[108:111], v155, s[28:31], s51 offen sc1
  ds_read_b64_tr_b16 v[64:65], v148 offset:0
  ds_read_b64_tr_b16 v[66:67], v148 offset:2048
  ds_read_b64_tr_b16 v[68:69], v149 offset:0
  ds_read_b64_tr_b16 v[70:71], v149 offset:2048
  ds_read_b64_tr_b16 v[72:73], v150 offset:0
  ds_read_b64_tr_b16 v[74:75], v150 offset:2048
  ds_read_b64_tr_b16 v[76:77], v151 offset:0
  ds_read_b64_tr_b16 v[78:79], v151 offset:2048
  s_add_u32 s48, s48, 1
  s_cmp_eq_u32 s48, 14
  s_cselect_b32 s48, 0, s48
  s_lshl_b32 s51, s48, 10
  buffer_load_dwordx4 v[112:115], v152, s[28:31], s51 offen sc1
  buffer_load_dwordx4 v[116:119], v153, s[28:31], s51 offen sc1
  buffer_load_dwordx4 v[120:123], v154, s[28:31], s51 offen sc1
  buffer_load_dwordx4 v[124:127], v155, s[28:31], s51 offen sc1
  s_add_u32 s48, s48, 1
  s_cmp_eq_u32 s48, 14
  s_cselect_b32 s48, 0, s48
  s_lshl_b32 s51, s48, 10
  buffer_load_dwordx4 v[128:131], v152, s[28:31], s51 offen sc1
  buffer_load_dwordx4 v[132:135], v153, s[28:31], s51 offen sc1
  buffer_load_dwordx4 v[136:139], v154, s[28:31], s51 offen sc1
  buffer_load_dwordx4 v[140:143], v155, s[28:31], s51 offen sc1
  s_add_u32 s48, s48, 1
  s_cmp_eq_u32 s48, 14
  s_cselect_b32 s48, 0, s48
  s_lshl_b32 s51, s48, 10
  buffer_load_dwordx4 v[160:163], v152, s[28:31], s51 offen sc1
  buffer_load_dwordx4 v[164:167], v153, s[28:31], s51 offen sc1
  buffer_load_dwordx4 v[168:171], v154, s[28:31], s51 offen sc1
  buffer_load_dwordx4 v[172:175], v155, s[28:31], s51 offen sc1
  s_add_u32 s48, s48, 1
  s_cmp_eq_u32 s48, 14
  s_cselect_b32 s48, 0, s48
  s_lshl_b32 s51, s48, 10
  buffer_load_dwordx4 v[176:179], v152, s[28:31], s51 offen sc1
  buffer_load_dwordx4 v[180:183], v153, s[28:31], s51 offen sc1
  buffer_load_dwordx4 v[184:187], v154, s[28:31], s51 offen sc1
  buffer_load_dwordx4 v[188:191], v155, s[28:31], s51 offen sc1
  s_add_u32 s48, s48, 1
  s_cmp_eq_u32 s48, 14
  s_cselect_b32 s48, 0, s48
  s_lshl_b32 s51, s48, 10
  buffer_load_dwordx4 v[192:195], v152, s[28:31], s51 offen sc1
  buffer_load_dwordx4 v[196:199], v153, s[28:31], s51 offen sc1
  buffer_load_dwordx4 v[200:203], v154, s[28:31], s51 offen sc1
  buffer_load_dwordx4 v[204:207], v155, s[28:31], s51 offen sc1
  s_add_u32 s48, s48, 1
  s_cmp_eq_u32 s48, 14
  s_cselect_b32 s48, 0, s48
  s_lshl_b32 s51, s48, 10
  buffer_load_dwordx4 v[208:211], v152, s[28:31], s51 offen sc1
  buffer_load_dwordx4 v[212:215], v153, s[28:31], s51 offen sc1
  buffer_load_dwordx4 v[216:219], v154, s[28:31], s51 offen sc1
  buffer_load_dwordx4 v[220:223], v155, s[28:31], s51 offen sc1
  s_waitcnt vmcnt(20) lgkmcnt(0)
  v_mfma_f32_16x16x32_bf16 v[0:3], v[64:67], v[96:99], 0
  ds_read_b64_tr_b16 v[80:81], v148 offset:4096
  v_mfma_f32_16x16x32_bf16 v[4:7], v[64:67], v[100:103], 0
  ds_read_b64_tr_b16 v[82:83], v148 offset:6144
  v_mfma_f32_16x16x32_bf16 v[8:11], v[64:67], v[104:107], 0
  ds_read_b64_tr_b16 v[84:85], v149 offset:4096
  v_mfma_f32_16x16x32_bf16 v[12:15], v[64:67], v[108:111], 0
  ds_read_b64_tr_b16 v[86:87], v149 offset:6144
  v_mfma_f32_16x16x32_bf16 v[16:19], v[68:71], v[96:99], 0
  ds_read_b64_tr_b16 v[88:89], v150 offset:4096
  v_mfma_f32_16x16x32_bf16 v[20:23], v[68:71], v[100:103], 0
  ds_read_b64_tr_b16 v[90:91], v150 offset:6144
  v_mfma_f32_16x16x32_bf16 v[24:27], v[68:71], v[104:107], 0
  ds_read_b64_tr_b16 v[92:93], v151 offset:4096
  v_mfma_f32_16x16x32_bf16 v[28:31], v[68:71], v[108:111], 0
  ds_read_b64_tr_b16 v[94:95], v151 offset:6144
  v_mfma_f32_16x16x32_bf16 v[32:35], v[72:75], v[96:99], 0
  v_mfma_f32_16x16x32_bf16 v[36:39], v[72:75], v[100:103], 0
  s_add_u32 s48, s48, 1
  s_cmp_eq_u32 s48, 14
  s_cselect_b32 s48, 0, s48
  s_lshl_b32 s51, s48, 10
  buffer_load_dwordx4 v[224:227], v152, s[28:31], s51 offen sc1
  v_mfma_f32_16x16x32_bf16 v[40:43], v[72:75], v[104:107], 0
  v_mfma_f32_16x16x32_bf16 v[44:47], v[72:75], v[108:111], 0
  buffer_load_dwordx4 v[228:231], v153, s[28:31], s51 offen sc1
  v_mfma_f32_16x16x32_bf16 v[48:51], v[76:79], v[96:99], 0
  v_mfma_f32_16x16x32_bf16 v[52:55], v[76:79], v[100:103], 0
  buffer_load_dwordx4 v[232:235], v154, s[28:31], s51 offen sc1
  v_mfma_f32_16x16x32_bf16 v[56:59], v[76:79], v[104:107], 0
  v_mfma_f32_16x16x32_bf16 v[60:63], v[76:79], v[108:111], 0
  buffer_load_dwordx4 v[236:239], v155, s[28:31], s51 offen sc1
  s_waitcnt vmcnt(20) lgkmcnt(0)
  v_mfma_f32_16x16x32_bf16 v[0:3], v[80:83], v[112:115], v[0:3]
  ds_read_b64_tr_b16 v[64:65], v148 offset:8192
  s_add_u32 s49, s49, 1
  s_cmp_eq_u32 s49, 14
  s_cselect_b32 s49, 0, s49
  s_add_u32 m0, s71, 0
  s_mul_i32 s50, s49, 28672
  v_mfma_f32_16x16x32_bf16 v[4:7], v[80:83], v[116:119], v[4:7]
  ds_read_b64_tr_b16 v[66:67], v148 offset:10240
  v_mfma_f32_16x16x32_bf16 v[8:11], v[80:83], v[120:123], v[8:11]
  ds_read_b64_tr_b16 v[68:69], v149 offset:8192
  v_mfma_f32_16x16x32_bf16 v[12:15], v[80:83], v[124:127], v[12:15]
  ds_read_b64_tr_b16 v[70:71], v149 offset:10240
  v_mfma_f32_16x16x32_bf16 v[16:19], v[84:87], v[112:115], v[16:19]
  ds_read_b64_tr_b16 v[72:73], v150 offset:8192
  v_mfma_f32_16x16x32_bf16 v[20:23], v[84:87], v[116:119], v[20:23]
  ds_read_b64_tr_b16 v[74:75], v150 offset:10240
  v_mfma_f32_16x16x32_bf16 v[24:27], v[84:87], v[120:123], v[24:27]
  ds_read_b64_tr_b16 v[76:77], v151 offset:8192
  v_mfma_f32_16x16x32_bf16 v[28:31], v[84:87], v[124:127], v[28:31]
  ds_read_b64_tr_b16 v[78:79], v151 offset:10240
  v_mfma_f32_16x16x32_bf16 v[32:35], v[88:91], v[112:115], v[32:35]
  buffer_load_dwordx4 v144, s[24:27], s50 offen offset:0 lds
  v_mfma_f32_16x16x32_bf16 v[36:39], v[88:91], v[116:119], v[36:39]
  s_add_u32 s48, s48, 1
  s_cmp_eq_u32 s48, 14
  s_cselect_b32 s48, 0, s48
  s_lshl_b32 s51, s48, 10
  buffer_load_dwordx4 v[96:99], v152, s[28:31], s51 offen sc1
  v_mfma_f32_16x16x32_bf16 v[40:43], v[88:91], v[120:123], v[40:43]
  buffer_load_dwordx4 v145, s[24:27], s50 offen offset:1024 lds
  v_mfma_f32_16x16x32_bf16 v[44:47], v[88:91], v[124:127], v[44:47]
  buffer_load_dwordx4 v[100:103], v153, s[28:31], s51 offen sc1
  v_mfma_f32_16x16x32_bf16 v[48:51], v[92:95], v[112:115], v[48:51]
  buffer_load_dwordx4 v146, s[24:27], s50 offen offset:2048 lds
  v_mfma_f32_16x16x32_bf16 v[52:55], v[92:95], v[116:119], v[52:55]
  buffer_load_dwordx4 v[104:107], v154, s[28:31], s51 offen sc1
  v_mfma_f32_16x16x32_bf16 v[56:59], v[92:95], v[120:123], v[56:59]
  buffer_load_dwordx4 v147, s[24:27], s50 offen offset:3072 lds
  v_mfma_f32_16x16x32_bf16 v[60:63], v[92:95], v[124:127], v[60:63]
  buffer_load_dwordx4 v[108:111], v155, s[28:31], s51 offen sc1
  s_waitcnt vmcnt(24) lgkmcnt(0)
  v_mfma_f32_16x16x32_bf16 v[0:3], v[64:67], v[128:131], v[0:3]
  ds_read_b64_tr_b16 v[80:81], v148 offset:12288
  s_add_u32 s49, s49, 1
  s_cmp_eq_u32 s49, 14
  s_cselect_b32 s49, 0, s49
  s_add_u32 m0, s71, 4096
  s_mul_i32 s50, s49, 28672
  v_mfma_f32_16x16x32_bf16 v[4:7], v[64:67], v[132:135], v[4:7]
  ds_read_b64_tr_b16 v[82:83], v148 offset:14336
  v_mfma_f32_16x16x32_bf16 v[8:11], v[64:67], v[136:139], v[8:11]
  ds_read_b64_tr_b16 v[84:85], v149 offset:12288
  v_mfma_f32_16x16x32_bf16 v[12:15], v[64:67], v[140:143], v[12:15]
  ds_read_b64_tr_b16 v[86:87], v149 offset:14336
  v_mfma_f32_16x16x32_bf16 v[16:19], v[68:71], v[128:131], v[16:19]
  ds_read_b64_tr_b16 v[88:89], v150 offset:12288
  v_mfma_f32_16x16x32_bf16 v[20:23], v[68:71], v[132:135], v[20:23]
  ds_read_b64_tr_b16 v[90:91], v150 offset:14336
  v_mfma_f32_16x16x32_bf16 v[24:27], v[68:71], v[136:139], v[24:27]
  ds_read_b64_tr_b16 v[92:93], v151 offset:12288
  v_mfma_f32_16x16x32_bf16 v[28:31], v[68:71], v[140:143], v[28:31]
  ds_read_b64_tr_b16 v[94:95], v151 offset:14336
  v_mfma_f32_16x16x32_bf16 v[32:35], v[72:75], v[128:131], v[32:35]
  buffer_load_dwordx4 v144, s[24:27], s50 offen offset:0 lds
  v_mfma_f32_16x16x32_bf16 v[36:39], v[72:75], v[132:135], v[36:39]
  s_add_u32 s48, s48, 1
  s_cmp_eq_u32 s48, 14
  s_cselect_b32 s48, 0, s48
  s_lshl_b32 s51, s48, 10
  buffer_load_dwordx4 v[112:115], v152, s[28:31], s51 offen sc1
  v_mfma_f32_16x16x32_bf16 v[40:43], v[72:75], v[136:139], v[40:43]
  buffer_load_dwordx4 v145, s[24:27], s50 offen offset:1024 lds
  v_mfma_f32_16x16x32_bf16 v[44:47], v[72:75], v[140:143], v[44:47]
  buffer_load_dwordx4 v[116:119], v153, s[28:31], s51 offen sc1
  v_mfma_f32_16x16x32_bf16 v[48:51], v[76:79], v[128:131], v[48:51]
  buffer_load_dwordx4 v146, s[24:27], s50 offen offset:2048 lds
  v_mfma_f32_16x16x32_bf16 v[52:55], v[76:79], v[132:135], v[52:55]
  buffer_load_dwordx4 v[120:123], v154, s[28:31], s51 offen sc1
  v_mfma_f32_16x16x32_bf16 v[56:59], v[76:79], v[136:139], v[56:59]
  buffer_load_dwordx4 v147, s[24:27], s50 offen offset:3072 lds
  v_mfma_f32_16x16x32_bf16 v[60:63], v[76:79], v[140:143], v[60:63]
  buffer_load_dwordx4 v[124:127], v155, s[28:31], s51 offen sc1
  s_waitcnt vmcnt(28) lgkmcnt(0)
  v_mfma_f32_16x16x32_bf16 v[0:3], v[80:83], v[160:163], v[0:3]
  ds_read_b64_tr_b16 v[64:65], v148 offset:16384
  s_add_u32 s49, s49, 1
  s_cmp_eq_u32 s49, 14
  s_cselect_b32 s49, 0, s49
  s_add_u32 m0, s71, 8192
  s_mul_i32 s50, s49, 28672
  v_mfma_f32_16x16x32_bf16 v[4:7], v[80:83], v[164:167], v[4:7]
  ds_read_b64_tr_b16 v[66:67], v148 offset:18432
  v_mfma_f32_16x16x32_bf16 v[8:11], v[80:83], v[168:171], v[8:11]
  ds_read_b64_tr_b16 v[68:69], v149 offset:16384
  v_mfma_f32_16x16x32_bf16 v[12:15], v[80:83], v[172:175], v[12:15]
  ds_read_b64_tr_b16 v[70:71], v149 offset:18432
  v_mfma_f32_16x16x32_bf16 v[16:19], v[84:87], v[160:163], v[16:19]
  ds_read_b64_tr_b16 v[72:73], v150 offset:16384
  v_mfma_f32_16x16x32_bf16 v[20:23], v[84:87], v[164:167], v[20:23]
  ds_read_b64_tr_b16 v[74:75], v150 offset:18432
  v_mfma_f32_16x16x32_bf16 v[24:27], v[84:87], v[168:171], v[24:27]
  ds_read_b64_tr_b16 v[76:77], v151 offset:16384
  v_mfma_f32_16x16x32_bf16 v[28:31], v[84:87], v[172:175], v[28:31]
  ds_read_b64_tr_b16 v[78:79], v151 offset:18432
  v_mfma_f32_16x16x32_bf16 v[32:35], v[88:91], v[160:163], v[32:35]
  buffer_load_dwordx4 v144, s[24:27], s50 offen offset:0 lds
  v_mfma_f32_16x16x32_bf16 v[36:39], v[88:91], v[164:167], v[36:39]
  s_add_u32 s48, s48, 1
  s_cmp_eq_u32 s48, 14
  s_cselect_b32 s48, 0, s48
  s_lshl_b32 s51, s48, 10
  buffer_load_dwordx4 v[128:131], v152, s[28:31], s51 offen sc1
  v_mfma_f32_16x16x32_bf16 v[40:43], v[88:91], v[168:171], v[40:43]
  buffer_load_dwordx4 v145, s[24:27], s50 offen offset:1024 lds
  v_mfma_f32_16x16x32_bf16 v[44:47], v[88:91], v[172:175], v[44:47]
  buffer_load_dwordx4 v[132:135], v153, s[28:31], s51 offen sc1
  v_mfma_f32_16x16x32_bf16 v[48:51], v[92:95], v[160:163], v[48:51]
  buffer_load_dwordx4 v146, s[24:27], s50 offen offset:2048 lds
  v_mfma_f32_16x16x32_bf16 v[52:55], v[92:95], v[164:167], v[52:55]
  buffer_load_dwordx4 v[136:139], v154, s[28:31], s51 offen sc1
  v_mfma_f32_16x16x32_bf16 v[56:59], v[92:95], v[168:171], v[56:59]
  buffer_load_dwordx4 v147, s[24:27], s50 offen offset:3072 lds
  v_mfma_f32_16x16x32_bf16 v[60:63], v[92:95], v[172:175], v[60:63]
  buffer_load_dwordx4 v[140:143], v155, s[28:31], s51 offen sc1
  s_waitcnt vmcnt(32) lgkmcnt(0)
  v_mfma_f32_16x16x32_bf16 v[0:3], v[64:67], v[176:179], v[0:3]
  ds_read_b64_tr_b16 v[80:81], v148 offset:20480
  s_add_u32 s49, s49, 1
  s_cmp_eq_u32 s49, 14
  s_cselect_b32 s49, 0, s49
  s_add_u32 m0, s71, 12288
  s_mul_i32 s50, s49, 28672
  v_mfma_f32_16x16x32_bf16 v[4:7], v[64:67], v[180:183], v[4:7]
  ds_read_b64_tr_b16 v[82:83], v148 offset:22528
  v_mfma_f32_16x16x32_bf16 v[8:11], v[64:67], v[184:187], v[8:11]
  ds_read_b64_tr_b16 v[84:85], v149 offset:20480
  v_mfma_f32_16x16x32_bf16 v[12:15], v[64:67], v[188:191], v[12:15]
  ds_read_b64_tr_b16 v[86:87], v149 offset:22528
  v_mfma_f32_16x16x32_bf16 v[16:19], v[68:71], v[176:179], v[16:19]
  ds_read_b64_tr_b16 v[88:89], v150 offset:20480
  v_mfma_f32_16x16x32_bf16 v[20:23], v[68:71], v[180:183], v[20:23]
  ds_read_b64_tr_b16 v[90:91], v150 offset:22528
  v_mfma_f32_16x16x32_bf16 v[24:27], v[68:71], v[184:187], v[24:27]
  ds_read_b64_tr_b16 v[92:93], v151 offset:20480
  v_mfma_f32_16x16x32_bf16 v[28:31], v[68:71], v[188:191], v[28:31]
  ds_read_b64_tr_b16 v[94:95], v151 offset:22528
  v_mfma_f32_16x16x32_bf16 v[32:35], v[72:75], v[176:179], v[32:35]
  buffer_load_dwordx4 v144, s[24:27], s50 offen offset:0 lds
  v_mfma_f32_16x16x32_bf16 v[36:39], v[72:75], v[180:183], v[36:39]
  s_add_u32 s48, s48, 1
  s_cmp_eq_u32 s48, 14
  s_cselect_b32 s48, 0, s48
  s_lshl_b32 s51, s48, 10
  buffer_load_dwordx4 v[160:163], v152, s[28:31], s51 offen sc1
  v_mfma_f32_16x16x32_bf16 v[40:43], v[72:75], v[184:187], v[40:43]
  buffer_load_dwordx4 v145, s[24:27], s50 offen offset:1024 lds
  v_mfma_f32_16x16x32_bf16 v[44:47], v[72:75], v[188:191], v[44:47]
  buffer_load_dwordx4 v[164:167], v153, s[28:31], s51 offen sc1
  v_mfma_f32_16x16x32_bf16 v[48:51], v[76:79], v[176:179], v[48:51]
  buffer_load_dwordx4 v146, s[24:27], s50 offen offset:2048 lds
  v_mfma_f32_16x16x32_bf16 v[52:55], v[76:79], v[180:183], v[52:55]
  buffer_load_dwordx4 v[168:171], v154, s[28:31], s51 offen sc1
  v_mfma_f32_16x16x32_bf16 v[56:59], v[76:79], v[184:187], v[56:59]
  buffer_load_dwordx4 v147, s[24:27], s50 offen offset:3072 lds
  v_mfma_f32_16x16x32_bf16 v[60:63], v[76:79], v[188:191], v[60:63]
  buffer_load_dwordx4 v[172:175], v155, s[28:31], s51 offen sc1
  s_waitcnt vmcnt(36) lgkmcnt(0)
  v_mfma_f32_16x16x32_bf16 v[0:3], v[80:83], v[192:195], v[0:3]
  ds_read_b64_tr_b16 v[64:65], v148 offset:24576
  v_mfma_f32_16x16x32_bf16 v[4:7], v[80:83], v[196:199], v[4:7]
  ds_read_b64_tr_b16 v[66:67], v148 offset:26624
  v_mfma_f32_16x16x32_bf16 v[8:11], v[80:83], v[200:203], v[8:11]
  ds_read_b64_tr_b16 v[68:69], v149 offset:24576
  v_mfma_f32_16x16x32_bf16 v[12:15], v[80:83], v[204:207], v[12:15]
  ds_read_b64_tr_b16 v[70:71], v149 offset:26624
  v_mfma_f32_16x16x32_bf16 v[16:19], v[84:87], v[192:195], v[16:19]
  ds_read_b64_tr_b16 v[72:73], v150 offset:24576
  v_mfma_f32_16x16x32_bf16 v[20:23], v[84:87], v[196:199], v[20:23]
  ds_read_b64_tr_b16 v[74:75], v150 offset:26624
  v_mfma_f32_16x16x32_bf16 v[24:27], v[84:87], v[200:203], v[24:27]
  ds_read_b64_tr_b16 v[76:77], v151 offset:24576
  v_mfma_f32_16x16x32_bf16 v[28:31], v[84:87], v[204:207], v[28:31]
  ds_read_b64_tr_b16 v[78:79], v151 offset:26624
  v_mfma_f32_16x16x32_bf16 v[32:35], v[88:91], v[192:195], v[32:35]
  v_mfma_f32_16x16x32_bf16 v[36:39], v[88:91], v[196:199], v[36:39]
  s_add_u32 s48, s48, 1
  s_cmp_eq_u32 s48, 14
  s_cselect_b32 s48, 0, s48
  s_lshl_b32 s51, s48, 10
  buffer_load_dwordx4 v[176:179], v152, s[28:31], s51 offen sc1
  v_mfma_f32_16x16x32_bf16 v[40:43], v[88:91], v[200:203], v[40:43]
  v_mfma_f32_16x16x32_bf16 v[44:47], v[88:91], v[204:207], v[44:47]
  buffer_load_dwordx4 v[180:183], v153, s[28:31], s51 offen sc1
  v_mfma_f32_16x16x32_bf16 v[48:51], v[92:95], v[192:195], v[48:51]
  v_mfma_f32_16x16x32_bf16 v[52:55], v[92:95], v[196:199], v[52:55]
  buffer_load_dwordx4 v[184:187], v154, s[28:31], s51 offen sc1
  v_mfma_f32_16x16x32_bf16 v[56:59], v[92:95], v[200:203], v[56:59]
  v_mfma_f32_16x16x32_bf16 v[60:63], v[92:95], v[204:207], v[60:63]
  buffer_load_dwordx4 v[188:191], v155, s[28:31], s51 offen sc1
  s_waitcnt vmcnt(36) lgkmcnt(0)
  v_mfma_f32_16x16x32_bf16 v[0:3], v[64:67], v[208:211], v[0:3]
  ds_read_b64_tr_b16 v[80:81], v148 offset:28672
  v_mfma_f32_16x16x32_bf16 v[4:7], v[64:67], v[212:215], v[4:7]
  ds_read_b64_tr_b16 v[82:83], v148 offset:30720
  v_mfma_f32_16x16x32_bf16 v[8:11], v[64:67], v[216:219], v[8:11]
  ds_read_b64_tr_b16 v[84:85], v149 offset:28672
  v_mfma_f32_16x16x32_bf16 v[12:15], v[64:67], v[220:223], v[12:15]
  ds_read_b64_tr_b16 v[86:87], v149 offset:30720
  v_mfma_f32_16x16x32_bf16 v[16:19], v[68:71], v[208:211], v[16:19]
  ds_read_b64_tr_b16 v[88:89], v150 offset:28672
  v_mfma_f32_16x16x32_bf16 v[20:23], v[68:71], v[212:215], v[20:23]
  ds_read_b64_tr_b16 v[90:91], v150 offset:30720
  v_mfma_f32_16x16x32_bf16 v[24:27], v[68:71], v[216:219], v[24:27]
  ds_read_b64_tr_b16 v[92:93], v151 offset:28672
  v_mfma_f32_16x16x32_bf16 v[28:31], v[68:71], v[220:223], v[28:31]
  ds_read_b64_tr_b16 v[94:95], v151 offset:30720
  v_mfma_f32_16x16x32_bf16 v[32:35], v[72:75], v[208:211], v[32:35]
  v_mfma_f32_16x16x32_bf16 v[36:39], v[72:75], v[212:215], v[36:39]
  s_add_u32 s48, s48, 1
  s_cmp_eq_u32 s48, 14
  s_cselect_b32 s48, 0, s48
  s_lshl_b32 s51, s48, 10
  buffer_load_dwordx4 v[192:195], v152, s[28:31], s51 offen sc1
  v_mfma_f32_16x16x32_bf16 v[40:43], v[72:75], v[216:219], v[40:43]
  v_mfma_f32_16x16x32_bf16 v[44:47], v[72:75], v[220:223], v[44:47]
  buffer_load_dwordx4 v[196:199], v153, s[28:31], s51 offen sc1
  v_mfma_f32_16x16x32_bf16 v[48:51], v[76:79], v[208:211], v[48:51]
  v_mfma_f32_16x16x32_bf16 v[52:55], v[76:79], v[212:215], v[52:55]
  buffer_load_dwordx4 v[200:203], v154, s[28:31], s51 offen sc1
  v_mfma_f32_16x16x32_bf16 v[56:59], v[76:79], v[216:219], v[56:59]
  v_mfma_f32_16x16x32_bf16 v[60:63], v[76:79], v[220:223], v[60:63]
  buffer_load_dwordx4 v[204:207], v155, s[28:31], s51 offen sc1
  s_waitcnt vmcnt(32) lgkmcnt(0)
  v_mfma_f32_16x16x32_bf16 v[0:3], v[80:83], v[224:227], v[0:3]
  ds_read_b64_tr_b16 v[64:65], v148 offset:32768
  v_mfma_f32_16x16x32_bf16 v[4:7], v[80:83], v[228:231], v[4:7]
  ds_read_b64_tr_b16 v[66:67], v148 offset:34816
  v_mfma_f32_16x16x32_bf16 v[8:11], v[80:83], v[232:235], v[8:11]
  ds_read_b64_tr_b16 v[68:69], v149 offset:32768
  v_mfma_f32_16x16x32_bf16 v[12:15], v[80:83], v[236:239], v[12:15]
  ds_read_b64_tr_b16 v[70:71], v149 offset:34816
  v_mfma_f32_16x16x32_bf16 v[16:19], v[84:87], v[224:227], v[16:19]
  ds_read_b64_tr_b16 v[72:73], v150 offset:32768
  v_mfma_f32_16x16x32_bf16 v[20:23], v[84:87], v[228:231], v[20:23]
  ds_read_b64_tr_b16 v[74:75], v150 offset:34816
  v_mfma_f32_16x16x32_bf16 v[24:27], v[84:87], v[232:235], v[24:27]
  ds_read_b64_tr_b16 v[76:77], v151 offset:32768
  v_mfma_f32_16x16x32_bf16 v[28:31], v[84:87], v[236:239], v[28:31]
  ds_read_b64_tr_b16 v[78:79], v151 offset:34816
  v_mfma_f32_16x16x32_bf16 v[32:35], v[88:91], v[224:227], v[32:35]
  v_mfma_f32_16x16x32_bf16 v[36:39], v[88:91], v[228:231], v[36:39]
  v_mfma_f32_16x16x32_bf16 v[40:43], v[88:91], v[232:235], v[40:43]
  v_mfma_f32_16x16x32_bf16 v[44:47], v[88:91], v[236:239], v[44:47]
  v_mfma_f32_16x16x32_bf16 v[48:51], v[92:95], v[224:227], v[48:51]
  v_mfma_f32_16x16x32_bf16 v[52:55], v[92:95], v[228:231], v[52:55]
  v_mfma_f32_16x16x32_bf16 v[56:59], v[92:95], v[232:235], v[56:59]
  v_mfma_f32_16x16x32_bf16 v[60:63], v[92:95], v[236:239], v[60:63]
  v_and_b32 v245, 15, v156
  s_lshl_b32 s52, s69, 6
  s_lshl_b32 s53, s14, 4
  s_add_u32 s52, s52, s53
  s_lshl_b32 s44, s70, 8
  s_mov_b32 s20, s10
  s_mov_b32 s21, s11
  s_and_b32 s21, s21, 0xffff
  s_mov_b32 s22, 0x2a00
  s_mov_b32 s23, 0x20000
  v_lshlrev_b32 v246, 4, v157
  s_add_u32 s47, s44, 8960
  buffer_load_dwordx4 v[208:211], v246, s[20:23], s47 offen offset:0 sc1
  buffer_load_dwordx4 v[212:215], v246, s[20:23], s47 offen offset:64 sc1
  buffer_load_dwordx4 v[216:219], v246, s[20:23], s47 offen offset:128 sc1
  buffer_load_dwordx4 v[220:223], v246, s[20:23], s47 offen offset:192 sc1
  s_waitcnt vmcnt(28) lgkmcnt(0)
  v_mfma_f32_16x16x32_bf16 v[0:3], v[64:67], v[96:99], v[0:3]
  ds_read_b64_tr_b16 v[80:81], v148 offset:36864
  v_mfma_f32_16x16x32_bf16 v[4:7], v[64:67], v[100:103], v[4:7]
  ds_read_b64_tr_b16 v[82:83], v148 offset:38912
  v_mfma_f32_16x16x32_bf16 v[8:11], v[64:67], v[104:107], v[8:11]
  ds_read_b64_tr_b16 v[84:85], v149 offset:36864
  v_mfma_f32_16x16x32_bf16 v[12:15], v[64:67], v[108:111], v[12:15]
  ds_read_b64_tr_b16 v[86:87], v149 offset:38912
  v_mfma_f32_16x16x32_bf16 v[16:19], v[68:71], v[96:99], v[16:19]
  ds_read_b64_tr_b16 v[88:89], v150 offset:36864
  v_mfma_f32_16x16x32_bf16 v[20:23], v[68:71], v[100:103], v[20:23]
  ds_read_b64_tr_b16 v[90:91], v150 offset:38912
  v_mfma_f32_16x16x32_bf16 v[24:27], v[68:71], v[104:107], v[24:27]
  ds_read_b64_tr_b16 v[92:93], v151 offset:36864
  v_mfma_f32_16x16x32_bf16 v[28:31], v[68:71], v[108:111], v[28:31]
  ds_read_b64_tr_b16 v[94:95], v151 offset:38912
  v_mfma_f32_16x16x32_bf16 v[32:35], v[72:75], v[96:99], v[32:35]
  v_mfma_f32_16x16x32_bf16 v[36:39], v[72:75], v[100:103], v[36:39]
  v_mfma_f32_16x16x32_bf16 v[40:43], v[72:75], v[104:107], v[40:43]
  v_mfma_f32_16x16x32_bf16 v[44:47], v[72:75], v[108:111], v[44:47]
  v_mfma_f32_16x16x32_bf16 v[48:51], v[76:79], v[96:99], v[48:51]
  v_mfma_f32_16x16x32_bf16 v[52:55], v[76:79], v[100:103], v[52:55]
  v_mfma_f32_16x16x32_bf16 v[56:59], v[76:79], v[104:107], v[56:59]
  v_mfma_f32_16x16x32_bf16 v[60:63], v[76:79], v[108:111], v[60:63]
  s_waitcnt vmcnt(20) lgkmcnt(0)
  v_mfma_f32_16x16x32_bf16 v[0:3], v[80:83], v[112:115], v[0:3]
  ds_read_b64_tr_b16 v[64:65], v148 offset:0
  v_mfma_f32_16x16x32_bf16 v[4:7], v[80:83], v[116:119], v[4:7]
  ds_read_b64_tr_b16 v[66:67], v148 offset:2048
  v_mfma_f32_16x16x32_bf16 v[8:11], v[80:83], v[120:123], v[8:11]
  ds_read_b64_tr_b16 v[68:69], v149 offset:0
  v_mfma_f32_16x16x32_bf16 v[12:15], v[80:83], v[124:127], v[12:15]
  ds_read_b64_tr_b16 v[70:71], v149 offset:2048
  v_mfma_f32_16x16x32_bf16 v[16:19], v[84:87], v[112:115], v[16:19]
  ds_read_b64_tr_b16 v[72:73], v150 offset:0
  v_mfma_f32_16x16x32_bf16 v[20:23], v[84:87], v[116:119], v[20:23]
  ds_read_b64_tr_b16 v[74:75], v150 offset:2048
  v_mfma_f32_16x16x32_bf16 v[24:27], v[84:87], v[120:123], v[24:27]
  ds_read_b64_tr_b16 v[76:77], v151 offset:0
  v_mfma_f32_16x16x32_bf16 v[28:31], v[84:87], v[124:127], v[28:31]
  ds_read_b64_tr_b16 v[78:79], v151 offset:2048
  v_mfma_f32_16x16x32_bf16 v[32:35], v[88:91], v[112:115], v[32:35]
  v_mfma_f32_16x16x32_bf16 v[36:39], v[88:91], v[116:119], v[36:39]
  v_mfma_f32_16x16x32_bf16 v[40:43], v[88:91], v[120:123], v[40:43]
  v_mfma_f32_16x16x32_bf16 v[44:47], v[88:91], v[124:127], v[44:47]
  v_mfma_f32_16x16x32_bf16 v[48:51], v[92:95], v[112:115], v[48:51]
  v_mfma_f32_16x16x32_bf16 v[52:55], v[92:95], v[116:119], v[52:55]
  v_mfma_f32_16x16x32_bf16 v[56:59], v[92:95], v[120:123], v[56:59]
  v_mfma_f32_16x16x32_bf16 v[60:63], v[92:95], v[124:127], v[60:63]
  s_lshr_b32 s56, s52, 4
  s_mul_i32 s56, s56, 14336
  s_lshl_b32 s57, s70, 11
  s_add_u32 s56, s56, s57
  s_mul_i32 s58, s52, 896
  s_lshl_b32 s57, s70, 7
  s_add_u32 s58, s58, s57
  v_mul_u32_u24 v247, 896, v245
  v_and_b32 v244, 1, v157
  v_lshl_add_u32 v247, v244, 5, v247
  v_lshrrev_b32 v244, 1, v157
  v_lshl_add_u32 v247, v244, 4, v247
  s_mov_b32 s16, s66
  s_mov_b32 s17, s67
  s_and_b32 s17, s17, 0xffff
  s_mov_b32 s18, 0x1c0000
  s_mov_b32 s19, 0x20000
  s_waitcnt vmcnt(12) lgkmcnt(0)
  v_mfma_f32_16x16x32_bf16 v[0:3], v[64:67], v[128:131], v[0:3]
  ds_read_b64_tr_b16 v[80:81], v148 offset:4096
  v_mfma_f32_16x16x32_bf16 v[4:7], v[64:67], v[132:135], v[4:7]
  ds_read_b64_tr_b16 v[82:83], v148 offset:6144
  v_mfma_f32_16x16x32_bf16 v[8:11], v[64:67], v[136:139], v[8:11]
  ds_read_b64_tr_b16 v[84:85], v149 offset:4096
  v_mfma_f32_16x16x32_bf16 v[12:15], v[64:67], v[140:143], v[12:15]
  ds_read_b64_tr_b16 v[86:87], v149 offset:6144
  v_mfma_f32_16x16x32_bf16 v[16:19], v[68:71], v[128:131], v[16:19]
  ds_read_b64_tr_b16 v[88:89], v150 offset:4096
  v_mfma_f32_16x16x32_bf16 v[20:23], v[68:71], v[132:135], v[20:23]
  ds_read_b64_tr_b16 v[90:91], v150 offset:6144
  v_mfma_f32_16x16x32_bf16 v[24:27], v[68:71], v[136:139], v[24:27]
  ds_read_b64_tr_b16 v[92:93], v151 offset:4096
  v_mfma_f32_16x16x32_bf16 v[28:31], v[68:71], v[140:143], v[28:31]
  ds_read_b64_tr_b16 v[94:95], v151 offset:6144
  v_mfma_f32_16x16x32_bf16 v[32:35], v[72:75], v[128:131], v[32:35]
  v_mfma_f32_16x16x32_bf16 v[36:39], v[72:75], v[132:135], v[36:39]
  v_mfma_f32_16x16x32_bf16 v[40:43], v[72:75], v[136:139], v[40:43]
  v_mfma_f32_16x16x32_bf16 v[44:47], v[72:75], v[140:143], v[44:47]
  v_mfma_f32_16x16x32_bf16 v[48:51], v[76:79], v[128:131], v[48:51]
  v_mfma_f32_16x16x32_bf16 v[52:55], v[76:79], v[132:135], v[52:55]
  v_mfma_f32_16x16x32_bf16 v[56:59], v[76:79], v[136:139], v[56:59]
  v_mfma_f32_16x16x32_bf16 v[60:63], v[76:79], v[140:143], v[60:63]
  s_waitcnt vmcnt(8) lgkmcnt(0)
  v_mfma_f32_16x16x32_bf16 v[0:3], v[80:83], v[160:163], v[0:3]
  ds_read_b64_tr_b16 v[64:65], v148 offset:8192
  v_mfma_f32_16x16x32_bf16 v[4:7], v[80:83], v[164:167], v[4:7]
  ds_read_b64_tr_b16 v[66:67], v148 offset:10240
  v_mfma_f32_16x16x32_bf16 v[8:11], v[80:83], v[168:171], v[8:11]
  ds_read_b64_tr_b16 v[68:69], v149 offset:8192
  v_mfma_f32_16x16x32_bf16 v[12:15], v[80:83], v[172:175], v[12:15]
  ds_read_b64_tr_b16 v[70:71], v149 offset:10240
  v_mfma_f32_16x16x32_bf16 v[16:19], v[84:87], v[160:163], v[16:19]
  ds_read_b64_tr_b16 v[72:73], v150 offset:8192
  v_mfma_f32_16x16x32_bf16 v[20:23], v[84:87], v[164:167], v[20:23]
  ds_read_b64_tr_b16 v[74:75], v150 offset:10240
  v_mfma_f32_16x16x32_bf16 v[24:27], v[84:87], v[168:171], v[24:27]
  ds_read_b64_tr_b16 v[76:77], v151 offset:8192
  v_mfma_f32_16x16x32_bf16 v[28:31], v[84:87], v[172:175], v[28:31]
  ds_read_b64_tr_b16 v[78:79], v151 offset:10240
  v_mfma_f32_16x16x32_bf16 v[32:35], v[88:91], v[160:163], v[32:35]
  v_mfma_f32_16x16x32_bf16 v[36:39], v[88:91], v[164:167], v[36:39]
  v_mfma_f32_16x16x32_bf16 v[40:43], v[88:91], v[168:171], v[40:43]
  v_mfma_f32_16x16x32_bf16 v[44:47], v[88:91], v[172:175], v[44:47]
  v_mfma_f32_16x16x32_bf16 v[48:51], v[92:95], v[160:163], v[48:51]
  v_mfma_f32_16x16x32_bf16 v[52:55], v[92:95], v[164:167], v[52:55]
  v_mfma_f32_16x16x32_bf16 v[56:59], v[92:95], v[168:171], v[56:59]
  v_mfma_f32_16x16x32_bf16 v[60:63], v[92:95], v[172:175], v[60:63]
  s_waitcnt vmcnt(4) lgkmcnt(0)
  v_mfma_f32_16x16x32_bf16 v[0:3], v[64:67], v[176:179], v[0:3]
  ds_read_b64_tr_b16 v[80:81], v148 offset:12288
  v_mfma_f32_16x16x32_bf16 v[4:7], v[64:67], v[180:183], v[4:7]
  ds_read_b64_tr_b16 v[82:83], v148 offset:14336
  v_mfma_f32_16x16x32_bf16 v[8:11], v[64:67], v[184:187], v[8:11]
  ds_read_b64_tr_b16 v[84:85], v149 offset:12288
  v_mfma_f32_16x16x32_bf16 v[12:15], v[64:67], v[188:191], v[12:15]
  ds_read_b64_tr_b16 v[86:87], v149 offset:14336
  v_mfma_f32_16x16x32_bf16 v[16:19], v[68:71], v[176:179], v[16:19]
  ds_read_b64_tr_b16 v[88:89], v150 offset:12288
  v_mfma_f32_16x16x32_bf16 v[20:23], v[68:71], v[180:183], v[20:23]
  ds_read_b64_tr_b16 v[90:91], v150 offset:14336
  v_mfma_f32_16x16x32_bf16 v[24:27], v[68:71], v[184:187], v[24:27]
  ds_read_b64_tr_b16 v[92:93], v151 offset:12288
  v_mfma_f32_16x16x32_bf16 v[28:31], v[68:71], v[188:191], v[28:31]
  ds_read_b64_tr_b16 v[94:95], v151 offset:14336
  v_mfma_f32_16x16x32_bf16 v[32:35], v[72:75], v[176:179], v[32:35]
  v_mfma_f32_16x16x32_bf16 v[36:39], v[72:75], v[180:183], v[36:39]
  v_mfma_f32_16x16x32_bf16 v[40:43], v[72:75], v[184:187], v[40:43]
  v_mfma_f32_16x16x32_bf16 v[44:47], v[72:75], v[188:191], v[44:47]
  v_mfma_f32_16x16x32_bf16 v[48:51], v[76:79], v[176:179], v[48:51]
  v_mfma_f32_16x16x32_bf16 v[52:55], v[76:79], v[180:183], v[52:55]
  v_mfma_f32_16x16x32_bf16 v[56:59], v[76:79], v[184:187], v[56:59]
  v_mfma_f32_16x16x32_bf16 v[60:63], v[76:79], v[188:191], v[60:63]
  s_waitcnt lgkmcnt(0)
  v_mfma_f32_16x16x32_bf16 v[0:3], v[80:83], v[192:195], v[0:3]
  v_mfma_f32_16x16x32_bf16 v[4:7], v[80:83], v[196:199], v[4:7]
  v_mfma_f32_16x16x32_bf16 v[8:11], v[80:83], v[200:203], v[8:11]
  v_mfma_f32_16x16x32_bf16 v[12:15], v[80:83], v[204:207], v[12:15]
  v_mfma_f32_16x16x32_bf16 v[16:19], v[84:87], v[192:195], v[16:19]
  v_mfma_f32_16x16x32_bf16 v[20:23], v[84:87], v[196:199], v[20:23]
  v_mfma_f32_16x16x32_bf16 v[24:27], v[84:87], v[200:203], v[24:27]
  v_mfma_f32_16x16x32_bf16 v[28:31], v[84:87], v[204:207], v[28:31]
  v_mfma_f32_16x16x32_bf16 v[32:35], v[88:91], v[192:195], v[32:35]
  v_mfma_f32_16x16x32_bf16 v[36:39], v[88:91], v[196:199], v[36:39]
  v_mfma_f32_16x16x32_bf16 v[40:43], v[88:91], v[200:203], v[40:43]
  v_mfma_f32_16x16x32_bf16 v[44:47], v[88:91], v[204:207], v[44:47]
  v_mfma_f32_16x16x32_bf16 v[48:51], v[92:95], v[192:195], v[48:51]
  v_mfma_f32_16x16x32_bf16 v[52:55], v[92:95], v[196:199], v[52:55]
  v_mfma_f32_16x16x32_bf16 v[56:59], v[92:95], v[200:203], v[56:59]
  v_mfma_f32_16x16x32_bf16 v[60:63], v[92:95], v[204:207], v[60:63]
  v_add_u32 v248, s71, v243
  s_sub_u32 s59, s14, 1
  s_and_b32 s59, s59, 3
  s_mul_i32 s73, s59, 40960
  v_add_u32 v249, s73, v243
  s_sub_u32 s59, s14, 2
  s_and_b32 s59, s59, 3
  s_mul_i32 s73, s59, 40960
  v_add_u32 v250, s73, v243
  s_sub_u32 s59, s14, 3
  s_and_b32 s59, s59, 3
  s_mul_i32 s73, s59, 40960
  v_add_u32 v251, s73, v243
  ds_write_b128 v248, v[4:7] offset:0
  ds_write_b128 v248, v[20:23] offset:1024
  ds_write_b128 v248, v[36:39] offset:2048
  ds_write_b128 v248, v[52:55] offset:3072
  ds_write_b128 v248, v[8:11] offset:4096
  ds_write_b128 v248, v[24:27] offset:5120
  ds_write_b128 v248, v[40:43] offset:6144
  ds_write_b128 v248, v[56:59] offset:7168
  ds_write_b128 v248, v[12:15] offset:8192
  ds_write_b128 v248, v[28:31] offset:9216
  ds_write_b128 v248, v[44:47] offset:10240
  ds_write_b128 v248, v[60:63] offset:11264
  s_waitcnt lgkmcnt(0)
  s_barrier
  ds_read_b128 v[4:7], v249 offset:0
  ds_read_b128 v[20:23], v249 offset:1024
  ds_read_b128 v[36:39], v249 offset:2048
  ds_read_b128 v[52:55], v249 offset:3072
  ds_read_b128 v[8:11], v250 offset:4096
  ds_read_b128 v[24:27], v250 offset:5120
  ds_read_b128 v[40:43], v250 offset:6144
  ds_read_b128 v[56:59], v250 offset:7168
  ds_read_b128 v[12:15], v251 offset:8192
  ds_read_b128 v[28:31], v251 offset:9216
  ds_read_b128 v[44:47], v251 offset:10240
  ds_read_b128 v[60:63], v251 offset:11264
  s_waitcnt lgkmcnt(8)
  v_add_f32 v64, v0, v4
  v_add_f32 v65, v1, v5
  v_add_f32 v66, v2, v6
  v_add_f32 v67, v3, v7
  v_add_f32 v68, v16, v20
  v_add_f32 v69, v17, v21
  v_add_f32 v70, v18, v22
  v_add_f32 v71, v19, v23
  v_add_f32 v72, v32, v36
  v_add_f32 v73, v33, v37
  v_add_f32 v74, v34, v38
  v_add_f32 v75, v35, v39
  v_add_f32 v76, v48, v52
  v_add_f32 v77, v49, v53
  v_add_f32 v78, v50, v54
  v_add_f32 v79, v51, v55
  s_waitcnt lgkmcnt(0)
  v_add_f32 v8, v8, v12
  v_add_f32 v9, v9, v13
  v_add_f32 v10, v10, v14
  v_add_f32 v11, v11, v15
  v_add_f32 v24, v24, v28
  v_add_f32 v25, v25, v29
  v_add_f32 v26, v26, v30
  v_add_f32 v27, v27, v31
  v_add_f32 v40, v40, v44
  v_add_f32 v41, v41, v45
  v_add_f32 v42, v42, v46
  v_add_f32 v43, v43, v47
  v_add_f32 v56, v56, v60
  v_add_f32 v57, v57, v61
  v_add_f32 v58, v58, v62
  v_add_f32 v59, v59, v63
  v_add_f32 v0, v64, v8
  v_add_f32 v1, v65, v9
  v_add_f32 v2, v66, v10
  v_add_f32 v3, v67, v11
  v_add_f32 v4, v68, v24
  v_add_f32 v5, v69, v25
  v_add_f32 v6, v70, v26
  v_add_f32 v7, v71, v27
  v_add_f32 v8, v72, v40
  v_add_f32 v9, v73, v41
  v_add_f32 v10, v74, v42
  v_add_f32 v11, v75, v43
  v_add_f32 v12, v76, v56
  v_add_f32 v13, v77, v57
  v_add_f32 v14, v78, v58
  v_add_f32 v15, v79, v59
  s_waitcnt vmcnt(0)
  v_cvt_pk_bf16_f32 v16, v0, v1
  v_cvt_pk_bf16_f32 v17, v2, v3
  v_cvt_pk_bf16_f32 v18, v4, v5
  v_cvt_pk_bf16_f32 v19, v6, v7
  v_cvt_pk_bf16_f32 v20, v8, v9
  v_cvt_pk_bf16_f32 v21, v10, v11
  v_cvt_pk_bf16_f32 v22, v12, v13
  v_cvt_pk_bf16_f32 v23, v14, v15
  v_lshlrev_b32 v0, 16, v16
  v_and_b32 v1, 0xffff0000, v16
  v_lshlrev_b32 v2, 16, v17
  v_and_b32 v3, 0xffff0000, v17
  v_lshlrev_b32 v4, 16, v18
  v_and_b32 v5, 0xffff0000, v18
  v_lshlrev_b32 v6, 16, v19
  v_and_b32 v7, 0xffff0000, v19
  v_lshlrev_b32 v8, 16, v20
  v_and_b32 v9, 0xffff0000, v20
  v_lshlrev_b32 v10, 16, v21
  v_and_b32 v11, 0xffff0000, v21
  v_lshlrev_b32 v12, 16, v22
  v_and_b32 v13, 0xffff0000, v22
  v_lshlrev_b32 v14, 16, v23
  v_and_b32 v15, 0xffff0000, v23
  v_mul_f32 v0, v0, v208
  v_mul_f32 v1, v1, v209
  v_mul_f32 v2, v2, v210
  v_mul_f32 v3, v3, v211
  v_mul_f32 v4, v4, v212
  v_mul_f32 v5, v5, v213
  v_mul_f32 v6, v6, v214
  v_mul_f32 v7, v7, v215
  v_mul_f32 v8, v8, v216
  v_mul_f32 v9, v9, v217
  v_mul_f32 v10, v10, v218
  v_mul_f32 v11, v11, v219
  v_mul_f32 v12, v12, v220
  v_mul_f32 v13, v13, v221
  v_mul_f32 v14, v14, v222
  v_mul_f32 v15, v15, v223
  v_cvt_pk_bf16_f32 v16, v0, v1
  v_cvt_pk_bf16_f32 v17, v2, v3
  v_cvt_pk_bf16_f32 v18, v4, v5
  v_cvt_pk_bf16_f32 v19, v6, v7
  v_cvt_pk_bf16_f32 v20, v8, v9
  v_cvt_pk_bf16_f32 v21, v10, v11
  v_cvt_pk_bf16_f32 v22, v12, v13
  v_cvt_pk_bf16_f32 v23, v14, v15
  v_accvgpr_read_b32 v24, a120
  v_accvgpr_read_b32 v25, a121
  v_accvgpr_read_b32 v26, a122
  v_accvgpr_read_b32 v27, a123
  v_accvgpr_read_b32 v28, a124
  v_accvgpr_read_b32 v29, a125
  v_accvgpr_read_b32 v30, a126
  v_accvgpr_read_b32 v31, a127
  v_lshlrev_b32 v0, 16, v16
  v_and_b32 v1, 0xffff0000, v16
  v_lshlrev_b32 v2, 16, v17
  v_and_b32 v3, 0xffff0000, v17
  v_lshlrev_b32 v4, 16, v18
  v_and_b32 v5, 0xffff0000, v18
  v_lshlrev_b32 v6, 16, v19
  v_and_b32 v7, 0xffff0000, v19
  v_lshlrev_b32 v8, 16, v20
  v_and_b32 v9, 0xffff0000, v20
  v_lshlrev_b32 v10, 16, v21
  v_and_b32 v11, 0xffff0000, v21
  v_lshlrev_b32 v12, 16, v22
  v_and_b32 v13, 0xffff0000, v22
  v_lshlrev_b32 v14, 16, v23
  v_and_b32 v15, 0xffff0000, v23
  v_lshlrev_b32 v32, 16, v24
  v_and_b32 v33, 0xffff0000, v24
  v_lshlrev_b32 v34, 16, v25
  v_and_b32 v35, 0xffff0000, v25
  v_lshlrev_b32 v36, 16, v26
  v_and_b32 v37, 0xffff0000, v26
  v_lshlrev_b32 v38, 16, v27
  v_and_b32 v39, 0xffff0000, v27
  v_lshlrev_b32 v40, 16, v28
  v_and_b32 v41, 0xffff0000, v28
  v_lshlrev_b32 v42, 16, v29
  v_and_b32 v43, 0xffff0000, v29
  v_lshlrev_b32 v44, 16, v30
  v_and_b32 v45, 0xffff0000, v30
  v_lshlrev_b32 v46, 16, v31
  v_and_b32 v47, 0xffff0000, v31
  v_add_f32 v0, v0, v32
  v_add_f32 v1, v1, v33
  v_add_f32 v2, v2, v34
  v_add_f32 v3, v3, v35
  v_add_f32 v4, v4, v36
  v_add_f32 v5, v5, v37
  v_add_f32 v6, v6, v38
  v_add_f32 v7, v7, v39
  v_add_f32 v8, v8, v40
  v_add_f32 v9, v9, v41
  v_add_f32 v10, v10, v42
  v_add_f32 v11, v11, v43
  v_add_f32 v12, v12, v44
  v_add_f32 v13, v13, v45
  v_add_f32 v14, v14, v46
  v_add_f32 v15, v15, v47
  v_cvt_pk_bf16_f32 v16, v0, v1
  v_cvt_pk_bf16_f32 v17, v2, v3
  v_cvt_pk_bf16_f32 v18, v4, v5
  v_cvt_pk_bf16_f32 v19, v6, v7
  v_cvt_pk_bf16_f32 v20, v8, v9
  v_cvt_pk_bf16_f32 v21, v10, v11
  v_cvt_pk_bf16_f32 v22, v12, v13
  v_cvt_pk_bf16_f32 v23, v14, v15
  s_nop 0
  v_permlane16_swap_b32 v16, v18
  v_permlane16_swap_b32 v17, v19
  v_permlane16_swap_b32 v20, v22
  v_permlane16_swap_b32 v21, v23
  buffer_store_dwordx4 v[16:19], v247, s[16:19], s58 offen offset:0 sc1
  buffer_store_dwordx4 v[20:23], v247, s[16:19], s58 offen offset:64 sc1
  s_or_b32 s44, s2, s14
  s_cmp_lg_u32 s44, 0
  s_cbranch_scc1 K2_end
  v_mov_b32 v0, 0
  s_mov_b32 s10, 256
  s_mov_b32 s11, 0x20000
  s_mov_b64 exec, 1
  buffer_store_dword v0, v0, s[8:11], 0 offen sc1
  s_endpgm
K2_uw:
  s_sub_u32 s13, s68, 28
  s_lshl_b32 s13, s13, 3
  s_and_b32 s12, s2, 7
  s_add_u32 s13, s13, s12
  s_cmp_ge_u32 s13, 28
  s_cbranch_scc1 K2_end
  v_mbcnt_lo_u32_b32 v0, -1, 0
  v_mbcnt_hi_u32_b32 v0, -1, v0
  s_lshl_b32 s12, s14, 6
  v_add_u32 v0, s12, v0
  v_mbcnt_lo_u32_b32 v1, -1, 0
  v_mbcnt_hi_u32_b32 v1, -1, v1
  v_lshlrev_b32 v1, 4, v1
  v_add_u32 v1, 8640, v1
  s_mov_b32 s74, 0x8000
K2_u_pl:
  buffer_load_dword v2, v1, s[32:35], 0 offen sc1
  buffer_load_dword v3, v1, s[32:35], 0 offen sc1
  s_waitcnt vmcnt(0)
  v_cmp_eq_u32 vcc, s75, v2
  s_nop 1
  s_and_b32 s73, vcc_lo, 0xffffffff
  v_cmp_eq_u32 vcc, s75, v3
  s_nop 1
  s_bcnt1_i32_b64 s46, vcc
  s_cmp_ge_u32 s46, 56
  s_cselect_b32 s73, s73, 0
  s_cmp_eq_u32 s73, 0xffffffff
  s_cbranch_scc1 K2_u_pd
  s_sleep 2
  s_sub_u32 s74, s74, 1
  s_cmp_lg_u32 s74, 0
  s_cbranch_scc1 K2_u_pl
K2_u_pd:
  v_and_b32 v1, 7, v0
  v_lshrrev_b32 v2, 3, v0
  v_mul_u32_u24 v3, 3584, v2
  v_lshl_add_u32 v3, v1, 4, v3
  v_lshlrev_b32 v4, 2, v2
  s_lshl_b32 s44, s13, 7
  s_lshl_b32 s45, s13, 8
  s_mov_b32 s16, s62
  s_mov_b32 s17, s63
  s_and_b32 s17, s17, 0xffff
  s_mov_b32 s18, 0x188000
  s_mov_b32 s19, 0x20000
  s_add_u32 s20, s10, 0x1500
  s_addc_u32 s21, s11, 0
  s_and_b32 s21, s21, 0xffff
  s_mov_b32 s22, 0xe00
  s_mov_b32 s23, 0x20000
  s_add_u32 s24, s10, 0x4000
  s_addc_u32 s25, s11, 0
  s_and_b32 s25, s25, 0xffff
  s_mov_b32 s26, 0x4000
  s_mov_b32 s27, 0x20000
  buffer_load_dword v8, v4, s[20:23], 0 offen offset:0 sc1
  buffer_load_dword v24, v4, s[20:23], 0 offen offset:1792 sc1
  buffer_load_dword v9, v4, s[20:23], 0 offen offset:128 sc1
  buffer_load_dword v25, v4, s[20:23], 0 offen offset:1920 sc1
  buffer_load_dword v10, v4, s[20:23], 0 offen offset:256 sc1
  buffer_load_dword v26, v4, s[20:23], 0 offen offset:2048 sc1
  buffer_load_dword v11, v4, s[20:23], 0 offen offset:384 sc1
  buffer_load_dword v27, v4, s[20:23], 0 offen offset:2176 sc1
  buffer_load_dword v12, v4, s[20:23], 0 offen offset:512 sc1
  buffer_load_dword v28, v4, s[20:23], 0 offen offset:2304 sc1
  buffer_load_dword v13, v4, s[20:23], 0 offen offset:640 sc1
  buffer_load_dword v29, v4, s[20:23], 0 offen offset:2432 sc1
  buffer_load_dword v14, v4, s[20:23], 0 offen offset:768 sc1
  buffer_load_dword v30, v4, s[20:23], 0 offen offset:2560 sc1
  buffer_load_dword v15, v4, s[20:23], 0 offen offset:896 sc1
  buffer_load_dword v31, v4, s[20:23], 0 offen offset:2688 sc1
  buffer_load_dword v16, v4, s[20:23], 0 offen offset:1024 sc1
  buffer_load_dword v32, v4, s[20:23], 0 offen offset:2816 sc1
  buffer_load_dword v17, v4, s[20:23], 0 offen offset:1152 sc1
  buffer_load_dword v33, v4, s[20:23], 0 offen offset:2944 sc1
  buffer_load_dword v18, v4, s[20:23], 0 offen offset:1280 sc1
  buffer_load_dword v34, v4, s[20:23], 0 offen offset:3072 sc1
  buffer_load_dword v19, v4, s[20:23], 0 offen offset:1408 sc1
  buffer_load_dword v35, v4, s[20:23], 0 offen offset:3200 sc1
  buffer_load_dword v20, v4, s[20:23], 0 offen offset:1536 sc1
  buffer_load_dword v36, v4, s[20:23], 0 offen offset:3328 sc1
  buffer_load_dword v21, v4, s[20:23], 0 offen offset:1664 sc1
  buffer_load_dword v37, v4, s[20:23], 0 offen offset:3456 sc1
  s_add_u32 s46, s44, 0
  buffer_load_dwordx4 v[40:43], v3, s[16:19], s46 offen
  s_add_u32 s46, s44, 114688
  buffer_load_dwordx4 v[44:47], v3, s[16:19], s46 offen
  s_add_u32 s46, s44, 229376
  buffer_load_dwordx4 v[48:51], v3, s[16:19], s46 offen
  s_add_u32 s46, s44, 344064
  buffer_load_dwordx4 v[52:55], v3, s[16:19], s46 offen
  s_add_u32 s46, s44, 458752
  buffer_load_dwordx4 v[56:59], v3, s[16:19], s46 offen
  s_add_u32 s46, s44, 573440
  buffer_load_dwordx4 v[60:63], v3, s[16:19], s46 offen
  s_add_u32 s46, s44, 688128
  buffer_load_dwordx4 v[64:67], v3, s[16:19], s46 offen
  s_add_u32 s46, s44, 802816
  buffer_load_dwordx4 v[68:71], v3, s[16:19], s46 offen
  s_add_u32 s46, s44, 917504
  buffer_load_dwordx4 v[72:75], v3, s[16:19], s46 offen
  s_add_u32 s46, s44, 1032192
  buffer_load_dwordx4 v[76:79], v3, s[16:19], s46 offen
  s_add_u32 s46, s44, 1146880
  buffer_load_dwordx4 v[80:83], v3, s[16:19], s46 offen
  s_add_u32 s46, s44, 1261568
  buffer_load_dwordx4 v[84:87], v3, s[16:19], s46 offen
  s_add_u32 s46, s44, 1376256
  buffer_load_dwordx4 v[88:91], v3, s[16:19], s46 offen
  s_add_u32 s46, s44, 1490944
  buffer_load_dwordx4 v[92:95], v3, s[16:19], s46 offen
  s_waitcnt vmcnt(13)
  v_lshlrev_b32 v112, 16, v40
  v_and_b32 v113, 0xffff0000, v40
  v_mul_f32 v96, v112, v24
  v_mul_f32 v97, v113, v24
  v_mul_f32 v104, v112, v8
  v_mul_f32 v105, v113, v8
  v_lshlrev_b32 v112, 16, v41
  v_and_b32 v113, 0xffff0000, v41
  v_mul_f32 v98, v112, v24
  v_mul_f32 v99, v113, v24
  v_mul_f32 v106, v112, v8
  v_mul_f32 v107, v113, v8
  v_lshlrev_b32 v112, 16, v42
  v_and_b32 v113, 0xffff0000, v42
  v_mul_f32 v100, v112, v24
  v_mul_f32 v101, v113, v24
  v_mul_f32 v108, v112, v8
  v_mul_f32 v109, v113, v8
  v_lshlrev_b32 v112, 16, v43
  v_and_b32 v113, 0xffff0000, v43
  v_mul_f32 v102, v112, v24
  v_mul_f32 v103, v113, v24
  v_mul_f32 v110, v112, v8
  v_mul_f32 v111, v113, v8
  s_waitcnt vmcnt(12)
  v_lshlrev_b32 v112, 16, v44
  v_and_b32 v113, 0xffff0000, v44
  v_fmac_f32 v96, v112, v25
  v_fmac_f32 v97, v113, v25
  v_fmac_f32 v104, v112, v9
  v_fmac_f32 v105, v113, v9
  v_lshlrev_b32 v112, 16, v45
  v_and_b32 v113, 0xffff0000, v45
  v_fmac_f32 v98, v112, v25
  v_fmac_f32 v99, v113, v25
  v_fmac_f32 v106, v112, v9
  v_fmac_f32 v107, v113, v9
  v_lshlrev_b32 v112, 16, v46
  v_and_b32 v113, 0xffff0000, v46
  v_fmac_f32 v100, v112, v25
  v_fmac_f32 v101, v113, v25
  v_fmac_f32 v108, v112, v9
  v_fmac_f32 v109, v113, v9
  v_lshlrev_b32 v112, 16, v47
  v_and_b32 v113, 0xffff0000, v47
  v_fmac_f32 v102, v112, v25
  v_fmac_f32 v103, v113, v25
  v_fmac_f32 v110, v112, v9
  v_fmac_f32 v111, v113, v9
  s_waitcnt vmcnt(11)
  v_lshlrev_b32 v112, 16, v48
  v_and_b32 v113, 0xffff0000, v48
  v_fmac_f32 v96, v112, v26
  v_fmac_f32 v97, v113, v26
  v_fmac_f32 v104, v112, v10
  v_fmac_f32 v105, v113, v10
  v_lshlrev_b32 v112, 16, v49
  v_and_b32 v113, 0xffff0000, v49
  v_fmac_f32 v98, v112, v26
  v_fmac_f32 v99, v113, v26
  v_fmac_f32 v106, v112, v10
  v_fmac_f32 v107, v113, v10
  v_lshlrev_b32 v112, 16, v50
  v_and_b32 v113, 0xffff0000, v50
  v_fmac_f32 v100, v112, v26
  v_fmac_f32 v101, v113, v26
  v_fmac_f32 v108, v112, v10
  v_fmac_f32 v109, v113, v10
  v_lshlrev_b32 v112, 16, v51
  v_and_b32 v113, 0xffff0000, v51
  v_fmac_f32 v102, v112, v26
  v_fmac_f32 v103, v113, v26
  v_fmac_f32 v110, v112, v10
  v_fmac_f32 v111, v113, v10
  s_waitcnt vmcnt(10)
  v_lshlrev_b32 v112, 16, v52
  v_and_b32 v113, 0xffff0000, v52
  v_fmac_f32 v96, v112, v27
  v_fmac_f32 v97, v113, v27
  v_fmac_f32 v104, v112, v11
  v_fmac_f32 v105, v113, v11
  v_lshlrev_b32 v112, 16, v53
  v_and_b32 v113, 0xffff0000, v53
  v_fmac_f32 v98, v112, v27
  v_fmac_f32 v99, v113, v27
  v_fmac_f32 v106, v112, v11
  v_fmac_f32 v107, v113, v11
  v_lshlrev_b32 v112, 16, v54
  v_and_b32 v113, 0xffff0000, v54
  v_fmac_f32 v100, v112, v27
  v_fmac_f32 v101, v113, v27
  v_fmac_f32 v108, v112, v11
  v_fmac_f32 v109, v113, v11
  v_lshlrev_b32 v112, 16, v55
  v_and_b32 v113, 0xffff0000, v55
  v_fmac_f32 v102, v112, v27
  v_fmac_f32 v103, v113, v27
  v_fmac_f32 v110, v112, v11
  v_fmac_f32 v111, v113, v11
  s_waitcnt vmcnt(9)
  v_lshlrev_b32 v112, 16, v56
  v_and_b32 v113, 0xffff0000, v56
  v_fmac_f32 v96, v112, v28
  v_fmac_f32 v97, v113, v28
  v_fmac_f32 v104, v112, v12
  v_fmac_f32 v105, v113, v12
  v_lshlrev_b32 v112, 16, v57
  v_and_b32 v113, 0xffff0000, v57
  v_fmac_f32 v98, v112, v28
  v_fmac_f32 v99, v113, v28
  v_fmac_f32 v106, v112, v12
  v_fmac_f32 v107, v113, v12
  v_lshlrev_b32 v112, 16, v58
  v_and_b32 v113, 0xffff0000, v58
  v_fmac_f32 v100, v112, v28
  v_fmac_f32 v101, v113, v28
  v_fmac_f32 v108, v112, v12
  v_fmac_f32 v109, v113, v12
  v_lshlrev_b32 v112, 16, v59
  v_and_b32 v113, 0xffff0000, v59
  v_fmac_f32 v102, v112, v28
  v_fmac_f32 v103, v113, v28
  v_fmac_f32 v110, v112, v12
  v_fmac_f32 v111, v113, v12
  s_waitcnt vmcnt(8)
  v_lshlrev_b32 v112, 16, v60
  v_and_b32 v113, 0xffff0000, v60
  v_fmac_f32 v96, v112, v29
  v_fmac_f32 v97, v113, v29
  v_fmac_f32 v104, v112, v13
  v_fmac_f32 v105, v113, v13
  v_lshlrev_b32 v112, 16, v61
  v_and_b32 v113, 0xffff0000, v61
  v_fmac_f32 v98, v112, v29
  v_fmac_f32 v99, v113, v29
  v_fmac_f32 v106, v112, v13
  v_fmac_f32 v107, v113, v13
  v_lshlrev_b32 v112, 16, v62
  v_and_b32 v113, 0xffff0000, v62
  v_fmac_f32 v100, v112, v29
  v_fmac_f32 v101, v113, v29
  v_fmac_f32 v108, v112, v13
  v_fmac_f32 v109, v113, v13
  v_lshlrev_b32 v112, 16, v63
  v_and_b32 v113, 0xffff0000, v63
  v_fmac_f32 v102, v112, v29
  v_fmac_f32 v103, v113, v29
  v_fmac_f32 v110, v112, v13
  v_fmac_f32 v111, v113, v13
  s_waitcnt vmcnt(7)
  v_lshlrev_b32 v112, 16, v64
  v_and_b32 v113, 0xffff0000, v64
  v_fmac_f32 v96, v112, v30
  v_fmac_f32 v97, v113, v30
  v_fmac_f32 v104, v112, v14
  v_fmac_f32 v105, v113, v14
  v_lshlrev_b32 v112, 16, v65
  v_and_b32 v113, 0xffff0000, v65
  v_fmac_f32 v98, v112, v30
  v_fmac_f32 v99, v113, v30
  v_fmac_f32 v106, v112, v14
  v_fmac_f32 v107, v113, v14
  v_lshlrev_b32 v112, 16, v66
  v_and_b32 v113, 0xffff0000, v66
  v_fmac_f32 v100, v112, v30
  v_fmac_f32 v101, v113, v30
  v_fmac_f32 v108, v112, v14
  v_fmac_f32 v109, v113, v14
  v_lshlrev_b32 v112, 16, v67
  v_and_b32 v113, 0xffff0000, v67
  v_fmac_f32 v102, v112, v30
  v_fmac_f32 v103, v113, v30
  v_fmac_f32 v110, v112, v14
  v_fmac_f32 v111, v113, v14
  s_waitcnt vmcnt(6)
  v_lshlrev_b32 v112, 16, v68
  v_and_b32 v113, 0xffff0000, v68
  v_fmac_f32 v96, v112, v31
  v_fmac_f32 v97, v113, v31
  v_fmac_f32 v104, v112, v15
  v_fmac_f32 v105, v113, v15
  v_lshlrev_b32 v112, 16, v69
  v_and_b32 v113, 0xffff0000, v69
  v_fmac_f32 v98, v112, v31
  v_fmac_f32 v99, v113, v31
  v_fmac_f32 v106, v112, v15
  v_fmac_f32 v107, v113, v15
  v_lshlrev_b32 v112, 16, v70
  v_and_b32 v113, 0xffff0000, v70
  v_fmac_f32 v100, v112, v31
  v_fmac_f32 v101, v113, v31
  v_fmac_f32 v108, v112, v15
  v_fmac_f32 v109, v113, v15
  v_lshlrev_b32 v112, 16, v71
  v_and_b32 v113, 0xffff0000, v71
  v_fmac_f32 v102, v112, v31
  v_fmac_f32 v103, v113, v31
  v_fmac_f32 v110, v112, v15
  v_fmac_f32 v111, v113, v15
  s_waitcnt vmcnt(5)
  v_lshlrev_b32 v112, 16, v72
  v_and_b32 v113, 0xffff0000, v72
  v_fmac_f32 v96, v112, v32
  v_fmac_f32 v97, v113, v32
  v_fmac_f32 v104, v112, v16
  v_fmac_f32 v105, v113, v16
  v_lshlrev_b32 v112, 16, v73
  v_and_b32 v113, 0xffff0000, v73
  v_fmac_f32 v98, v112, v32
  v_fmac_f32 v99, v113, v32
  v_fmac_f32 v106, v112, v16
  v_fmac_f32 v107, v113, v16
  v_lshlrev_b32 v112, 16, v74
  v_and_b32 v113, 0xffff0000, v74
  v_fmac_f32 v100, v112, v32
  v_fmac_f32 v101, v113, v32
  v_fmac_f32 v108, v112, v16
  v_fmac_f32 v109, v113, v16
  v_lshlrev_b32 v112, 16, v75
  v_and_b32 v113, 0xffff0000, v75
  v_fmac_f32 v102, v112, v32
  v_fmac_f32 v103, v113, v32
  v_fmac_f32 v110, v112, v16
  v_fmac_f32 v111, v113, v16
  s_waitcnt vmcnt(4)
  v_lshlrev_b32 v112, 16, v76
  v_and_b32 v113, 0xffff0000, v76
  v_fmac_f32 v96, v112, v33
  v_fmac_f32 v97, v113, v33
  v_fmac_f32 v104, v112, v17
  v_fmac_f32 v105, v113, v17
  v_lshlrev_b32 v112, 16, v77
  v_and_b32 v113, 0xffff0000, v77
  v_fmac_f32 v98, v112, v33
  v_fmac_f32 v99, v113, v33
  v_fmac_f32 v106, v112, v17
  v_fmac_f32 v107, v113, v17
  v_lshlrev_b32 v112, 16, v78
  v_and_b32 v113, 0xffff0000, v78
  v_fmac_f32 v100, v112, v33
  v_fmac_f32 v101, v113, v33
  v_fmac_f32 v108, v112, v17
  v_fmac_f32 v109, v113, v17
  v_lshlrev_b32 v112, 16, v79
  v_and_b32 v113, 0xffff0000, v79
  v_fmac_f32 v102, v112, v33
  v_fmac_f32 v103, v113, v33
  v_fmac_f32 v110, v112, v17
  v_fmac_f32 v111, v113, v17
  s_waitcnt vmcnt(3)
  v_lshlrev_b32 v112, 16, v80
  v_and_b32 v113, 0xffff0000, v80
  v_fmac_f32 v96, v112, v34
  v_fmac_f32 v97, v113, v34
  v_fmac_f32 v104, v112, v18
  v_fmac_f32 v105, v113, v18
  v_lshlrev_b32 v112, 16, v81
  v_and_b32 v113, 0xffff0000, v81
  v_fmac_f32 v98, v112, v34
  v_fmac_f32 v99, v113, v34
  v_fmac_f32 v106, v112, v18
  v_fmac_f32 v107, v113, v18
  v_lshlrev_b32 v112, 16, v82
  v_and_b32 v113, 0xffff0000, v82
  v_fmac_f32 v100, v112, v34
  v_fmac_f32 v101, v113, v34
  v_fmac_f32 v108, v112, v18
  v_fmac_f32 v109, v113, v18
  v_lshlrev_b32 v112, 16, v83
  v_and_b32 v113, 0xffff0000, v83
  v_fmac_f32 v102, v112, v34
  v_fmac_f32 v103, v113, v34
  v_fmac_f32 v110, v112, v18
  v_fmac_f32 v111, v113, v18
  s_waitcnt vmcnt(2)
  v_lshlrev_b32 v112, 16, v84
  v_and_b32 v113, 0xffff0000, v84
  v_fmac_f32 v96, v112, v35
  v_fmac_f32 v97, v113, v35
  v_fmac_f32 v104, v112, v19
  v_fmac_f32 v105, v113, v19
  v_lshlrev_b32 v112, 16, v85
  v_and_b32 v113, 0xffff0000, v85
  v_fmac_f32 v98, v112, v35
  v_fmac_f32 v99, v113, v35
  v_fmac_f32 v106, v112, v19
  v_fmac_f32 v107, v113, v19
  v_lshlrev_b32 v112, 16, v86
  v_and_b32 v113, 0xffff0000, v86
  v_fmac_f32 v100, v112, v35
  v_fmac_f32 v101, v113, v35
  v_fmac_f32 v108, v112, v19
  v_fmac_f32 v109, v113, v19
  v_lshlrev_b32 v112, 16, v87
  v_and_b32 v113, 0xffff0000, v87
  v_fmac_f32 v102, v112, v35
  v_fmac_f32 v103, v113, v35
  v_fmac_f32 v110, v112, v19
  v_fmac_f32 v111, v113, v19
  s_waitcnt vmcnt(1)
  v_lshlrev_b32 v112, 16, v88
  v_and_b32 v113, 0xffff0000, v88
  v_fmac_f32 v96, v112, v36
  v_fmac_f32 v97, v113, v36
  v_fmac_f32 v104, v112, v20
  v_fmac_f32 v105, v113, v20
  v_lshlrev_b32 v112, 16, v89
  v_and_b32 v113, 0xffff0000, v89
  v_fmac_f32 v98, v112, v36
  v_fmac_f32 v99, v113, v36
  v_fmac_f32 v106, v112, v20
  v_fmac_f32 v107, v113, v20
  v_lshlrev_b32 v112, 16, v90
  v_and_b32 v113, 0xffff0000, v90
  v_fmac_f32 v100, v112, v36
  v_fmac_f32 v101, v113, v36
  v_fmac_f32 v108, v112, v20
  v_fmac_f32 v109, v113, v20
  v_lshlrev_b32 v112, 16, v91
  v_and_b32 v113, 0xffff0000, v91
  v_fmac_f32 v102, v112, v36
  v_fmac_f32 v103, v113, v36
  v_fmac_f32 v110, v112, v20
  v_fmac_f32 v111, v113, v20
  s_waitcnt vmcnt(0)
  v_lshlrev_b32 v112, 16, v92
  v_and_b32 v113, 0xffff0000, v92
  v_fmac_f32 v96, v112, v37
  v_fmac_f32 v97, v113, v37
  v_fmac_f32 v104, v112, v21
  v_fmac_f32 v105, v113, v21
  v_lshlrev_b32 v112, 16, v93
  v_and_b32 v113, 0xffff0000, v93
  v_fmac_f32 v98, v112, v37
  v_fmac_f32 v99, v113, v37
  v_fmac_f32 v106, v112, v21
  v_fmac_f32 v107, v113, v21
  v_lshlrev_b32 v112, 16, v94
  v_and_b32 v113, 0xffff0000, v94
  v_fmac_f32 v100, v112, v37
  v_fmac_f32 v101, v113, v37
  v_fmac_f32 v108, v112, v21
  v_fmac_f32 v109, v113, v21
  v_lshlrev_b32 v112, 16, v95
  v_and_b32 v113, 0xffff0000, v95
  v_fmac_f32 v102, v112, v37
  v_fmac_f32 v103, v113, v37
  v_fmac_f32 v110, v112, v21
  v_fmac_f32 v111, v113, v21
  v_lshlrev_b32 v5, 8, v2
  v_lshl_add_u32 v5, v1, 5, v5
  ds_write_b128 v5, v[96:99]
  ds_write_b128 v5, v[100:103] offset:16
  ds_write_b128 v5, v[104:107] offset:8192
  ds_write_b128 v5, v[108:111] offset:8208
  v_and_b32 v6, 63, v0
  v_lshlrev_b32 v6, 2, v6
  v_bfe_u32 v7, v0, 6, 1
  v_lshl_add_u32 v8, v7, 13, v6
  s_waitcnt lgkmcnt(0)
  s_barrier
  ds_read_b32 v40, v8 offset:0
  ds_read_b32 v41, v8 offset:256
  ds_read_b32 v42, v8 offset:512
  ds_read_b32 v43, v8 offset:768
  ds_read_b32 v44, v8 offset:1024
  ds_read_b32 v45, v8 offset:1280
  ds_read_b32 v46, v8 offset:1536
  ds_read_b32 v47, v8 offset:1792
  ds_read_b32 v48, v8 offset:2048
  ds_read_b32 v49, v8 offset:2304
  ds_read_b32 v50, v8 offset:2560
  ds_read_b32 v51, v8 offset:2816
  ds_read_b32 v52, v8 offset:3072
  ds_read_b32 v53, v8 offset:3328
  ds_read_b32 v54, v8 offset:3584
  ds_read_b32 v55, v8 offset:3840
  ds_read_b32 v56, v8 offset:4096
  ds_read_b32 v57, v8 offset:4352
  ds_read_b32 v58, v8 offset:4608
  ds_read_b32 v59, v8 offset:4864
  ds_read_b32 v60, v8 offset:5120
  ds_read_b32 v61, v8 offset:5376
  ds_read_b32 v62, v8 offset:5632
  ds_read_b32 v63, v8 offset:5888
  ds_read_b32 v64, v8 offset:6144
  ds_read_b32 v65, v8 offset:6400
  ds_read_b32 v66, v8 offset:6656
  ds_read_b32 v67, v8 offset:6912
  ds_read_b32 v68, v8 offset:7168
  ds_read_b32 v69, v8 offset:7424
  ds_read_b32 v70, v8 offset:7680
  ds_read_b32 v71, v8 offset:7936
  s_waitcnt lgkmcnt(0)
  v_add_f32 v40, v40, v56
  v_add_f32 v41, v41, v57
  v_add_f32 v42, v42, v58
  v_add_f32 v43, v43, v59
  v_add_f32 v44, v44, v60
  v_add_f32 v45, v45, v61
  v_add_f32 v46, v46, v62
  v_add_f32 v47, v47, v63
  v_add_f32 v48, v48, v64
  v_add_f32 v49, v49, v65
  v_add_f32 v50, v50, v66
  v_add_f32 v51, v51, v67
  v_add_f32 v52, v52, v68
  v_add_f32 v53, v53, v69
  v_add_f32 v54, v54, v70
  v_add_f32 v55, v55, v71
  v_add_f32 v40, v40, v48
  v_add_f32 v41, v41, v49
  v_add_f32 v42, v42, v50
  v_add_f32 v43, v43, v51
  v_add_f32 v44, v44, v52
  v_add_f32 v45, v45, v53
  v_add_f32 v46, v46, v54
  v_add_f32 v47, v47, v55
  v_add_f32 v40, v40, v44
  v_add_f32 v41, v41, v45
  v_add_f32 v42, v42, v46
  v_add_f32 v43, v43, v47
  v_add_f32 v40, v40, v42
  v_add_f32 v41, v41, v43
  v_add_f32 v40, v40, v41
  v_mov_b32 v41, 0x3fb8aa3b
  v_cmp_eq_u32 vcc, 0, v7
  s_nop 1
  v_cndmask_b32 v41, v41, 1.0, vcc
  v_mul_f32 v40, v40, v41
  buffer_store_dword v40, v8, s[24:27], s45 offen sc1
  s_waitcnt vmcnt(0)
  s_barrier
  s_lshl_b32 s46, s13, 2
  s_add_u32 s46, s46, 6144
  s_cmp_lg_u32 s14, 0
  s_cbranch_scc1 K2_u_nf
  v_mov_b32 v1, 0
  v_mov_b32 v2, s75
  s_mov_b64 exec, 1
  buffer_store_dword v2, v1, s[32:35], s46 offen sc1
  s_mov_b64 exec, -1
K2_u_nf:
  s_endpgm
K2_fb:
  s_mov_b32 s43, 1
  s_waitcnt vmcnt(0)
  s_barrier
  v_mov_b32 v160, 0xff800000
  v_mov_b32 v164, 0xff800000
  s_mov_b32 s41, 0
K2_mx:
  s_add_u32 m0, s40, 0x0
  s_nop 0
  buffer_load_dwordx4 v182, s[16:19], s41 offen offset:0 nt lds
  buffer_load_dwordx4 v183, s[16:19], s41 offen offset:1024 nt lds
  buffer_load_dwordx4 v184, s[16:19], s41 offen offset:2048 nt lds
  buffer_load_dwordx4 v185, s[16:19], s41 offen offset:3072 nt lds
  s_waitcnt vmcnt(0)
  s_barrier
  ds_read_b128 a[0:3], v170 offset:0
  ds_read_b128 a[4:7], v171 offset:0
  ds_read_b128 a[8:11], v172 offset:0
  ds_read_b128 a[12:15], v173 offset:0
  ds_read_b128 a[16:19], v170 offset:256
  ds_read_b128 a[20:23], v171 offset:256
  ds_read_b128 a[24:27], v172 offset:256
  ds_read_b128 a[28:31], v173 offset:256
  ds_read_b128 a[32:35], v170 offset:8192
  ds_read_b128 a[36:39], v171 offset:8192
  ds_read_b128 a[40:43], v172 offset:8192
  ds_read_b128 a[44:47], v173 offset:8192
  ds_read_b128 a[48:51], v170 offset:8448
  ds_read_b128 a[52:55], v171 offset:8448
  ds_read_b128 a[56:59], v172 offset:8448
  ds_read_b128 a[60:63], v173 offset:8448
  s_waitcnt lgkmcnt(0)
  s_barrier
  v_mfma_f32_16x16x32_bf16 v[128:131], a[0:3], v[192:195], 0
  v_mfma_f32_16x16x32_bf16 v[128:131], a[4:7], v[200:203], v[128:131]
  v_mfma_f32_16x16x32_bf16 v[128:131], a[8:11], v[208:211], v[128:131]
  v_mfma_f32_16x16x32_bf16 v[128:131], a[12:15], v[216:219], v[128:131]
  v_mfma_f32_16x16x32_bf16 v[128:131], a[16:19], v[224:227], v[128:131]
  v_mfma_f32_16x16x32_bf16 v[128:131], a[20:23], v[232:235], v[128:131]
  v_mfma_f32_16x16x32_bf16 v[128:131], a[24:27], v[240:243], v[128:131]
  v_mfma_f32_16x16x32_bf16 v[128:131], a[28:31], v[248:251], v[128:131]
  v_mfma_f32_16x16x32_bf16 v[132:135], a[0:3], v[196:199], 0
  v_mfma_f32_16x16x32_bf16 v[132:135], a[4:7], v[204:207], v[132:135]
  v_mfma_f32_16x16x32_bf16 v[132:135], a[8:11], v[212:215], v[132:135]
  v_mfma_f32_16x16x32_bf16 v[132:135], a[12:15], v[220:223], v[132:135]
  v_mfma_f32_16x16x32_bf16 v[132:135], a[16:19], v[228:231], v[132:135]
  v_mfma_f32_16x16x32_bf16 v[132:135], a[20:23], v[236:239], v[132:135]
  v_mfma_f32_16x16x32_bf16 v[132:135], a[24:27], v[244:247], v[132:135]
  v_mfma_f32_16x16x32_bf16 v[132:135], a[28:31], v[252:255], v[132:135]
  v_mfma_f32_16x16x32_bf16 v[136:139], a[32:35], v[192:195], 0
  v_mfma_f32_16x16x32_bf16 v[136:139], a[36:39], v[200:203], v[136:139]
  v_mfma_f32_16x16x32_bf16 v[136:139], a[40:43], v[208:211], v[136:139]
  v_mfma_f32_16x16x32_bf16 v[136:139], a[44:47], v[216:219], v[136:139]
  v_mfma_f32_16x16x32_bf16 v[136:139], a[48:51], v[224:227], v[136:139]
  v_mfma_f32_16x16x32_bf16 v[136:139], a[52:55], v[232:235], v[136:139]
  v_mfma_f32_16x16x32_bf16 v[136:139], a[56:59], v[240:243], v[136:139]
  v_mfma_f32_16x16x32_bf16 v[136:139], a[60:63], v[248:251], v[136:139]
  v_mfma_f32_16x16x32_bf16 v[140:143], a[32:35], v[196:199], 0
  v_mfma_f32_16x16x32_bf16 v[140:143], a[36:39], v[204:207], v[140:143]
  v_mfma_f32_16x16x32_bf16 v[140:143], a[40:43], v[212:215], v[140:143]
  v_mfma_f32_16x16x32_bf16 v[140:143], a[44:47], v[220:223], v[140:143]
  v_mfma_f32_16x16x32_bf16 v[140:143], a[48:51], v[228:231], v[140:143]
  v_mfma_f32_16x16x32_bf16 v[140:143], a[52:55], v[236:239], v[140:143]
  v_mfma_f32_16x16x32_bf16 v[140:143], a[56:59], v[244:247], v[140:143]
  v_mfma_f32_16x16x32_bf16 v[140:143], a[60:63], v[252:255], v[140:143]
  s_nop 7
  v_max3_f32 v160, v128, v129, v160
  v_max3_f32 v160, v130, v131, v160
  v_max3_f32 v164, v132, v133, v164
  v_max3_f32 v164, v134, v135, v164
  v_max3_f32 v160, v136, v137, v160
  v_max3_f32 v160, v138, v139, v160
  v_max3_f32 v164, v140, v141, v164
  v_max3_f32 v164, v142, v143, v164
  s_add_u32 s41, s41, 16384
  s_cmp_lt_u32 s41, 1048576
  s_cbranch_scc1 K2_mx
  v_mov_b32 v161, v160
  s_nop 1
  v_permlane32_swap_b32 v160, v161
  s_nop 1
  v_max_f32 v160, v160, v161
  v_mov_b32 v161, v160
  s_nop 1
  v_permlane16_swap_b32 v160, v161
  s_nop 1
  v_max_f32 v160, v160, v161
  v_mov_b32 v165, v164
  s_nop 1
  v_permlane32_swap_b32 v164, v165
  s_nop 1
  v_max_f32 v164, v164, v165
  v_mov_b32 v165, v164
  s_nop 1
  v_permlane16_swap_b32 v164, v165
  s_nop 1
  v_max_f32 v164, v164, v165
  v_sub_f32 v160, 0, v160
  v_mov_b32 v161, v160
  v_mov_b32 v162, v160
  v_mov_b32 v163, v160
  v_sub_f32 v164, 0, v164
  v_mov_b32 v165, v164
  v_mov_b32 v166, v164
  v_mov_b32 v167, v164
  v_mov_b64 v[0:1], 0
  v_mov_b64 v[2:3], 0
  v_mov_b64 v[4:5], 0
  v_mov_b64 v[6:7], 0
  v_mov_b64 v[8:9], 0
  v_mov_b64 v[10:11], 0
  v_mov_b64 v[12:13], 0
  v_mov_b64 v[14:15], 0
  v_mov_b64 v[16:17], 0
  v_mov_b64 v[18:19], 0
  v_mov_b64 v[20:21], 0
  v_mov_b64 v[22:23], 0
  v_mov_b64 v[24:25], 0
  v_mov_b64 v[26:27], 0
  v_mov_b64 v[28:29], 0
  v_mov_b64 v[30:31], 0
  v_mov_b64 v[32:33], 0
  v_mov_b64 v[34:35], 0
  v_mov_b64 v[36:37], 0
  v_mov_b64 v[38:39], 0
  v_mov_b64 v[40:41], 0
  v_mov_b64 v[42:43], 0
  v_mov_b64 v[44:45], 0
  v_mov_b64 v[46:47], 0
  v_mov_b64 v[48:49], 0
  v_mov_b64 v[50:51], 0
  v_mov_b64 v[52:53], 0
  v_mov_b64 v[54:55], 0
  v_mov_b64 v[56:57], 0
  v_mov_b64 v[58:59], 0
  v_mov_b64 v[60:61], 0
  v_mov_b64 v[62:63], 0
  v_mov_b64 v[64:65], 0
  v_mov_b64 v[66:67], 0
  v_mov_b64 v[68:69], 0
  v_mov_b64 v[70:71], 0
  v_mov_b64 v[72:73], 0
  v_mov_b64 v[74:75], 0
  v_mov_b64 v[76:77], 0
  v_mov_b64 v[78:79], 0
  v_mov_b64 v[80:81], 0
  v_mov_b64 v[82:83], 0
  v_mov_b64 v[84:85], 0
  v_mov_b64 v[86:87], 0
  v_mov_b64 v[88:89], 0
  v_mov_b64 v[90:91], 0
  v_mov_b64 v[92:93], 0
  v_mov_b64 v[94:95], 0
  v_mov_b64 v[96:97], 0
  v_mov_b64 v[98:99], 0
  v_mov_b64 v[100:101], 0
  v_mov_b64 v[102:103], 0
  v_mov_b64 v[104:105], 0
  v_mov_b64 v[106:107], 0
  v_mov_b64 v[108:109], 0
  v_mov_b64 v[110:111], 0
  v_mov_b64 v[112:113], 0
  v_mov_b64 v[114:115], 0
  v_mov_b64 v[116:117], 0
  v_mov_b64 v[118:119], 0
  v_mov_b64 v[120:121], 0
  v_mov_b64 v[122:123], 0
  v_mov_b64 v[124:125], 0
  v_mov_b64 v[126:127], 0
  s_add_u32 m0, s40, 0x0
  s_mov_b32 s44, 0x0
  buffer_load_dwordx4 v182, s[16:19], s44 offen offset:0 nt lds
  buffer_load_dwordx4 v183, s[16:19], s44 offen offset:1024 nt lds
  buffer_load_dwordx4 v184, s[16:19], s44 offen offset:2048 nt lds
  buffer_load_dwordx4 v185, s[16:19], s44 offen offset:3072 nt lds
  s_add_u32 m0, s40, 0x4000
  s_mov_b32 s44, 0x4000
  buffer_load_dwordx4 v182, s[16:19], s44 offen offset:0 nt lds
  buffer_load_dwordx4 v183, s[16:19], s44 offen offset:1024 nt lds
  buffer_load_dwordx4 v184, s[16:19], s44 offen offset:2048 nt lds
  buffer_load_dwordx4 v185, s[16:19], s44 offen offset:3072 nt lds
  s_add_u32 m0, s40, 0x8000
  s_mov_b32 s44, 0x8000
  buffer_load_dwordx4 v182, s[16:19], s44 offen offset:0 nt lds
  buffer_load_dwordx4 v183, s[16:19], s44 offen offset:1024 nt lds
  buffer_load_dwordx4 v184, s[16:19], s44 offen offset:2048 nt lds
  buffer_load_dwordx4 v185, s[16:19], s44 offen offset:3072 nt lds
  s_add_u32 m0, s40, 0x10000
  s_mov_b32 s44, 0x0
  buffer_load_dwordx4 v186, s[20:23], s44 offen offset:0 nt lds
  buffer_load_dwordx4 v187, s[20:23], s44 offen offset:1024 nt lds
  buffer_load_dwordx4 v188, s[20:23], s44 offen offset:2048 nt lds
  buffer_load_dwordx4 v189, s[20:23], s44 offen offset:3072 nt lds
  s_add_u32 m0, s40, 0xc000
  s_mov_b32 s44, 0xc000
  buffer_load_dwordx4 v182, s[16:19], s44 offen offset:0 nt lds
  buffer_load_dwordx4 v183, s[16:19], s44 offen offset:1024 nt lds
  buffer_load_dwordx4 v184, s[16:19], s44 offen offset:2048 nt lds
  buffer_load_dwordx4 v185, s[16:19], s44 offen offset:3072 nt lds
  s_add_u32 m0, s40, 0x14000
  s_mov_b32 s44, 0x4000
  buffer_load_dwordx4 v186, s[20:23], s44 offen offset:0 nt lds
  buffer_load_dwordx4 v187, s[20:23], s44 offen offset:1024 nt lds
  buffer_load_dwordx4 v188, s[20:23], s44 offen offset:2048 nt lds
  buffer_load_dwordx4 v189, s[20:23], s44 offen offset:3072 nt lds
  s_add_u32 m0, s40, 0x18000
  s_mov_b32 s44, 0x8000
  buffer_load_dwordx4 v186, s[20:23], s44 offen offset:0 nt lds
  buffer_load_dwordx4 v187, s[20:23], s44 offen offset:1024 nt lds
  buffer_load_dwordx4 v188, s[20:23], s44 offen offset:2048 nt lds
  buffer_load_dwordx4 v189, s[20:23], s44 offen offset:3072 nt lds
  s_waitcnt vmcnt(24)
  s_barrier
  ds_read_b128 a[0:3], v170 offset:0
  ds_read_b128 a[4:7], v171 offset:0
  ds_read_b128 a[8:11], v172 offset:0
  ds_read_b128 a[12:15], v173 offset:0
  ds_read_b128 a[16:19], v170 offset:256
  ds_read_b128 a[20:23], v171 offset:256
  ds_read_b128 a[24:27], v172 offset:256
  ds_read_b128 a[28:31], v173 offset:256
  ds_read_b128 a[32:35], v170 offset:8192
  ds_read_b128 a[36:39], v171 offset:8192
  ds_read_b128 a[40:43], v172 offset:8192
  ds_read_b128 a[44:47], v173 offset:8192
  ds_read_b128 a[48:51], v170 offset:8448
  ds_read_b128 a[52:55], v171 offset:8448
  ds_read_b128 a[56:59], v172 offset:8448
  ds_read_b128 a[60:63], v173 offset:8448
  s_waitcnt vmcnt(20) lgkmcnt(0)
  s_barrier
  s_add_u32 m0, s40, 0x0
  s_mov_b32 s44, 0x10000
  buffer_load_dwordx4 v182, s[16:19], s44 offen offset:0 nt lds
  buffer_load_dwordx4 v183, s[16:19], s44 offen offset:1024 nt lds
  buffer_load_dwordx4 v184, s[16:19], s44 offen offset:2048 nt lds
  buffer_load_dwordx4 v185, s[16:19], s44 offen offset:3072 nt lds
  v_mfma_f32_16x16x32_bf16 v[128:131], a[0:3], v[192:195], 0
  v_mfma_f32_16x16x32_bf16 v[128:131], a[4:7], v[200:203], v[128:131]
  v_mfma_f32_16x16x32_bf16 v[128:131], a[8:11], v[208:211], v[128:131]
  v_mfma_f32_16x16x32_bf16 v[128:131], a[12:15], v[216:219], v[128:131]
  v_mfma_f32_16x16x32_bf16 v[128:131], a[16:19], v[224:227], v[128:131]
  v_mfma_f32_16x16x32_bf16 v[128:131], a[20:23], v[232:235], v[128:131]
  v_mfma_f32_16x16x32_bf16 v[128:131], a[24:27], v[240:243], v[128:131]
  v_mfma_f32_16x16x32_bf16 v[128:131], a[28:31], v[248:251], v[128:131]
  v_mfma_f32_16x16x32_bf16 v[132:135], a[0:3], v[196:199], 0
  ds_read_b128 a[0:3], v170 offset:16384
  v_mfma_f32_16x16x32_bf16 v[132:135], a[4:7], v[204:207], v[132:135]
  ds_read_b128 a[4:7], v171 offset:16384
  v_mfma_f32_16x16x32_bf16 v[132:135], a[8:11], v[212:215], v[132:135]
  ds_read_b128 a[8:11], v172 offset:16384
  v_mfma_f32_16x16x32_bf16 v[132:135], a[12:15], v[220:223], v[132:135]
  ds_read_b128 a[12:15], v173 offset:16384
  v_mfma_f32_16x16x32_bf16 v[132:135], a[16:19], v[228:231], v[132:135]
  ds_read_b128 a[16:19], v170 offset:16640
  v_mfma_f32_16x16x32_bf16 v[132:135], a[20:23], v[236:239], v[132:135]
  ds_read_b128 a[20:23], v171 offset:16640
  v_mfma_f32_16x16x32_bf16 v[132:135], a[24:27], v[244:247], v[132:135]
  ds_read_b128 a[24:27], v172 offset:16640
  v_mfma_f32_16x16x32_bf16 v[132:135], a[28:31], v[252:255], v[132:135]
  ds_read_b128 a[28:31], v173 offset:16640
  v_mfma_f32_16x16x32_bf16 v[136:139], a[32:35], v[192:195], 0
  v_mfma_f32_16x16x32_bf16 v[136:139], a[36:39], v[200:203], v[136:139]
  v_mfma_f32_16x16x32_bf16 v[136:139], a[40:43], v[208:211], v[136:139]
  v_mfma_f32_16x16x32_bf16 v[136:139], a[44:47], v[216:219], v[136:139]
  v_mfma_f32_16x16x32_bf16 v[136:139], a[48:51], v[224:227], v[136:139]
  v_mfma_f32_16x16x32_bf16 v[136:139], a[52:55], v[232:235], v[136:139]
  v_mfma_f32_16x16x32_bf16 v[136:139], a[56:59], v[240:243], v[136:139]
  v_mfma_f32_16x16x32_bf16 v[136:139], a[60:63], v[248:251], v[136:139]
  v_mfma_f32_16x16x32_bf16 v[140:143], a[32:35], v[196:199], 0
  ds_read_b128 a[32:35], v170 offset:24576
  v_mfma_f32_16x16x32_bf16 v[140:143], a[36:39], v[204:207], v[140:143]
  ds_read_b128 a[36:39], v171 offset:24576
  v_mfma_f32_16x16x32_bf16 v[140:143], a[40:43], v[212:215], v[140:143]
  ds_read_b128 a[40:43], v172 offset:24576
  v_mfma_f32_16x16x32_bf16 v[140:143], a[44:47], v[220:223], v[140:143]
  ds_read_b128 a[44:47], v173 offset:24576
  v_mfma_f32_16x16x32_bf16 v[140:143], a[48:51], v[228:231], v[140:143]
  ds_read_b128 a[48:51], v170 offset:24832
  v_mfma_f32_16x16x32_bf16 v[140:143], a[52:55], v[236:239], v[140:143]
  ds_read_b128 a[52:55], v171 offset:24832
  v_mfma_f32_16x16x32_bf16 v[140:143], a[56:59], v[244:247], v[140:143]
  ds_read_b128 a[56:59], v172 offset:24832
  v_mfma_f32_16x16x32_bf16 v[140:143], a[60:63], v[252:255], v[140:143]
  ds_read_b128 a[60:63], v173 offset:24832
  s_nop 7
  v_add_f32 v128, v128, v161
  v_add_f32 v129, v129, v162
  v_add_f32 v130, v130, v163
  v_add_f32 v131, v131, v160
  v_add_f32 v132, v132, v165
  v_add_f32 v133, v133, v166
  v_add_f32 v134, v134, v167
  v_add_f32 v135, v135, v164
  v_add_f32 v136, v136, v161
  v_add_f32 v137, v137, v162
  v_add_f32 v138, v138, v163
  v_add_f32 v139, v139, v160
  v_add_f32 v140, v140, v165
  v_add_f32 v141, v141, v166
  v_add_f32 v142, v142, v167
  v_add_f32 v143, v143, v164
  v_exp_f32 v128, v128
  v_exp_f32 v129, v129
  v_exp_f32 v130, v130
  v_exp_f32 v131, v131
  v_exp_f32 v132, v132
  v_exp_f32 v133, v133
  v_exp_f32 v134, v134
  v_exp_f32 v135, v135
  v_exp_f32 v136, v136
  v_exp_f32 v137, v137
  v_exp_f32 v138, v138
  v_exp_f32 v139, v139
  v_exp_f32 v140, v140
  v_exp_f32 v141, v141
  v_exp_f32 v142, v142
  v_exp_f32 v143, v143
  v_add_f32 v168, v128, v129
  v_add_f32 v169, v132, v133
  v_add_f32 v168, v130, v168
  v_add_f32 v168, v131, v168
  v_add_f32 v169, v134, v169
  v_add_f32 v169, v135, v169
  v_add_f32 v168, v136, v168
  v_add_f32 v168, v137, v168
  v_add_f32 v168, v138, v168
  v_add_f32 v168, v139, v168
  v_add_f32 v169, v140, v169
  v_add_f32 v169, v141, v169
  v_add_f32 v169, v142, v169
  v_add_f32 v169, v143, v169
  v_cvt_pk_bf16_f32 v144, v128, v129
  v_cvt_pk_bf16_f32 v145, v130, v131
  v_cvt_pk_bf16_f32 v148, v132, v133
  v_cvt_pk_bf16_f32 v149, v134, v135
  v_cvt_pk_bf16_f32 v146, v136, v137
  v_cvt_pk_bf16_f32 v147, v138, v139
  v_cvt_pk_bf16_f32 v150, v140, v141
  v_cvt_pk_bf16_f32 v151, v142, v143
  s_mov_b32 s42, 49152
  s_mov_b32 s41, 81920
  buffer_load_dwordx4 a[128:131], v190, s[76:79], s47 offen
  buffer_load_dwordx4 a[128:131], v190, s[76:79], s47 offen
  s_branch K2_loop
K2_end:
  s_endpgm
.section .rodata,"a"
.p2align 6
.amdhsa_kernel adaLN_cond__mha_block_cached__dense_activation_silu__prompt_kernel
  .amdhsa_next_free_vgpr 388
  .amdhsa_next_free_sgpr 80
  .amdhsa_accum_offset 256
  .amdhsa_group_segment_fixed_size 0
  .amdhsa_kernarg_size 104
  .amdhsa_user_sgpr_count 2
  .amdhsa_user_sgpr_kernarg_segment_ptr 1
  .amdhsa_system_sgpr_workgroup_id_x 1
  .amdhsa_float_denorm_mode_32 3
  .amdhsa_float_denorm_mode_16_64 3
.end_amdhsa_kernel
.text
CODE_END:
```
